```python
import torch

def _softmax(x, axis=-1):
    return torch.softmax(x, dim=axis)
def _gelu(x):
    return torch.nn.functional.gelu(x, approximate="tanh")
def _silu(x):
    return torch.nn.functional.silu(x)
def _sigmoid(x):
    return torch.sigmoid(x)
def _layernorm(x, axis=-1, eps=1e-5):
    m = x.mean(dim=axis, keepdim=True)
    v = x.var(dim=axis, keepdim=True, unbiased=False)
    return (x - m) / torch.sqrt(v + eps)
def _scatter_add(tgt, idx, src, axis=0):
    return tgt.clone().index_add_(axis, idx, src)
def _segment_sum(src, seg, n):
    out = torch.zeros((n,) + src.shape[1:], dtype=src.dtype)
    return out.index_add_(0, seg, src)
def _pad(x, pw):
    flat = tuple(v for pair in reversed(pw) for v in pair)
    return torch.nn.functional.pad(x, flat)

kernel_name = 'concat_heads__gqa_block_cached__mha_block_cached__near_ridge'

def setup_inputs():

    _w = (lambda a: (lambda t: t.to(torch.bfloat16) if t.is_floating_point() else t)(torch.as_tensor(a)))
    def _A_setup():
        B, Sq, D = 32, 80, 448
        Hq, Hkv, Sk, Dh = 16, 8, 512, 256
        assert Hq % Hkv == 0, (Hq, Hkv)
        return {
            "x": _w((lambda *s: torch.randn(*s, dtype=torch.bfloat16) * 0.8)(B, Sq, D)),
            "k_cache": _w((lambda *s: torch.randn(*s, dtype=torch.bfloat16) * 0.8)(B, Hkv, Sk, Dh)),
            "v_cache": _w((lambda *s: torch.randn(*s, dtype=torch.bfloat16) * 0.05)(B, Hkv, Sk, Dh)),
            "wq": _w((lambda *s: torch.randn(*s, dtype=torch.bfloat16) * 0.8)(D, Hq * Dh) * (D ** -0.5)),
            "wo": _w((lambda *s: torch.randn(*s, dtype=torch.bfloat16) * 0.05)(Hq * Dh, D) * ((Hq * Dh) ** -0.5)),
        }
    _A_in = _A_setup()

    def _B_setup():
        B, Sq, D = 32, 80, 448
        H, Sk, Dh = 16, 512, 256
        return {
            "x": _w((lambda *s: torch.randn(*s, dtype=torch.bfloat16) * 0.8)(B, Sq, D)),
            "k_cache": _w((lambda *s: torch.randn(*s, dtype=torch.bfloat16) * 0.8)(B, H, Sk, Dh)),
            "v_cache": _w((lambda *s: torch.randn(*s, dtype=torch.bfloat16) * 0.05)(B, H, Sk, Dh)),
            "wq": _w((lambda *s: torch.randn(*s, dtype=torch.bfloat16) * 0.8)(D, H * Dh) * (D ** -0.5)),
            "wo": _w((lambda *s: torch.randn(*s, dtype=torch.bfloat16) * 0.05)(H * Dh, D) * ((H * Dh) ** -0.5)),
        }
    _B_in = _B_setup()

    return {
        "A_x": _A_in["x"],
        "A_k_cache": _A_in["k_cache"],
        "A_v_cache": _A_in["v_cache"],
        "A_wq": _A_in["wq"],
        "A_wo": _A_in["wo"],
        "B_x": _B_in["x"],
        "B_k_cache": _B_in["k_cache"],
        "B_v_cache": _B_in["v_cache"],
        "B_wq": _B_in["wq"],
        "B_wo": _B_in["wo"],
    }

def reference(A_x, A_k_cache, A_v_cache, A_wq, A_wo, B_x, B_k_cache, B_v_cache, B_wq, B_wo):
    def _A_ref(x, k_cache, v_cache, wq, wo):
        B, Sq, D = x.shape
        Hq, Dh = 16, 256
        Hkv = k_cache.shape[1]
        rep = Hq // Hkv
        q = (lambda x, *d: x.permute(*d))((x @ wq).reshape(B, Sq, Hq, Dh), 0, 2, 1, 3)
        k = (lambda x, n, axis: torch.repeat_interleave(x, n, dim=axis))(k_cache, rep, axis=1)
        v = (lambda x, n, axis: torch.repeat_interleave(x, n, dim=axis))(v_cache, rep, axis=1)
        scores = torch.einsum("bhqd,bhkd->bhqk", q, k) * (Dh ** -0.5)
        p = _softmax(scores, axis=-1)
        o = torch.einsum("bhqk,bhkd->bhqd", p, v)
        return (lambda x, *d: x.permute(*d))(o, 0, 2, 1, 3).reshape(B, Sq, Hq * Dh) @ wo

    def _B_ref(x, k_cache, v_cache, wq, wo):
        B, Sq, D = x.shape
        H, Dh = 16, 256
        q = (lambda x, *d: x.permute(*d))((x @ wq).reshape(B, Sq, H, Dh), 0, 2, 1, 3)
        scores = torch.einsum("bhqd,bhkd->bhqk", q, k_cache) * (Dh ** -0.5)
        p = _softmax(scores, axis=-1)
        o = torch.einsum("bhqk,bhkd->bhqd", p, v_cache)
        return (lambda x, *d: x.permute(*d))(o, 0, 2, 1, 3).reshape(B, Sq, H * Dh) @ wo

    a = _A_ref(A_x, A_k_cache, A_v_cache, A_wq, A_wo)
    b = _B_ref(B_x, B_k_cache, B_v_cache, B_wq, B_wo)
    return torch.concatenate([a, b], axis=-1)
```

```asm
; @launch kernel=concat_heads__gqa_block_cached__mha_block_cached__near_ridge_kernel grid=(256,1,1) block=(512,1,1) lds=163840
; @launch kernel=reduce_kernel grid=(2240,1,1) block=(128,1,1) lds=0
.amdgcn_target "amdgcn-amd-amdhsa--gfx950"
.text
.globl concat_heads__gqa_block_cached__mha_block_cached__near_ridge_kernel
.p2align 8
.type concat_heads__gqa_block_cached__mha_block_cached__near_ridge_kernel,@function
concat_heads__gqa_block_cached__mha_block_cached__near_ridge_kernel:
    s_cmp_ge_u32 s2, 256
    s_cbranch_scc1 L_attn_done
    s_load_dwordx16 s[4:19], s[0:1], 0
    s_load_dwordx4 s[20:23], s[0:1], 64
    s_load_dwordx2 s[24:25], s[0:1], 96
    v_lshrrev_b32 v7, 6, v0
    v_and_b32 v4, 63, v0
    v_readfirstlane_b32 s83, v7
    v_lshrrev_b32 v5, 4, v4
    v_and_b32 v6, 15, v4
    s_nop 1
    s_and_b32 s84, s83, 3
    s_lshr_b32 s85, s83, 2
    s_lshr_b32 s86, s2, 3
    s_and_b32 s87, s2, 7
    s_mul_i32 s76, s83, 10240
    s_add_u32 s76, s76, 81920
    s_mul_i32 s81, s85, 20480
    s_lshl_b32 s88, s84, 10
    s_add_u32 s81, s81, s88
    v_and_b32 v1, 7, v4
    v_lshlrev_b32 v3, 1, v5
    v_xor_b32 v3, v3, v1
    v_lshlrev_b32 v3, 4, v3
    v_lshrrev_b32 v2, 3, v4
    s_lshl_b32 s88, s84, 7
    v_lshrrev_b32 v7, 5, v4
    v_lshlrev_b32 v7, 3, v7
    v_and_b32 v243, 3, v2
    v_add_u32 v7, v7, v243
    v_lshl_add_u32 v243, v7, 13, v3
    v_add_u32 v243, s88, v243
    v_add_u32 v244, 130048, v243
    s_lshr_b32 s91, s86, 1
    s_min_u32 s91, s91, 13
    s_lshl_b32 s98, s91, 18
    s_sub_u32 s98, s98, 262144
    s_cselect_b32 s98, 3407872, s98
    s_lshl_b32 s89, s84, 2
    s_lshl_b32 s90, s85, 8
    s_lshl_b32 s91, s91, 6
    s_add_u32 s90, s90, s91
    v_add_u32 v8, s89, v5
    v_xor_b32 v9, v8, v6
    v_lshl_add_u32 v9, v9, 4, s90
    v_mul_u32_u24 v8, 896, v8
    v_subrev_u32 v10, 896, v9
    v_min_u32 v10, v10, v9
    v_add_u32 v222, v8, v10
    v_add_u32 v9, 512, v9
    v_subrev_u32 v10, 896, v9
    v_min_u32 v10, v10, v9
    v_add_u32 v223, v8, v10
    v_subrev_u32 v9, s91, v9
    v_mov_b32 v10, 0x4000000
    v_cmp_gt_u32 vcc, 896, v9
    s_nop 1
    v_cndmask_b32 v223, v10, v223, vcc
    s_waitcnt lgkmcnt(0)
    s_getreg_b32 s3, hwreg(HW_REG_XCC_ID)
    s_and_b32 s3, s3, 1
    s_cmp_eq_u32 s3, 1
    s_cselect_b64 s[28:29], s[14:15], s[4:5]
    s_cselect_b64 s[32:33], s[20:21], s[10:11]
    s_cselect_b64 s[36:37], s[4:5], s[14:15]
    s_cselect_b64 s[40:41], s[10:11], s[20:21]
    s_mul_i32 s90, s86, 71680
    s_add_u32 s28, s28, s90
    s_addc_u32 s29, s29, 0
    s_and_b32 s29, s29, 0xffff
    s_mov_b32 s30, 71680
    s_mov_b32 s31, 0x20000
    s_lshl_b32 s89, s87, 1
    s_add_u32 s89, s89, s85
    s_lshl_b32 s89, s89, 9
    s_sub_u32 s91, 3670016, s89
    s_add_u32 s32, s32, s89
    s_addc_u32 s33, s33, 0
    s_and_b32 s33, s33, 0xffff
    s_mov_b32 s34, s91
    s_mov_b32 s35, 0x20000
    s_add_u32 s98, s98, 262144
    s_sub_u32 s77, s98, 3670016
    s_cselect_b32 s98, s98, s77
    s_add_u32 s77, s98, 0
    s_add_u32 m0, s76, 0
    s_nop 0
    buffer_load_dwordx4 v243, s[32:35], s77 offen lds
    buffer_load_dwordx4 v244, s[32:35], s77 offen offset:1024 lds
    s_add_u32 s77, s98, 32768
    s_add_u32 m0, s76, 2048
    s_nop 0
    buffer_load_dwordx4 v243, s[32:35], s77 offen lds
    buffer_load_dwordx4 v244, s[32:35], s77 offen offset:1024 lds
    s_barrier
    s_mov_b32 s77, 0
    s_add_u32 m0, s81, 0
    s_nop 0
    buffer_load_dwordx4 v222, s[28:31], s77 offen lds
    s_mov_b32 s77, 14336
    s_add_u32 m0, s81, 4096
    s_nop 0
    buffer_load_dwordx4 v222, s[28:31], s77 offen lds
    s_mov_b32 s77, 28672
    s_add_u32 m0, s81, 8192
    s_nop 0
    buffer_load_dwordx4 v222, s[28:31], s77 offen lds
    s_mov_b32 s77, 43008
    s_add_u32 m0, s81, 12288
    s_nop 0
    buffer_load_dwordx4 v222, s[28:31], s77 offen lds
    s_mov_b32 s77, 57344
    s_add_u32 m0, s81, 16384
    s_nop 0
    buffer_load_dwordx4 v222, s[28:31], s77 offen lds
    s_mov_b32 s77, 0
    s_add_u32 m0, s81, 40960
    s_nop 0
    buffer_load_dwordx4 v223, s[28:31], s77 offen lds
    s_mov_b32 s77, 14336
    s_add_u32 m0, s81, 45056
    s_nop 0
    buffer_load_dwordx4 v223, s[28:31], s77 offen lds
    s_mov_b32 s77, 28672
    s_add_u32 m0, s81, 49152
    s_nop 0
    buffer_load_dwordx4 v223, s[28:31], s77 offen lds
    s_mov_b32 s77, 43008
    s_add_u32 m0, s81, 53248
    s_nop 0
    buffer_load_dwordx4 v223, s[28:31], s77 offen lds
    s_mov_b32 s77, 57344
    s_add_u32 m0, s81, 57344
    s_nop 0
    buffer_load_dwordx4 v223, s[28:31], s77 offen lds
    s_add_u32 s36, s36, s90
    s_addc_u32 s37, s37, 0
    s_and_b32 s37, s37, 0xffff
    s_mov_b32 s38, 71680
    s_mov_b32 s39, 0x20000
    s_add_u32 s40, s40, s89
    s_addc_u32 s41, s41, 0
    s_and_b32 s41, s41, 0xffff
    s_mov_b32 s42, s91
    s_mov_b32 s43, 0x20000
    s_mul_i32 s82, s83, 10240
    s_mov_b32 s78, 0x3db8aa3b
    s_mov_b32 s79, 0x3db8aa3b
    s_mov_b32 s80, 0xbdb8aa3b
    s_mov_b32 s92, 0
    s_mul_i32 s93, s85, 40960
    s_xor_b32 s94, s84, 0
    s_lshl_b32 s94, s94, 7
    s_xor_b32 s95, s84, 1
    s_lshl_b32 s95, s95, 7
    s_xor_b32 s96, s84, 2
    s_lshl_b32 s96, s96, 7
    s_xor_b32 s97, s84, 3
    s_lshl_b32 s97, s97, 7
    v_lshl_add_u32 v220, v2, 9, v3
    v_add_u32 v220, s88, v220
    v_add_u32 v221, 3072, v220
    s_lshl_b32 s89, s83, 7
    s_cmp_eq_u32 s83, 7
    s_cselect_b32 s89, 0x4000000, s89
    v_mul_u32_u24 v245, 896, v2
    v_add3_u32 v245, v245, v3, s89
    v_add_u32 v246, 6144, v245
    v_xor_b32 v1, v1, v5
    v_lshlrev_b32 v1, 4, v1
    v_lshl_add_u32 v218, v2, 9, v1
    s_lshl_b32 s89, s84, 16
    v_add_u32 v218, s89, v218
    v_xor_b32 v219, 64, v218
    v_add_u32 v219, 3072, v219
    v_lshrrev_b32 v1, 2, v4
    v_lshlrev_b32 v1, 7, v1
    v_bfe_u32 v2, v4, 3, 2
    v_lshl_add_u32 v1, v2, 5, v1
    v_and_b32 v2, 3, v4
    v_lshl_add_u32 v1, v2, 3, v1
    v_add_u32 v233, s76, v1
    v_xor_b32 v234, 32, v233
    v_xor_b32 v235, 64, v233
    v_xor_b32 v236, 96, v233
    v_lshrrev_b32 v1, 1, v6
    v_xor_b32 v1, v1, v5
    v_lshlrev_b32 v1, 4, v1
    v_lshl_add_u32 v1, v6, 7, v1
    v_add_u32 v216, s76, v1
    v_xor_b32 v217, 64, v216
    v_xor_b32 v1, v5, v6
    v_lshlrev_b32 v1, 4, v1
    v_lshl_add_u32 v237, v6, 8, v1
    v_xor_b32 v238, 64, v237
    v_xor_b32 v239, 128, v237
    v_xor_b32 v240, 192, v237
    v_add_u32 v241, 61440, v237
    v_add_u32 v242, 61440, v238
    v_lshlrev_b32 v230, 4, v4
    v_add_u32 v247, 40960, v230
    s_mul_i32 s89, s85, 40960
    s_mul_i32 s90, s84, 10240
    s_add_u32 s90, s90, s89
    v_add_u32 v224, s89, v230
    s_mul_i32 s91, s84, 5120
    v_add_u32 v228, s91, v224
    v_lshrrev_b32 v1, 1, v5
    v_lshlrev_b32 v1, 8, v1
    v_and_b32 v2, 1, v5
    v_lshl_add_u32 v1, v2, 9, v1
    v_lshl_add_u32 v1, v6, 4, v1
    v_add_u32 v231, s90, v1
    v_lshlrev_b32 v1, 3, v6
    v_add_u32 v226, s76, v1
    s_add_u32 s89, s93, 81920
    v_add_u32 v227, s89, v1
    v_add_u32 v229, s81, v230
    s_lshr_b32 s91, s86, 1
    s_and_b32 s91, s91, 14
    s_lshl_b32 s89, s83, 1
    s_sub_u32 s89, s89, s91
    s_and_b32 s89, s89, 15
    s_mul_i32 s89, s89, 5120
    v_add_u32 v232, s89, v230
    s_add_u32 s91, s91, 15
    s_and_b32 s91, s91, 15
    s_mul_i32 s99, s91, 28672
    s_lshl_b32 s89, s86, 3
    s_add_u32 s89, s89, s87
    s_lshl_b32 s90, s89, 18
    s_lshl_b32 s91, s85, 13
    s_add_u32 s90, s90, s91
    s_sub_u32 s91, 262144, s91
    s_mov_b64 s[48:49], s[6:7]
    s_mov_b64 s[52:53], s[8:9]
    s_add_u32 s48, s48, s90
    s_addc_u32 s49, s49, 0
    s_and_b32 s49, s49, 0xffff
    s_mov_b32 s50, s91
    s_mov_b32 s51, 0x20000
    s_add_u32 s52, s52, s90
    s_addc_u32 s53, s53, 0
    s_and_b32 s53, s53, 0xffff
    s_mov_b32 s54, s91
    s_mov_b32 s55, 0x20000
    s_lshl_b32 s90, s89, 1
    s_add_u32 s90, s90, s85
    s_lshl_b32 s90, s90, 18
    s_mov_b64 s[60:61], s[16:17]
    s_mov_b64 s[64:65], s[18:19]
    s_add_u32 s60, s60, s90
    s_addc_u32 s61, s61, 0
    s_and_b32 s61, s61, 0xffff
    s_mov_b32 s62, 262144
    s_mov_b32 s63, 0x20000
    s_add_u32 s64, s64, s90
    s_addc_u32 s65, s65, 0
    s_and_b32 s65, s65, 0xffff
    s_mov_b32 s66, 262144
    s_mov_b32 s67, 0x20000
    s_mul_i32 s90, s87, 458752
    s_mov_b64 s[56:57], s[12:13]
    s_mov_b64 s[68:69], s[22:23]
    s_add_u32 s56, s56, s90
    s_addc_u32 s57, s57, 0
    s_and_b32 s57, s57, 0xffff
    s_mov_b32 s58, 458752
    s_mov_b32 s59, 0x20000
    s_add_u32 s68, s68, s90
    s_addc_u32 s69, s69, 0
    s_and_b32 s69, s69, 0xffff
    s_mov_b32 s70, 458752
    s_mov_b32 s71, 0x20000
    s_add_u32 s90, s89, 0
    s_mul_i32 s90, s90, 71680
    s_add_u32 s72, s24, s90
    s_addc_u32 s73, s25, 0
    s_and_b32 s73, s73, 0xffff
    s_add_u32 s90, s89, 256
    s_mul_i32 s90, s90, 71680
    s_add_u32 s74, s24, s90
    s_addc_u32 s75, s25, 0
    s_and_b32 s75, s75, 0xffff
    s_mov_b64 s[44:45], s[72:73]
    s_mov_b32 s46, 0
    s_mov_b32 s47, 0x20000
    v_add_u32 v253, s76, v230
    s_cmp_eq_u32 s3, 1
    s_cbranch_scc0 L_sk1
    s_add_u32 s88, s95, 16384
    buffer_load_dwordx4 v[100:103], v218, s[60:63], s88 offen nt
    buffer_load_dwordx4 v[104:107], v219, s[60:63], s88 offen offset:1024 nt
    s_add_u32 s88, s95, 24576
    buffer_load_dwordx4 v[108:111], v218, s[60:63], s88 offen nt
    buffer_load_dwordx4 v[112:115], v219, s[60:63], s88 offen offset:1024 nt
    s_add_u32 s88, s96, 0
    buffer_load_dwordx4 v[116:119], v218, s[60:63], s88 offen nt
    buffer_load_dwordx4 v[120:123], v219, s[60:63], s88 offen offset:1024 nt
    s_add_u32 s88, s96, 8192
    buffer_load_dwordx4 v[124:127], v218, s[60:63], s88 offen nt
    buffer_load_dwordx4 v[128:131], v219, s[60:63], s88 offen offset:1024 nt
    s_add_u32 s88, s96, 16384
    buffer_load_dwordx4 v[132:135], v218, s[60:63], s88 offen nt
    buffer_load_dwordx4 v[136:139], v219, s[60:63], s88 offen offset:1024 nt
    s_add_u32 s88, s96, 24576
    buffer_load_dwordx4 v[140:143], v218, s[60:63], s88 offen nt
    buffer_load_dwordx4 v[144:147], v219, s[60:63], s88 offen offset:1024 nt
    s_add_u32 s88, s97, 0
    buffer_load_dwordx4 v[148:151], v218, s[60:63], s88 offen nt
    buffer_load_dwordx4 v[152:155], v219, s[60:63], s88 offen offset:1024 nt
L_sk1:
    s_add_u32 s98, s98, 262144
    s_sub_u32 s77, s98, 3670016
    s_cselect_b32 s98, s98, s77
    s_add_u32 s77, s98, 0
    s_add_u32 m0, s76, 4096
    s_nop 0
    buffer_load_dwordx4 v243, s[32:35], s77 offen lds
    buffer_load_dwordx4 v244, s[32:35], s77 offen offset:1024 lds
    s_add_u32 s77, s98, 32768
    s_add_u32 m0, s76, 6144
    s_nop 0
    buffer_load_dwordx4 v243, s[32:35], s77 offen lds
    buffer_load_dwordx4 v244, s[32:35], s77 offen offset:1024 lds
    s_add_u32 s98, s98, 262144
    s_sub_u32 s77, s98, 3670016
    s_cselect_b32 s98, s98, s77
    s_add_u32 s77, s98, 0
    s_add_u32 m0, s76, 8192
    s_nop 0
    buffer_load_dwordx4 v243, s[32:35], s77 offen lds
    buffer_load_dwordx4 v244, s[32:35], s77 offen offset:1024 lds
    s_waitcnt vmcnt(16)
    ds_read_b64_tr_b16 v[160:161], v233
    ds_read_b64_tr_b16 v[164:165], v234
    ds_read_b64_tr_b16 v[168:169], v235
    ds_read_b64_tr_b16 v[172:173], v236
    ds_read_b64_tr_b16 v[162:163], v233 offset:2048
    ds_read_b64_tr_b16 v[166:167], v234 offset:2048
    ds_read_b64_tr_b16 v[170:171], v235 offset:2048
    ds_read_b64_tr_b16 v[174:175], v236 offset:2048
    s_waitcnt vmcnt(11)
    s_waitcnt lgkmcnt(0)
    s_barrier
    ds_read_b128 v[192:195], v237
    ds_read_b128 v[196:199], v237 offset:4096
    ds_read_b128 v[200:203], v237 offset:8192
    ds_read_b128 v[204:207], v237 offset:12288
    ds_read_b128 v[208:211], v237 offset:16384
    s_add_u32 s77, s98, 32768
    s_add_u32 m0, s76, 0
    s_nop 0
    buffer_load_dwordx4 v243, s[32:35], s77 offen lds
    buffer_load_dwordx4 v244, s[32:35], s77 offen offset:1024 lds
    s_add_u32 s98, s98, 262144
    s_sub_u32 s77, s98, 3670016
    s_cselect_b32 s98, s98, s77
    s_add_u32 s77, s98, 0
    s_add_u32 m0, s76, 2048
    s_nop 0
    buffer_load_dwordx4 v243, s[32:35], s77 offen lds
    buffer_load_dwordx4 v244, s[32:35], s77 offen offset:1024 lds
    s_waitcnt lgkmcnt(0)
    s_cmp_eq_u32 s3, 1
    s_cbranch_scc1 L_body1
L_body0:
    s_setprio 3
    s_waitcnt vmcnt(8)
    s_waitcnt lgkmcnt(4)
    v_mfma_f32_16x16x32_bf16 v[0:3], v[160:163], v[192:195], 0
    ds_read_b64_tr_b16 v[176:177], v233 offset:4096
    ds_read_b64_tr_b16 v[180:181], v234 offset:4096
    v_mfma_f32_16x16x32_bf16 v[20:23], v[164:167], v[192:195], 0
    ds_read_b64_tr_b16 v[184:185], v235 offset:4096
    ds_read_b64_tr_b16 v[188:189], v236 offset:4096
    v_mfma_f32_16x16x32_bf16 v[40:43], v[168:171], v[192:195], 0
    v_mfma_f32_16x16x32_bf16 v[60:63], v[172:175], v[192:195], 0
    ds_read_b128 v[192:195], v238
    s_waitcnt lgkmcnt(8)
    v_mfma_f32_16x16x32_bf16 v[4:7], v[160:163], v[196:199], 0
    v_mfma_f32_16x16x32_bf16 v[24:27], v[164:167], v[196:199], 0
    s_cmp_eq_u32 s92, 0
    s_cbranch_scc1 L_sk2
    s_add_u32 s88, s82, 0
    buffer_store_dwordx4 v[120:123], v230, s[44:47], s88 offen sc1
L_sk2:
    s_waitcnt lgkmcnt(1)
    s_add_u32 s77, s98, 32768
    s_add_u32 m0, s76, 4096
    s_nop 0
    buffer_load_dwordx4 v243, s[32:35], s77 offen lds
    buffer_load_dwordx4 v244, s[32:35], s77 offen offset:1024 lds
    v_mfma_f32_16x16x32_bf16 v[44:47], v[168:171], v[196:199], 0
    v_mfma_f32_16x16x32_bf16 v[64:67], v[172:175], v[196:199], 0
    ds_read_b128 v[196:199], v238 offset:4096
    v_mfma_f32_16x16x32_bf16 v[8:11], v[160:163], v[200:203], 0
    v_mfma_f32_16x16x32_bf16 v[28:31], v[164:167], v[200:203], 0
    s_waitcnt vmcnt(8)
    v_mfma_f32_16x16x32_bf16 v[48:51], v[168:171], v[200:203], 0
    ds_read_b64_tr_b16 v[178:179], v233 offset:6144
    ds_read_b64_tr_b16 v[182:183], v234 offset:6144
    v_mfma_f32_16x16x32_bf16 v[68:71], v[172:175], v[200:203], 0
    ds_read_b64_tr_b16 v[186:187], v235 offset:6144
    ds_read_b64_tr_b16 v[190:191], v236 offset:6144
    ds_read_b128 v[200:203], v238 offset:8192
    v_mfma_f32_16x16x32_bf16 v[12:15], v[160:163], v[204:207], 0
    v_mfma_f32_16x16x32_bf16 v[32:35], v[164:167], v[204:207], 0
    s_cmp_eq_u32 s92, 0
    s_cbranch_scc1 L_sk3
    s_add_u32 s88, s82, 1024
    buffer_store_dwordx4 v[124:127], v230, s[44:47], s88 offen sc1
L_sk3:
    v_mfma_f32_16x16x32_bf16 v[52:55], v[168:171], v[204:207], 0
    v_mfma_f32_16x16x32_bf16 v[72:75], v[172:175], v[204:207], 0
    ds_read_b128 v[204:207], v238 offset:12288
    s_waitcnt lgkmcnt(2)
    s_add_u32 s98, s98, 262144
    s_sub_u32 s77, s98, 3670016
    s_cselect_b32 s98, s98, s77
    s_add_u32 s77, s98, 0
    s_add_u32 m0, s76, 6144
    s_nop 0
    buffer_load_dwordx4 v243, s[32:35], s77 offen lds
    buffer_load_dwordx4 v244, s[32:35], s77 offen offset:1024 lds
    v_mfma_f32_16x16x32_bf16 v[16:19], v[160:163], v[208:211], 0
    v_mfma_f32_16x16x32_bf16 v[36:39], v[164:167], v[208:211], 0
    v_mfma_f32_16x16x32_bf16 v[56:59], v[168:171], v[208:211], 0
    v_mfma_f32_16x16x32_bf16 v[76:79], v[172:175], v[208:211], 0
    ds_read_b128 v[208:211], v238 offset:16384
    s_setprio 2
    s_waitcnt vmcnt(8)
    s_barrier
    v_mfma_f32_16x16x32_bf16 v[0:3], v[176:179], v[192:195], v[0:3]
    ds_read_b64_tr_b16 v[160:161], v233 offset:8192
    ds_read_b64_tr_b16 v[164:165], v234 offset:8192
    v_mfma_f32_16x16x32_bf16 v[20:23], v[180:183], v[192:195], v[20:23]
    ds_read_b64_tr_b16 v[168:169], v235 offset:8192
    ds_read_b64_tr_b16 v[172:173], v236 offset:8192
    v_mfma_f32_16x16x32_bf16 v[40:43], v[184:187], v[192:195], v[40:43]
    v_mfma_f32_16x16x32_bf16 v[60:63], v[188:191], v[192:195], v[60:63]
    ds_read_b128 v[192:195], v239
    v_mfma_f32_16x16x32_bf16 v[4:7], v[176:179], v[196:199], v[4:7]
    v_mfma_f32_16x16x32_bf16 v[24:27], v[180:183], v[196:199], v[24:27]
    s_cmp_eq_u32 s92, 0
    s_cbranch_scc1 L_sk4
    s_add_u32 s88, s82, 2048
    buffer_store_dwordx4 v[128:131], v230, s[44:47], s88 offen sc1
L_sk4:
    s_waitcnt lgkmcnt(1)
    s_add_u32 s77, s98, 32768
    s_add_u32 m0, s76, 8192
    s_nop 0
    buffer_load_dwordx4 v243, s[32:35], s77 offen lds
    buffer_load_dwordx4 v244, s[32:35], s77 offen offset:1024 lds
    v_mfma_f32_16x16x32_bf16 v[44:47], v[184:187], v[196:199], v[44:47]
    v_mfma_f32_16x16x32_bf16 v[64:67], v[188:191], v[196:199], v[64:67]
    ds_read_b128 v[196:199], v239 offset:4096
    v_mfma_f32_16x16x32_bf16 v[8:11], v[176:179], v[200:203], v[8:11]
    s_cmp_eq_u32 s92, 0
    s_cbranch_scc1 L_sk5
    ds_write_b128 v229, v[100:103] offset:40960
L_sk5:
    v_mfma_f32_16x16x32_bf16 v[28:31], v[180:183], v[200:203], v[28:31]
    s_waitcnt vmcnt(8)
    v_mfma_f32_16x16x32_bf16 v[48:51], v[184:187], v[200:203], v[48:51]
    ds_read_b64_tr_b16 v[162:163], v233
    ds_read_b64_tr_b16 v[166:167], v234
    v_mfma_f32_16x16x32_bf16 v[68:71], v[188:191], v[200:203], v[68:71]
    ds_read_b64_tr_b16 v[170:171], v235
    ds_read_b64_tr_b16 v[174:175], v236
    ds_read_b128 v[200:203], v239 offset:8192
    v_mfma_f32_16x16x32_bf16 v[12:15], v[176:179], v[204:207], v[12:15]
    v_mfma_f32_16x16x32_bf16 v[32:35], v[180:183], v[204:207], v[32:35]
    s_cmp_eq_u32 s92, 0
    s_cbranch_scc1 L_sk6
    s_add_u32 s88, s82, 3072
    buffer_store_dwordx4 v[132:135], v230, s[44:47], s88 offen sc1
L_sk6:
    v_mfma_f32_16x16x32_bf16 v[52:55], v[184:187], v[204:207], v[52:55]
    v_mfma_f32_16x16x32_bf16 v[72:75], v[188:191], v[204:207], v[72:75]
    ds_read_b128 v[204:207], v239 offset:12288
    s_waitcnt lgkmcnt(2)
    s_add_u32 s98, s98, 262144
    s_sub_u32 s77, s98, 3670016
    s_cselect_b32 s98, s98, s77
    s_add_u32 s77, s98, 0
    s_add_u32 m0, s76, 0
    s_nop 0
    buffer_load_dwordx4 v243, s[32:35], s77 offen lds
    buffer_load_dwordx4 v244, s[32:35], s77 offen offset:1024 lds
    v_mfma_f32_16x16x32_bf16 v[16:19], v[176:179], v[208:211], v[16:19]
    v_mfma_f32_16x16x32_bf16 v[36:39], v[180:183], v[208:211], v[36:39]
    v_mfma_f32_16x16x32_bf16 v[56:59], v[184:187], v[208:211], v[56:59]
    s_cmp_eq_u32 s92, 0
    s_cbranch_scc1 L_sk7
    ds_write_b128 v229, v[104:107] offset:45056
L_sk7:
    v_mfma_f32_16x16x32_bf16 v[76:79], v[188:191], v[208:211], v[76:79]
    ds_read_b128 v[208:211], v239 offset:16384
    s_setprio 1
    s_waitcnt vmcnt(8)
    v_mfma_f32_16x16x32_bf16 v[0:3], v[160:163], v[192:195], v[0:3]
    ds_read_b64_tr_b16 v[176:177], v233 offset:2048
    ds_read_b64_tr_b16 v[180:181], v234 offset:2048
    v_mfma_f32_16x16x32_bf16 v[20:23], v[164:167], v[192:195], v[20:23]
    ds_read_b64_tr_b16 v[184:185], v235 offset:2048
    ds_read_b64_tr_b16 v[188:189], v236 offset:2048
    v_mfma_f32_16x16x32_bf16 v[40:43], v[168:171], v[192:195], v[40:43]
    v_mfma_f32_16x16x32_bf16 v[60:63], v[172:175], v[192:195], v[60:63]
    ds_read_b128 v[192:195], v240
    v_mfma_f32_16x16x32_bf16 v[4:7], v[160:163], v[196:199], v[4:7]
    v_mfma_f32_16x16x32_bf16 v[24:27], v[164:167], v[196:199], v[24:27]
    s_cmp_eq_u32 s92, 0
    s_cbranch_scc1 L_sk8
    s_add_u32 s88, s82, 4096
    buffer_store_dwordx4 v[136:139], v230, s[44:47], s88 offen sc1
L_sk8:
    s_waitcnt lgkmcnt(1)
    s_add_u32 s77, s98, 32768
    s_add_u32 m0, s76, 2048
    s_nop 0
    buffer_load_dwordx4 v243, s[32:35], s77 offen lds
    buffer_load_dwordx4 v244, s[32:35], s77 offen offset:1024 lds
    v_mfma_f32_16x16x32_bf16 v[44:47], v[168:171], v[196:199], v[44:47]
    v_mfma_f32_16x16x32_bf16 v[64:67], v[172:175], v[196:199], v[64:67]
    ds_read_b128 v[196:199], v240 offset:4096
    v_mfma_f32_16x16x32_bf16 v[8:11], v[160:163], v[200:203], v[8:11]
    s_cmp_eq_u32 s92, 0
    s_cbranch_scc1 L_sk9
    ds_write_b128 v229, v[108:111] offset:49152
L_sk9:
    v_mfma_f32_16x16x32_bf16 v[28:31], v[164:167], v[200:203], v[28:31]
    s_waitcnt vmcnt(8)
    v_mfma_f32_16x16x32_bf16 v[48:51], v[168:171], v[200:203], v[48:51]
    ds_read_b64_tr_b16 v[178:179], v233 offset:4096
    ds_read_b64_tr_b16 v[182:183], v234 offset:4096
    v_mfma_f32_16x16x32_bf16 v[68:71], v[172:175], v[200:203], v[68:71]
    ds_read_b64_tr_b16 v[186:187], v235 offset:4096
    ds_read_b64_tr_b16 v[190:191], v236 offset:4096
    ds_read_b128 v[200:203], v240 offset:8192
    v_mfma_f32_16x16x32_bf16 v[12:15], v[160:163], v[204:207], v[12:15]
    v_mfma_f32_16x16x32_bf16 v[32:35], v[164:167], v[204:207], v[32:35]
    s_cmp_eq_u32 s92, 0
    s_cbranch_scc1 L_sk10
    s_add_u32 s88, s82, 5120
    buffer_store_dwordx4 v[140:143], v230, s[44:47], s88 offen sc1
L_sk10:
    v_mfma_f32_16x16x32_bf16 v[52:55], v[168:171], v[204:207], v[52:55]
    v_mfma_f32_16x16x32_bf16 v[72:75], v[172:175], v[204:207], v[72:75]
    ds_read_b128 v[204:207], v240 offset:12288
    s_waitcnt lgkmcnt(2)
    s_add_u32 s98, s98, 262144
    s_sub_u32 s77, s98, 3670016
    s_cselect_b32 s98, s98, s77
    s_add_u32 s77, s98, 0
    s_add_u32 m0, s76, 4096
    s_nop 0
    buffer_load_dwordx4 v243, s[32:35], s77 offen lds
    buffer_load_dwordx4 v244, s[32:35], s77 offen offset:1024 lds
    v_mfma_f32_16x16x32_bf16 v[16:19], v[160:163], v[208:211], v[16:19]
    v_mfma_f32_16x16x32_bf16 v[36:39], v[164:167], v[208:211], v[36:39]
    v_mfma_f32_16x16x32_bf16 v[56:59], v[168:171], v[208:211], v[56:59]
    s_cmp_eq_u32 s92, 0
    s_cbranch_scc1 L_sk11
    ds_write_b128 v229, v[112:115] offset:53248
L_sk11:
    v_mfma_f32_16x16x32_bf16 v[76:79], v[172:175], v[208:211], v[76:79]
    ds_read_b128 v[208:211], v240 offset:16384
    s_setprio 0
    s_waitcnt vmcnt(8)
    v_mfma_f32_16x16x32_bf16 v[0:3], v[176:179], v[192:195], v[0:3]
    ds_read_b64_tr_b16 v[160:161], v233 offset:6144
    ds_read_b64_tr_b16 v[164:165], v234 offset:6144
    v_mfma_f32_16x16x32_bf16 v[20:23], v[180:183], v[192:195], v[20:23]
    ds_read_b64_tr_b16 v[168:169], v235 offset:6144
    ds_read_b64_tr_b16 v[172:173], v236 offset:6144
    v_mfma_f32_16x16x32_bf16 v[40:43], v[184:187], v[192:195], v[40:43]
    v_mfma_f32_16x16x32_bf16 v[60:63], v[188:191], v[192:195], v[60:63]
    ds_read_b128 v[192:195], v237 offset:20480
    v_mfma_f32_16x16x32_bf16 v[4:7], v[176:179], v[196:199], v[4:7]
    v_mfma_f32_16x16x32_bf16 v[24:27], v[180:183], v[196:199], v[24:27]
    s_cmp_eq_u32 s92, 0
    s_cbranch_scc1 L_sk12
    s_add_u32 s88, s82, 6144
    buffer_store_dwordx4 v[144:147], v230, s[44:47], s88 offen sc1
L_sk12:
    s_waitcnt lgkmcnt(1)
    s_add_u32 s77, s98, 32768
    s_add_u32 m0, s76, 6144
    s_nop 0
    buffer_load_dwordx4 v243, s[32:35], s77 offen lds
    buffer_load_dwordx4 v244, s[32:35], s77 offen offset:1024 lds
    v_mfma_f32_16x16x32_bf16 v[44:47], v[184:187], v[196:199], v[44:47]
    v_mfma_f32_16x16x32_bf16 v[64:67], v[188:191], v[196:199], v[64:67]
    ds_read_b128 v[196:199], v237 offset:24576
    v_mfma_f32_16x16x32_bf16 v[8:11], v[176:179], v[200:203], v[8:11]
    s_cmp_eq_u32 s92, 0
    s_cbranch_scc1 L_sk13
    ds_write_b128 v229, v[116:119] offset:57344
L_sk13:
    v_mfma_f32_16x16x32_bf16 v[28:31], v[180:183], v[200:203], v[28:31]
    s_waitcnt vmcnt(8)
    v_mfma_f32_16x16x32_bf16 v[48:51], v[184:187], v[200:203], v[48:51]
    ds_read_b64_tr_b16 v[162:163], v233 offset:8192
    ds_read_b64_tr_b16 v[166:167], v234 offset:8192
    v_mfma_f32_16x16x32_bf16 v[68:71], v[188:191], v[200:203], v[68:71]
    ds_read_b64_tr_b16 v[170:171], v235 offset:8192
    ds_read_b64_tr_b16 v[174:175], v236 offset:8192
    ds_read_b128 v[200:203], v237 offset:28672
    v_mfma_f32_16x16x32_bf16 v[12:15], v[176:179], v[204:207], v[12:15]
    v_mfma_f32_16x16x32_bf16 v[32:35], v[180:183], v[204:207], v[32:35]
    s_cmp_eq_u32 s92, 0
    s_cbranch_scc1 L_sk14
    s_add_u32 s88, s82, 7168
    buffer_store_dwordx4 v[148:151], v230, s[44:47], s88 offen sc1
L_sk14:
    v_mfma_f32_16x16x32_bf16 v[52:55], v[184:187], v[204:207], v[52:55]
    v_mfma_f32_16x16x32_bf16 v[72:75], v[188:191], v[204:207], v[72:75]
    ds_read_b128 v[204:207], v237 offset:32768
    s_waitcnt lgkmcnt(2)
    s_add_u32 s98, s98, 262144
    s_sub_u32 s77, s98, 3670016
    s_cselect_b32 s98, s98, s77
    s_add_u32 s77, s98, 0
    s_add_u32 m0, s76, 8192
    s_nop 0
    buffer_load_dwordx4 v243, s[32:35], s77 offen lds
    buffer_load_dwordx4 v244, s[32:35], s77 offen offset:1024 lds
    v_mfma_f32_16x16x32_bf16 v[16:19], v[176:179], v[208:211], v[16:19]
    v_mfma_f32_16x16x32_bf16 v[36:39], v[180:183], v[208:211], v[36:39]
    v_mfma_f32_16x16x32_bf16 v[56:59], v[184:187], v[208:211], v[56:59]
    v_mfma_f32_16x16x32_bf16 v[76:79], v[188:191], v[208:211], v[76:79]
    ds_read_b128 v[208:211], v237 offset:36864
    s_setprio 3
    s_waitcnt vmcnt(8)
    v_mfma_f32_16x16x32_bf16 v[0:3], v[160:163], v[192:195], v[0:3]
    ds_read_b64_tr_b16 v[176:177], v233
    ds_read_b64_tr_b16 v[180:181], v234
    v_mfma_f32_16x16x32_bf16 v[20:23], v[164:167], v[192:195], v[20:23]
    ds_read_b64_tr_b16 v[184:185], v235
    ds_read_b64_tr_b16 v[188:189], v236
    v_mfma_f32_16x16x32_bf16 v[40:43], v[168:171], v[192:195], v[40:43]
    v_mfma_f32_16x16x32_bf16 v[60:63], v[172:175], v[192:195], v[60:63]
    ds_read_b128 v[192:195], v238 offset:20480
    v_mfma_f32_16x16x32_bf16 v[4:7], v[160:163], v[196:199], v[4:7]
    v_mfma_f32_16x16x32_bf16 v[24:27], v[164:167], v[196:199], v[24:27]
    s_cmp_eq_u32 s92, 0
    s_cbranch_scc1 L_sk15
    s_add_u32 s88, s82, 8192
    buffer_store_dwordx4 v[152:155], v230, s[44:47], s88 offen sc1
L_sk15:
    s_waitcnt lgkmcnt(1)
    s_add_u32 s77, s98, 32768
    s_add_u32 m0, s76, 0
    s_nop 0
    buffer_load_dwordx4 v243, s[32:35], s77 offen lds
    buffer_load_dwordx4 v244, s[32:35], s77 offen offset:1024 lds
    v_mfma_f32_16x16x32_bf16 v[44:47], v[168:171], v[196:199], v[44:47]
    v_mfma_f32_16x16x32_bf16 v[64:67], v[172:175], v[196:199], v[64:67]
    ds_read_b128 v[196:199], v238 offset:24576
    v_mfma_f32_16x16x32_bf16 v[8:11], v[160:163], v[200:203], v[8:11]
    v_mfma_f32_16x16x32_bf16 v[28:31], v[164:167], v[200:203], v[28:31]
    s_waitcnt vmcnt(8)
    v_mfma_f32_16x16x32_bf16 v[48:51], v[168:171], v[200:203], v[48:51]
    ds_read_b64_tr_b16 v[178:179], v233 offset:2048
    ds_read_b64_tr_b16 v[182:183], v234 offset:2048
    v_mfma_f32_16x16x32_bf16 v[68:71], v[172:175], v[200:203], v[68:71]
    ds_read_b64_tr_b16 v[186:187], v235 offset:2048
    ds_read_b64_tr_b16 v[190:191], v236 offset:2048
    ds_read_b128 v[200:203], v238 offset:28672
    v_mfma_f32_16x16x32_bf16 v[12:15], v[160:163], v[204:207], v[12:15]
    v_mfma_f32_16x16x32_bf16 v[32:35], v[164:167], v[204:207], v[32:35]
    s_cmp_eq_u32 s92, 0
    s_cbranch_scc1 L_sk16
    s_add_u32 s88, s82, 9216
    buffer_store_dwordx4 v[156:159], v230, s[44:47], s88 offen sc1
L_sk16:
    v_mfma_f32_16x16x32_bf16 v[52:55], v[168:171], v[204:207], v[52:55]
    v_mfma_f32_16x16x32_bf16 v[72:75], v[172:175], v[204:207], v[72:75]
    ds_read_b128 v[204:207], v238 offset:32768
    s_waitcnt lgkmcnt(2)
    s_add_u32 s98, s98, 262144
    s_sub_u32 s77, s98, 3670016
    s_cselect_b32 s98, s98, s77
    s_add_u32 s77, s98, 0
    s_add_u32 m0, s76, 2048
    s_nop 0
    buffer_load_dwordx4 v243, s[32:35], s77 offen lds
    buffer_load_dwordx4 v244, s[32:35], s77 offen offset:1024 lds
    v_mfma_f32_16x16x32_bf16 v[16:19], v[160:163], v[208:211], v[16:19]
    v_mfma_f32_16x16x32_bf16 v[36:39], v[164:167], v[208:211], v[36:39]
    v_mfma_f32_16x16x32_bf16 v[56:59], v[168:171], v[208:211], v[56:59]
    v_mfma_f32_16x16x32_bf16 v[76:79], v[172:175], v[208:211], v[76:79]
    ds_read_b128 v[208:211], v238 offset:36864
    s_setprio 2
    s_waitcnt vmcnt(8)
    v_mfma_f32_16x16x32_bf16 v[0:3], v[176:179], v[192:195], v[0:3]
    ds_read_b64_tr_b16 v[160:161], v233 offset:4096
    ds_read_b64_tr_b16 v[164:165], v234 offset:4096
    v_mfma_f32_16x16x32_bf16 v[20:23], v[180:183], v[192:195], v[20:23]
    ds_read_b64_tr_b16 v[168:169], v235 offset:4096
    ds_read_b64_tr_b16 v[172:173], v236 offset:4096
    v_mfma_f32_16x16x32_bf16 v[40:43], v[184:187], v[192:195], v[40:43]
    v_mfma_f32_16x16x32_bf16 v[60:63], v[188:191], v[192:195], v[60:63]
    ds_read_b128 v[192:195], v239 offset:20480
    v_mfma_f32_16x16x32_bf16 v[4:7], v[176:179], v[196:199], v[4:7]
    v_mfma_f32_16x16x32_bf16 v[24:27], v[180:183], v[196:199], v[24:27]
    s_waitcnt lgkmcnt(1)
    s_add_u32 s77, s98, 32768
    s_add_u32 m0, s76, 4096
    s_nop 0
    buffer_load_dwordx4 v243, s[32:35], s77 offen lds
    buffer_load_dwordx4 v244, s[32:35], s77 offen offset:1024 lds
    v_mfma_f32_16x16x32_bf16 v[44:47], v[184:187], v[196:199], v[44:47]
    v_mfma_f32_16x16x32_bf16 v[64:67], v[188:191], v[196:199], v[64:67]
    ds_read_b128 v[196:199], v239 offset:24576
    v_mfma_f32_16x16x32_bf16 v[8:11], v[176:179], v[200:203], v[8:11]
    v_mfma_f32_16x16x32_bf16 v[28:31], v[180:183], v[200:203], v[28:31]
    s_waitcnt vmcnt(8)
    v_mfma_f32_16x16x32_bf16 v[48:51], v[184:187], v[200:203], v[48:51]
    ds_read_b64_tr_b16 v[162:163], v233 offset:6144
    ds_read_b64_tr_b16 v[166:167], v234 offset:6144
    v_mfma_f32_16x16x32_bf16 v[68:71], v[188:191], v[200:203], v[68:71]
    ds_read_b64_tr_b16 v[170:171], v235 offset:6144
    ds_read_b64_tr_b16 v[174:175], v236 offset:6144
    ds_read_b128 v[200:203], v239 offset:28672
    v_mfma_f32_16x16x32_bf16 v[12:15], v[176:179], v[204:207], v[12:15]
    v_mfma_f32_16x16x32_bf16 v[32:35], v[180:183], v[204:207], v[32:35]
    v_mfma_f32_16x16x32_bf16 v[52:55], v[184:187], v[204:207], v[52:55]
    v_mfma_f32_16x16x32_bf16 v[72:75], v[188:191], v[204:207], v[72:75]
    ds_read_b128 v[204:207], v239 offset:32768
    s_waitcnt lgkmcnt(2)
    s_add_u32 s98, s98, 262144
    s_sub_u32 s77, s98, 3670016
    s_cselect_b32 s98, s98, s77
    s_add_u32 s77, s98, 0
    s_add_u32 m0, s76, 6144
    s_nop 0
    buffer_load_dwordx4 v243, s[32:35], s77 offen lds
    buffer_load_dwordx4 v244, s[32:35], s77 offen offset:1024 lds
    v_mfma_f32_16x16x32_bf16 v[16:19], v[176:179], v[208:211], v[16:19]
    v_mfma_f32_16x16x32_bf16 v[36:39], v[180:183], v[208:211], v[36:39]
    v_mfma_f32_16x16x32_bf16 v[56:59], v[184:187], v[208:211], v[56:59]
    v_mfma_f32_16x16x32_bf16 v[76:79], v[188:191], v[208:211], v[76:79]
    ds_read_b128 v[208:211], v239 offset:36864
    s_setprio 1
    s_waitcnt vmcnt(8)
    v_mfma_f32_16x16x32_bf16 v[0:3], v[160:163], v[192:195], v[0:3]
    ds_read_b64_tr_b16 v[176:177], v233 offset:8192
    ds_read_b64_tr_b16 v[180:181], v234 offset:8192
    v_mfma_f32_16x16x32_bf16 v[20:23], v[164:167], v[192:195], v[20:23]
    ds_read_b64_tr_b16 v[184:185], v235 offset:8192
    ds_read_b64_tr_b16 v[188:189], v236 offset:8192
    v_mfma_f32_16x16x32_bf16 v[40:43], v[168:171], v[192:195], v[40:43]
    v_mfma_f32_16x16x32_bf16 v[60:63], v[172:175], v[192:195], v[60:63]
    ds_read_b128 v[192:195], v240 offset:20480
    v_mfma_f32_16x16x32_bf16 v[4:7], v[160:163], v[196:199], v[4:7]
    v_mfma_f32_16x16x32_bf16 v[24:27], v[164:167], v[196:199], v[24:27]
    s_waitcnt lgkmcnt(1)
    s_add_u32 s77, s98, 32768
    s_add_u32 m0, s76, 8192
    s_nop 0
    buffer_load_dwordx4 v243, s[32:35], s77 offen lds
    buffer_load_dwordx4 v244, s[32:35], s77 offen offset:1024 lds
    v_mfma_f32_16x16x32_bf16 v[44:47], v[168:171], v[196:199], v[44:47]
    v_mfma_f32_16x16x32_bf16 v[64:67], v[172:175], v[196:199], v[64:67]
    ds_read_b128 v[196:199], v240 offset:24576
    v_mfma_f32_16x16x32_bf16 v[8:11], v[160:163], v[200:203], v[8:11]
    v_mfma_f32_16x16x32_bf16 v[28:31], v[164:167], v[200:203], v[28:31]
    s_waitcnt vmcnt(8)
    v_mfma_f32_16x16x32_bf16 v[48:51], v[168:171], v[200:203], v[48:51]
    ds_read_b64_tr_b16 v[178:179], v233
    ds_read_b64_tr_b16 v[182:183], v234
    v_mfma_f32_16x16x32_bf16 v[68:71], v[172:175], v[200:203], v[68:71]
    ds_read_b64_tr_b16 v[186:187], v235
    ds_read_b64_tr_b16 v[190:191], v236
    ds_read_b128 v[200:203], v240 offset:28672
    v_mfma_f32_16x16x32_bf16 v[12:15], v[160:163], v[204:207], v[12:15]
    v_mfma_f32_16x16x32_bf16 v[32:35], v[164:167], v[204:207], v[32:35]
    v_mfma_f32_16x16x32_bf16 v[52:55], v[168:171], v[204:207], v[52:55]
    v_mfma_f32_16x16x32_bf16 v[72:75], v[172:175], v[204:207], v[72:75]
    ds_read_b128 v[204:207], v240 offset:32768
    s_waitcnt lgkmcnt(2)
    s_add_u32 s98, s98, 262144
    s_sub_u32 s77, s98, 3670016
    s_cselect_b32 s98, s98, s77
    s_add_u32 s77, s98, 0
    s_add_u32 m0, s76, 0
    s_nop 0
    buffer_load_dwordx4 v243, s[32:35], s77 offen lds
    buffer_load_dwordx4 v244, s[32:35], s77 offen offset:1024 lds
    v_mfma_f32_16x16x32_bf16 v[16:19], v[160:163], v[208:211], v[16:19]
    v_mfma_f32_16x16x32_bf16 v[36:39], v[164:167], v[208:211], v[36:39]
    v_mfma_f32_16x16x32_bf16 v[56:59], v[168:171], v[208:211], v[56:59]
    v_mfma_f32_16x16x32_bf16 v[76:79], v[172:175], v[208:211], v[76:79]
    ds_read_b128 v[208:211], v240 offset:36864
    s_setprio 0
    s_waitcnt vmcnt(8)
    s_barrier
    v_mfma_f32_16x16x32_bf16 v[0:3], v[176:179], v[192:195], v[0:3]
    ds_read_b64_tr_b16 v[160:161], v233 offset:2048
    ds_read_b64_tr_b16 v[164:165], v234 offset:2048
    v_mfma_f32_16x16x32_bf16 v[20:23], v[180:183], v[192:195], v[20:23]
    ds_read_b64_tr_b16 v[168:169], v235 offset:2048
    ds_read_b64_tr_b16 v[172:173], v236 offset:2048
    v_mfma_f32_16x16x32_bf16 v[40:43], v[184:187], v[192:195], v[40:43]
    v_mfma_f32_16x16x32_bf16 v[60:63], v[188:191], v[192:195], v[60:63]
    ds_read_b128 v[192:195], v237 offset:40960
    v_mfma_f32_16x16x32_bf16 v[4:7], v[176:179], v[196:199], v[4:7]
    v_mfma_f32_16x16x32_bf16 v[24:27], v[180:183], v[196:199], v[24:27]
    s_waitcnt lgkmcnt(1)
    s_add_u32 s77, s98, 32768
    s_add_u32 m0, s76, 2048
    s_nop 0
    buffer_load_dwordx4 v243, s[32:35], s77 offen lds
    buffer_load_dwordx4 v244, s[32:35], s77 offen offset:1024 lds
    v_mfma_f32_16x16x32_bf16 v[44:47], v[184:187], v[196:199], v[44:47]
    v_mfma_f32_16x16x32_bf16 v[64:67], v[188:191], v[196:199], v[64:67]
    ds_read_b128 v[196:199], v237 offset:45056
    v_mfma_f32_16x16x32_bf16 v[8:11], v[176:179], v[200:203], v[8:11]
    v_mfma_f32_16x16x32_bf16 v[28:31], v[180:183], v[200:203], v[28:31]
    s_waitcnt vmcnt(8)
    v_mfma_f32_16x16x32_bf16 v[48:51], v[184:187], v[200:203], v[48:51]
    ds_read_b64_tr_b16 v[162:163], v233 offset:4096
    ds_read_b64_tr_b16 v[166:167], v234 offset:4096
    v_mfma_f32_16x16x32_bf16 v[68:71], v[188:191], v[200:203], v[68:71]
    ds_read_b64_tr_b16 v[170:171], v235 offset:4096
    ds_read_b64_tr_b16 v[174:175], v236 offset:4096
    ds_read_b128 v[200:203], v237 offset:49152
    v_mfma_f32_16x16x32_bf16 v[12:15], v[176:179], v[204:207], v[12:15]
    v_mfma_f32_16x16x32_bf16 v[32:35], v[180:183], v[204:207], v[32:35]
    v_mfma_f32_16x16x32_bf16 v[52:55], v[184:187], v[204:207], v[52:55]
    v_mfma_f32_16x16x32_bf16 v[72:75], v[188:191], v[204:207], v[72:75]
    ds_read_b128 v[204:207], v237 offset:53248
    s_waitcnt lgkmcnt(2)
    s_add_u32 s98, s98, 262144
    s_sub_u32 s77, s98, 3670016
    s_cselect_b32 s98, s98, s77
    s_add_u32 s77, s98, 0
    s_add_u32 m0, s76, 4096
    s_nop 0
    buffer_load_dwordx4 v243, s[32:35], s77 offen lds
    buffer_load_dwordx4 v244, s[32:35], s77 offen offset:1024 lds
    v_mfma_f32_16x16x32_bf16 v[16:19], v[176:179], v[208:211], v[16:19]
    v_mfma_f32_16x16x32_bf16 v[36:39], v[180:183], v[208:211], v[36:39]
    v_mfma_f32_16x16x32_bf16 v[56:59], v[184:187], v[208:211], v[56:59]
    v_mfma_f32_16x16x32_bf16 v[76:79], v[188:191], v[208:211], v[76:79]
    ds_read_b128 v[208:211], v237 offset:57344
    s_setprio 3
    s_waitcnt vmcnt(8)
    v_mfma_f32_16x16x32_bf16 v[0:3], v[160:163], v[192:195], v[0:3]
    ds_read_b64_tr_b16 v[176:177], v233 offset:6144
    ds_read_b64_tr_b16 v[180:181], v234 offset:6144
    v_mfma_f32_16x16x32_bf16 v[20:23], v[164:167], v[192:195], v[20:23]
    ds_read_b64_tr_b16 v[184:185], v235 offset:6144
    ds_read_b64_tr_b16 v[188:189], v236 offset:6144
    v_mfma_f32_16x16x32_bf16 v[40:43], v[168:171], v[192:195], v[40:43]
    v_mfma_f32_16x16x32_bf16 v[60:63], v[172:175], v[192:195], v[60:63]
    ds_read_b128 v[192:195], v238 offset:40960
    v_mfma_f32_16x16x32_bf16 v[4:7], v[160:163], v[196:199], v[4:7]
    v_mfma_f32_16x16x32_bf16 v[24:27], v[164:167], v[196:199], v[24:27]
    s_waitcnt lgkmcnt(1)
    s_add_u32 s77, s98, 32768
    s_add_u32 m0, s76, 6144
    s_nop 0
    buffer_load_dwordx4 v243, s[32:35], s77 offen lds
    buffer_load_dwordx4 v244, s[32:35], s77 offen offset:1024 lds
    v_mfma_f32_16x16x32_bf16 v[44:47], v[168:171], v[196:199], v[44:47]
    v_mfma_f32_16x16x32_bf16 v[64:67], v[172:175], v[196:199], v[64:67]
    ds_read_b128 v[196:199], v238 offset:45056
    v_mfma_f32_16x16x32_bf16 v[8:11], v[160:163], v[200:203], v[8:11]
    v_mfma_f32_16x16x32_bf16 v[28:31], v[164:167], v[200:203], v[28:31]
    s_waitcnt vmcnt(8)
    v_mfma_f32_16x16x32_bf16 v[48:51], v[168:171], v[200:203], v[48:51]
    ds_read_b64_tr_b16 v[178:179], v233 offset:8192
    ds_read_b64_tr_b16 v[182:183], v234 offset:8192
    v_mfma_f32_16x16x32_bf16 v[68:71], v[172:175], v[200:203], v[68:71]
    ds_read_b64_tr_b16 v[186:187], v235 offset:8192
    ds_read_b64_tr_b16 v[190:191], v236 offset:8192
    ds_read_b128 v[200:203], v238 offset:49152
    v_mfma_f32_16x16x32_bf16 v[12:15], v[160:163], v[204:207], v[12:15]
    v_mfma_f32_16x16x32_bf16 v[32:35], v[164:167], v[204:207], v[32:35]
    v_mfma_f32_16x16x32_bf16 v[52:55], v[168:171], v[204:207], v[52:55]
    v_mfma_f32_16x16x32_bf16 v[72:75], v[172:175], v[204:207], v[72:75]
    ds_read_b128 v[204:207], v238 offset:53248
    s_waitcnt lgkmcnt(2)
    s_add_u32 s98, s98, 262144
    s_sub_u32 s77, s98, 3670016
    s_cselect_b32 s98, s98, s77
    s_add_u32 s77, s98, 0
    s_add_u32 m0, s76, 8192
    s_nop 0
    buffer_load_dwordx4 v243, s[32:35], s77 offen lds
    buffer_load_dwordx4 v244, s[32:35], s77 offen offset:1024 lds
    v_mfma_f32_16x16x32_bf16 v[16:19], v[160:163], v[208:211], v[16:19]
    v_mfma_f32_16x16x32_bf16 v[36:39], v[164:167], v[208:211], v[36:39]
    v_mfma_f32_16x16x32_bf16 v[56:59], v[168:171], v[208:211], v[56:59]
    v_mfma_f32_16x16x32_bf16 v[76:79], v[172:175], v[208:211], v[76:79]
    ds_read_b128 v[208:211], v238 offset:57344
    s_setprio 2
    s_waitcnt vmcnt(8)
    v_mfma_f32_16x16x32_bf16 v[0:3], v[176:179], v[192:195], v[0:3]
    ds_read_b64_tr_b16 v[160:161], v233
    ds_read_b64_tr_b16 v[164:165], v234
    v_mfma_f32_16x16x32_bf16 v[20:23], v[180:183], v[192:195], v[20:23]
    ds_read_b64_tr_b16 v[168:169], v235
    ds_read_b64_tr_b16 v[172:173], v236
    v_mfma_f32_16x16x32_bf16 v[40:43], v[184:187], v[192:195], v[40:43]
    v_mfma_f32_16x16x32_bf16 v[60:63], v[188:191], v[192:195], v[60:63]
    ds_read_b128 v[192:195], v239 offset:40960
    v_mfma_f32_16x16x32_bf16 v[4:7], v[176:179], v[196:199], v[4:7]
    v_mfma_f32_16x16x32_bf16 v[24:27], v[180:183], v[196:199], v[24:27]
    s_waitcnt lgkmcnt(1)
    s_add_u32 s77, s98, 32768
    s_add_u32 m0, s76, 0
    s_nop 0
    buffer_load_dwordx4 v243, s[32:35], s77 offen lds
    buffer_load_dwordx4 v244, s[32:35], s77 offen offset:1024 lds
    v_mfma_f32_16x16x32_bf16 v[44:47], v[184:187], v[196:199], v[44:47]
    v_mfma_f32_16x16x32_bf16 v[64:67], v[188:191], v[196:199], v[64:67]
    ds_read_b128 v[196:199], v239 offset:45056
    v_mfma_f32_16x16x32_bf16 v[8:11], v[176:179], v[200:203], v[8:11]
    v_mfma_f32_16x16x32_bf16 v[28:31], v[180:183], v[200:203], v[28:31]
    s_waitcnt vmcnt(8)
    v_mfma_f32_16x16x32_bf16 v[48:51], v[184:187], v[200:203], v[48:51]
    ds_read_b64_tr_b16 v[162:163], v233 offset:2048
    ds_read_b64_tr_b16 v[166:167], v234 offset:2048
    v_mfma_f32_16x16x32_bf16 v[68:71], v[188:191], v[200:203], v[68:71]
    ds_read_b64_tr_b16 v[170:171], v235 offset:2048
    ds_read_b64_tr_b16 v[174:175], v236 offset:2048
    ds_read_b128 v[200:203], v239 offset:49152
    v_mfma_f32_16x16x32_bf16 v[12:15], v[176:179], v[204:207], v[12:15]
    v_mfma_f32_16x16x32_bf16 v[32:35], v[180:183], v[204:207], v[32:35]
    v_mfma_f32_16x16x32_bf16 v[52:55], v[184:187], v[204:207], v[52:55]
    v_mfma_f32_16x16x32_bf16 v[72:75], v[188:191], v[204:207], v[72:75]
    ds_read_b128 v[204:207], v239 offset:53248
    s_waitcnt lgkmcnt(2)
    s_add_u32 s98, s98, 262144
    s_sub_u32 s77, s98, 3670016
    s_cselect_b32 s98, s98, s77
    s_add_u32 s77, s98, 0
    s_add_u32 m0, s76, 2048
    s_nop 0
    buffer_load_dwordx4 v243, s[32:35], s77 offen lds
    buffer_load_dwordx4 v244, s[32:35], s77 offen offset:1024 lds
    v_mfma_f32_16x16x32_bf16 v[16:19], v[176:179], v[208:211], v[16:19]
    v_mfma_f32_16x16x32_bf16 v[36:39], v[180:183], v[208:211], v[36:39]
    v_mfma_f32_16x16x32_bf16 v[56:59], v[184:187], v[208:211], v[56:59]
    v_mfma_f32_16x16x32_bf16 v[76:79], v[188:191], v[208:211], v[76:79]
    ds_read_b128 v[208:211], v239 offset:57344
    s_setprio 1
    s_waitcnt vmcnt(8)
    v_mfma_f32_16x16x32_bf16 v[0:3], v[160:163], v[192:195], v[0:3]
    ds_read_b64_tr_b16 v[176:177], v233 offset:4096
    ds_read_b64_tr_b16 v[180:181], v234 offset:4096
    v_mfma_f32_16x16x32_bf16 v[20:23], v[164:167], v[192:195], v[20:23]
    ds_read_b64_tr_b16 v[184:185], v235 offset:4096
    ds_read_b64_tr_b16 v[188:189], v236 offset:4096
    ds_read_b128 v[80:83], v242
    v_mfma_f32_16x16x32_bf16 v[40:43], v[168:171], v[192:195], v[40:43]
    v_mfma_f32_16x16x32_bf16 v[60:63], v[172:175], v[192:195], v[60:63]
    ds_read_b128 v[192:195], v240 offset:40960
    v_mfma_f32_16x16x32_bf16 v[4:7], v[160:163], v[196:199], v[4:7]
    v_mfma_f32_16x16x32_bf16 v[24:27], v[164:167], v[196:199], v[24:27]
    ds_read_b128 v[84:87], v242 offset:4096
    s_waitcnt lgkmcnt(3)
    s_add_u32 s77, s98, 32768
    s_add_u32 m0, s76, 4096
    s_nop 0
    buffer_load_dwordx4 v243, s[32:35], s77 offen lds
    buffer_load_dwordx4 v244, s[32:35], s77 offen offset:1024 lds
    s_mov_b64 s[28:29], s[36:37]
    s_mov_b32 s30, s38
    s_mov_b64 s[32:33], s[40:41]
    s_mov_b32 s34, s42
    s_mov_b32 s38, 0
    s_mov_b32 s42, 0
    v_mfma_f32_16x16x32_bf16 v[44:47], v[168:171], v[196:199], v[44:47]
    v_mfma_f32_16x16x32_bf16 v[64:67], v[172:175], v[196:199], v[64:67]
    ds_read_b128 v[196:199], v240 offset:45056
    v_mfma_f32_16x16x32_bf16 v[8:11], v[160:163], v[200:203], v[8:11]
    v_mfma_f32_16x16x32_bf16 v[28:31], v[164:167], v[200:203], v[28:31]
    ds_read_b128 v[88:91], v242 offset:8192
    s_waitcnt vmcnt(8)
    v_mfma_f32_16x16x32_bf16 v[48:51], v[168:171], v[200:203], v[48:51]
    ds_read_b64_tr_b16 v[178:179], v233 offset:6144
    ds_read_b64_tr_b16 v[182:183], v234 offset:6144
    v_mfma_f32_16x16x32_bf16 v[68:71], v[172:175], v[200:203], v[68:71]
    ds_read_b64_tr_b16 v[186:187], v235 offset:6144
    ds_read_b64_tr_b16 v[190:191], v236 offset:6144
    ds_read_b128 v[200:203], v240 offset:49152
    v_mfma_f32_16x16x32_bf16 v[12:15], v[160:163], v[204:207], v[12:15]
    v_mfma_f32_16x16x32_bf16 v[32:35], v[164:167], v[204:207], v[32:35]
    ds_read_b128 v[92:95], v242 offset:12288
    v_mfma_f32_16x16x32_bf16 v[52:55], v[168:171], v[204:207], v[52:55]
    v_mfma_f32_16x16x32_bf16 v[72:75], v[172:175], v[204:207], v[72:75]
    ds_read_b128 v[204:207], v240 offset:53248
    s_waitcnt lgkmcnt(3)
    s_add_u32 s77, s95, 16384
    s_add_u32 m0, s76, 6144
    s_nop 0
    buffer_load_dwordx4 v218, s[48:51], s77 offen nt lds
    buffer_load_dwordx4 v219, s[48:51], s77 offen offset:1024 nt lds
    v_mfma_f32_16x16x32_bf16 v[16:19], v[160:163], v[208:211], v[16:19]
    v_mfma_f32_16x16x32_bf16 v[36:39], v[164:167], v[208:211], v[36:39]
    ds_read_b128 v[96:99], v242 offset:16384
    v_mfma_f32_16x16x32_bf16 v[56:59], v[168:171], v[208:211], v[56:59]
    v_mfma_f32_16x16x32_bf16 v[76:79], v[172:175], v[208:211], v[76:79]
    ds_read_b128 v[208:211], v240 offset:57344
    s_setprio 0
    s_waitcnt vmcnt(8)
    v_mfma_f32_16x16x32_bf16 v[0:3], v[176:179], v[192:195], v[0:3]
    ds_read_b64_tr_b16 v[160:161], v233 offset:8192
    ds_read_b64_tr_b16 v[164:165], v234 offset:8192
    v_mfma_f32_16x16x32_bf16 v[20:23], v[180:183], v[192:195], v[20:23]
    ds_read_b64_tr_b16 v[168:169], v235 offset:8192
    ds_read_b64_tr_b16 v[172:173], v236 offset:8192
    v_mfma_f32_16x16x32_bf16 v[40:43], v[184:187], v[192:195], v[40:43]
    v_mfma_f32_16x16x32_bf16 v[60:63], v[188:191], v[192:195], v[60:63]
    ds_read_b128 v[192:195], v241
    v_mfma_f32_16x16x32_bf16 v[4:7], v[176:179], v[196:199], v[4:7]
    v_mfma_f32_16x16x32_bf16 v[24:27], v[180:183], v[196:199], v[24:27]
    s_waitcnt lgkmcnt(1)
    s_add_u32 s77, s96, 0
    s_add_u32 m0, s76, 8192
    s_nop 0
    buffer_load_dwordx4 v218, s[48:51], s77 offen nt lds
    buffer_load_dwordx4 v219, s[48:51], s77 offen offset:1024 nt lds
    v_mfma_f32_16x16x32_bf16 v[44:47], v[184:187], v[196:199], v[44:47]
    v_mfma_f32_16x16x32_bf16 v[64:67], v[188:191], v[196:199], v[64:67]
    ds_read_b128 v[196:199], v241 offset:4096
    v_mfma_f32_16x16x32_bf16 v[8:11], v[176:179], v[200:203], v[8:11]
    v_mfma_f32_16x16x32_bf16 v[28:31], v[180:183], v[200:203], v[28:31]
    s_waitcnt vmcnt(8)
    v_mfma_f32_16x16x32_bf16 v[48:51], v[184:187], v[200:203], v[48:51]
    ds_read_b64_tr_b16 v[162:163], v233
    ds_read_b64_tr_b16 v[166:167], v234
    v_mfma_f32_16x16x32_bf16 v[68:71], v[188:191], v[200:203], v[68:71]
    ds_read_b64_tr_b16 v[170:171], v235
    ds_read_b64_tr_b16 v[174:175], v236
    ds_read_b128 v[200:203], v241 offset:8192
    v_mfma_f32_16x16x32_bf16 v[12:15], v[176:179], v[204:207], v[12:15]
    v_mfma_f32_16x16x32_bf16 v[32:35], v[180:183], v[204:207], v[32:35]
    v_mfma_f32_16x16x32_bf16 v[52:55], v[184:187], v[204:207], v[52:55]
    v_mfma_f32_16x16x32_bf16 v[72:75], v[188:191], v[204:207], v[72:75]
    ds_read_b128 v[204:207], v241 offset:12288
    s_waitcnt lgkmcnt(2)
    s_add_u32 s77, s94, 0
    s_add_u32 m0, s76, 0
    s_nop 0
    buffer_load_dwordx4 v218, s[48:51], s77 offen nt lds
    buffer_load_dwordx4 v219, s[48:51], s77 offen offset:1024 nt lds
    v_mfma_f32_16x16x32_bf16 v[16:19], v[176:179], v[208:211], v[16:19]
    v_mfma_f32_16x16x32_bf16 v[36:39], v[180:183], v[208:211], v[36:39]
    v_mfma_f32_16x16x32_bf16 v[56:59], v[184:187], v[208:211], v[56:59]
    v_mfma_f32_16x16x32_bf16 v[76:79], v[188:191], v[208:211], v[76:79]
    ds_read_b128 v[208:211], v241 offset:16384
    s_setprio 3
    s_waitcnt vmcnt(8)
    v_mfma_f32_16x16x32_bf16 v[0:3], v[160:163], v[192:195], v[0:3]
    ds_read_b64_tr_b16 v[176:177], v233 offset:2048
    ds_read_b64_tr_b16 v[180:181], v234 offset:2048
    v_mfma_f32_16x16x32_bf16 v[20:23], v[164:167], v[192:195], v[20:23]
    ds_read_b64_tr_b16 v[184:185], v235 offset:2048
    ds_read_b64_tr_b16 v[188:189], v236 offset:2048
    s_waitcnt vmcnt(6)
    v_mfma_f32_16x16x32_bf16 v[40:43], v[168:171], v[192:195], v[40:43]
    ds_read_b64_tr_b16 v[178:179], v233 offset:4096
    ds_read_b64_tr_b16 v[182:183], v234 offset:4096
    v_mfma_f32_16x16x32_bf16 v[60:63], v[172:175], v[192:195], v[60:63]
    ds_read_b64_tr_b16 v[186:187], v235 offset:4096
    ds_read_b64_tr_b16 v[190:191], v236 offset:4096
    v_mfma_f32_16x16x32_bf16 v[4:7], v[160:163], v[196:199], v[4:7]
    v_mfma_f32_16x16x32_bf16 v[24:27], v[164:167], v[196:199], v[24:27]
    v_mfma_f32_16x16x32_bf16 v[44:47], v[168:171], v[196:199], v[44:47]
    v_mfma_f32_16x16x32_bf16 v[64:67], v[172:175], v[196:199], v[64:67]
    s_waitcnt lgkmcnt(0)
    s_barrier
    v_mfma_f32_16x16x32_bf16 v[0:3], v[176:179], v[80:83], v[0:3]
    s_add_u32 s77, s94, 16384
    s_add_u32 m0, s76, 2048
    s_nop 0
    buffer_load_dwordx4 v218, s[48:51], s77 offen nt lds
    buffer_load_dwordx4 v219, s[48:51], s77 offen offset:1024 nt lds
    v_mfma_f32_16x16x32_bf16 v[20:23], v[180:183], v[80:83], v[20:23]
    s_add_u32 s77, s95, 0
    s_add_u32 m0, s76, 4096
    s_nop 0
    buffer_load_dwordx4 v218, s[48:51], s77 offen nt lds
    buffer_load_dwordx4 v219, s[48:51], s77 offen offset:1024 nt lds
    v_mfma_f32_16x16x32_bf16 v[40:43], v[184:187], v[80:83], v[40:43]
    s_mul_i32 s88, s94, 80
    v_add_u32 v225, s88, v224
    v_subrev_u32 v216, s93, v216
    v_subrev_u32 v217, s93, v217
    v_mfma_f32_16x16x32_bf16 v[60:63], v[188:191], v[80:83], v[60:63]
    v_mfma_f32_16x16x32_bf16 v[8:11], v[160:163], v[200:203], v[8:11]
    v_mfma_f32_16x16x32_bf16 v[28:31], v[164:167], v[200:203], v[28:31]
    v_mfma_f32_16x16x32_bf16 v[48:51], v[168:171], v[200:203], v[48:51]
    v_cvt_pk_bf16_f32 v0, v0, v1
    v_cvt_pk_bf16_f32 v1, v2, v3
    v_cvt_pk_bf16_f32 v2, v20, v21
    v_mfma_f32_16x16x32_bf16 v[68:71], v[172:175], v[200:203], v[68:71]
    v_cvt_pk_bf16_f32 v3, v22, v23
    v_cvt_pk_bf16_f32 v40, v40, v41
    v_cvt_pk_bf16_f32 v41, v42, v43
    v_mfma_f32_16x16x32_bf16 v[4:7], v[176:179], v[84:87], v[4:7]
    v_cvt_pk_bf16_f32 v42, v60, v61
    v_cvt_pk_bf16_f32 v43, v62, v63
    v_permlane16_swap_b32 v0, v2
    v_mfma_f32_16x16x32_bf16 v[24:27], v[180:183], v[84:87], v[24:27]
    v_permlane16_swap_b32 v1, v3
    v_permlane16_swap_b32 v40, v42
    v_permlane16_swap_b32 v41, v43
    v_mfma_f32_16x16x32_bf16 v[44:47], v[184:187], v[84:87], v[44:47]
    ds_write_b128 v231, v[0:3]
    ds_write_b128 v231, v[40:43] offset:5120
    v_mfma_f32_16x16x32_bf16 v[64:67], v[188:191], v[84:87], v[64:67]
    s_setprio 2
    v_mfma_f32_16x16x32_bf16 v[12:15], v[160:163], v[204:207], v[12:15]
    v_mfma_f32_16x16x32_bf16 v[32:35], v[164:167], v[204:207], v[32:35]
    v_mfma_f32_16x16x32_bf16 v[52:55], v[168:171], v[204:207], v[52:55]
    v_cvt_pk_bf16_f32 v4, v4, v5
    v_cvt_pk_bf16_f32 v5, v6, v7
    v_cvt_pk_bf16_f32 v6, v24, v25
    v_mfma_f32_16x16x32_bf16 v[72:75], v[172:175], v[204:207], v[72:75]
    v_cvt_pk_bf16_f32 v7, v26, v27
    v_cvt_pk_bf16_f32 v44, v44, v45
    v_cvt_pk_bf16_f32 v45, v46, v47
    v_mfma_f32_16x16x32_bf16 v[8:11], v[176:179], v[88:91], v[8:11]
    v_cvt_pk_bf16_f32 v46, v64, v65
    v_cvt_pk_bf16_f32 v47, v66, v67
    v_permlane16_swap_b32 v4, v6
    v_mfma_f32_16x16x32_bf16 v[28:31], v[180:183], v[88:91], v[28:31]
    v_permlane16_swap_b32 v5, v7
    v_permlane16_swap_b32 v44, v46
    v_permlane16_swap_b32 v45, v47
    v_mfma_f32_16x16x32_bf16 v[48:51], v[184:187], v[88:91], v[48:51]
    ds_write_b128 v231, v[4:7] offset:1024
    ds_write_b128 v231, v[44:47] offset:6144
    v_mfma_f32_16x16x32_bf16 v[68:71], v[188:191], v[88:91], v[68:71]
    v_mfma_f32_16x16x32_bf16 v[16:19], v[160:163], v[208:211], v[16:19]
    v_mfma_f32_16x16x32_bf16 v[36:39], v[164:167], v[208:211], v[36:39]
    v_mfma_f32_16x16x32_bf16 v[56:59], v[168:171], v[208:211], v[56:59]
    v_cvt_pk_bf16_f32 v8, v8, v9
    v_cvt_pk_bf16_f32 v9, v10, v11
    v_cvt_pk_bf16_f32 v10, v28, v29
    v_mfma_f32_16x16x32_bf16 v[76:79], v[172:175], v[208:211], v[76:79]
    v_cvt_pk_bf16_f32 v11, v30, v31
    v_cvt_pk_bf16_f32 v48, v48, v49
    v_cvt_pk_bf16_f32 v49, v50, v51
    v_mfma_f32_16x16x32_bf16 v[12:15], v[176:179], v[92:95], v[12:15]
    v_cvt_pk_bf16_f32 v50, v68, v69
    v_cvt_pk_bf16_f32 v51, v70, v71
    v_permlane16_swap_b32 v8, v10
    v_mfma_f32_16x16x32_bf16 v[32:35], v[180:183], v[92:95], v[32:35]
    v_permlane16_swap_b32 v9, v11
    v_permlane16_swap_b32 v48, v50
    v_permlane16_swap_b32 v49, v51
    v_mfma_f32_16x16x32_bf16 v[52:55], v[184:187], v[92:95], v[52:55]
    ds_write_b128 v231, v[8:11] offset:2048
    ds_write_b128 v231, v[48:51] offset:7168
    v_mfma_f32_16x16x32_bf16 v[72:75], v[188:191], v[92:95], v[72:75]
    v_mfma_f32_16x16x32_bf16 v[16:19], v[176:179], v[96:99], v[16:19]
    v_mfma_f32_16x16x32_bf16 v[36:39], v[180:183], v[96:99], v[36:39]
    v_mfma_f32_16x16x32_bf16 v[56:59], v[184:187], v[96:99], v[56:59]
    v_cvt_pk_bf16_f32 v12, v12, v13
    v_cvt_pk_bf16_f32 v13, v14, v15
    v_cvt_pk_bf16_f32 v14, v32, v33
    v_mfma_f32_16x16x32_bf16 v[76:79], v[188:191], v[96:99], v[76:79]
    v_cvt_pk_bf16_f32 v15, v34, v35
    v_cvt_pk_bf16_f32 v52, v52, v53
    v_cvt_pk_bf16_f32 v53, v54, v55
    v_cvt_pk_bf16_f32 v54, v72, v73
    v_cvt_pk_bf16_f32 v55, v74, v75
    v_permlane16_swap_b32 v12, v14
    v_permlane16_swap_b32 v13, v15
    v_permlane16_swap_b32 v52, v54
    v_permlane16_swap_b32 v53, v55
    ds_write_b128 v231, v[12:15] offset:3072
    ds_write_b128 v231, v[52:55] offset:8192
    v_cvt_pk_bf16_f32 v16, v16, v17
    v_cvt_pk_bf16_f32 v17, v18, v19
    v_cvt_pk_bf16_f32 v18, v36, v37
    v_cvt_pk_bf16_f32 v19, v38, v39
    v_cvt_pk_bf16_f32 v56, v56, v57
    v_cvt_pk_bf16_f32 v57, v58, v59
    v_cvt_pk_bf16_f32 v58, v76, v77
    v_cvt_pk_bf16_f32 v59, v78, v79
    v_permlane16_swap_b32 v16, v18
    v_permlane16_swap_b32 v17, v19
    v_permlane16_swap_b32 v56, v58
    v_permlane16_swap_b32 v57, v59
    ds_write_b128 v231, v[16:19] offset:4096
    ds_write_b128 v231, v[56:59] offset:9216
    s_setprio 0
    s_waitcnt vmcnt(4)
    s_waitcnt lgkmcnt(0)
    s_barrier
    ds_read_b128 v[200:203], v216
    ds_read_b128 v[204:207], v217
    ds_read_b128 v[160:163], v225
    ds_read_b128 v[164:167], v225 offset:1024
    ds_read_b128 v[168:171], v225 offset:2048
    ds_read_b128 v[172:175], v225 offset:3072
    ds_read_b128 v[176:179], v225 offset:4096
    ds_read_b128 v[180:183], v225 offset:5120
    ds_read_b128 v[184:187], v225 offset:6144
    ds_read_b128 v[188:191], v225 offset:7168
    ds_read_b128 v[192:195], v225 offset:8192
    ds_read_b128 v[196:199], v225 offset:9216
    s_waitcnt lgkmcnt(9)
    v_mfma_f32_16x16x32_bf16 v[0:3], v[200:203], v[160:163], 0
    ds_read_b128 v[208:211], v216 offset:40960
    s_waitcnt lgkmcnt(9)
    v_mfma_f32_16x16x32_bf16 v[4:7], v[200:203], v[164:167], 0
    ds_read_b128 v[212:215], v217 offset:40960
    s_waitcnt lgkmcnt(9)
    v_mfma_f32_16x16x32_bf16 v[8:11], v[200:203], v[168:171], 0
    s_waitcnt lgkmcnt(8)
    v_mfma_f32_16x16x32_bf16 v[12:15], v[200:203], v[172:175], 0
    s_waitcnt lgkmcnt(7)
    v_mfma_f32_16x16x32_bf16 v[16:19], v[200:203], v[176:179], 0
    s_waitcnt lgkmcnt(6)
    v_mfma_f32_16x16x32_bf16 v[0:3], v[204:207], v[180:183], v[0:3]
    s_waitcnt lgkmcnt(5)
    v_mfma_f32_16x16x32_bf16 v[4:7], v[204:207], v[184:187], v[4:7]
    s_waitcnt lgkmcnt(4)
    v_mfma_f32_16x16x32_bf16 v[8:11], v[204:207], v[188:191], v[8:11]
    s_waitcnt lgkmcnt(3)
    v_mfma_f32_16x16x32_bf16 v[12:15], v[204:207], v[192:195], v[12:15]
    s_waitcnt lgkmcnt(2)
    v_mfma_f32_16x16x32_bf16 v[16:19], v[204:207], v[196:199], v[16:19]
    s_waitcnt vmcnt(2)
    s_waitcnt lgkmcnt(0)
    s_barrier
    v_mfma_f32_16x16x32_bf16 v[20:23], v[208:211], v[160:163], 0
    ds_read_b128 v[200:203], v216 offset:2048
    v_mfma_f32_16x16x32_bf16 v[24:27], v[208:211], v[164:167], 0
    ds_read_b128 v[204:207], v217 offset:2048
    v_mfma_f32_16x16x32_bf16 v[28:31], v[208:211], v[168:171], 0
    s_add_u32 s77, s96, 16384
    s_add_u32 m0, s76, 0
    s_nop 0
    buffer_load_dwordx4 v218, s[48:51], s77 offen nt lds
    buffer_load_dwordx4 v219, s[48:51], s77 offen offset:1024 nt lds
    v_mfma_f32_16x16x32_bf16 v[32:35], v[208:211], v[172:175], 0
    v_mfma_f32_16x16x32_bf16 v[36:39], v[208:211], v[176:179], 0
    v_mfma_f32_16x16x32_bf16 v[20:23], v[212:215], v[180:183], v[20:23]
    v_mfma_f32_16x16x32_bf16 v[24:27], v[212:215], v[184:187], v[24:27]
    v_mfma_f32_16x16x32_bf16 v[28:31], v[212:215], v[188:191], v[28:31]
    v_mfma_f32_16x16x32_bf16 v[32:35], v[212:215], v[192:195], v[32:35]
    v_mfma_f32_16x16x32_bf16 v[36:39], v[212:215], v[196:199], v[36:39]
    s_waitcnt lgkmcnt(1)
    v_mfma_f32_16x16x32_bf16 v[40:43], v[200:203], v[160:163], 0
    ds_read_b128 v[208:211], v216 offset:43008
    v_mfma_f32_16x16x32_bf16 v[44:47], v[200:203], v[164:167], 0
    ds_read_b128 v[212:215], v217 offset:43008
    v_mfma_f32_16x16x32_bf16 v[48:51], v[200:203], v[168:171], 0
    v_mfma_f32_16x16x32_bf16 v[52:55], v[200:203], v[172:175], 0
    v_mfma_f32_16x16x32_bf16 v[56:59], v[200:203], v[176:179], 0
    s_waitcnt lgkmcnt(2)
    v_mfma_f32_16x16x32_bf16 v[40:43], v[204:207], v[180:183], v[40:43]
    v_mfma_f32_16x16x32_bf16 v[44:47], v[204:207], v[184:187], v[44:47]
    v_mfma_f32_16x16x32_bf16 v[48:51], v[204:207], v[188:191], v[48:51]
    v_mfma_f32_16x16x32_bf16 v[52:55], v[204:207], v[192:195], v[52:55]
    v_mfma_f32_16x16x32_bf16 v[56:59], v[204:207], v[196:199], v[56:59]
    s_mul_i32 s88, s95, 80
    v_add_u32 v225, s88, v224
    s_waitcnt vmcnt(2)
    s_waitcnt lgkmcnt(0)
    s_barrier
    v_mfma_f32_16x16x32_bf16 v[60:63], v[208:211], v[160:163], 0
    ds_read_b128 v[200:203], v216 offset:4096
    ds_read_b128 v[160:163], v225
    v_mfma_f32_16x16x32_bf16 v[64:67], v[208:211], v[164:167], 0
    ds_read_b128 v[204:207], v217 offset:4096
    ds_read_b128 v[164:167], v225 offset:1024
    v_mfma_f32_16x16x32_bf16 v[68:71], v[208:211], v[168:171], 0
    ds_read_b128 v[168:171], v225 offset:2048
    s_add_u32 s77, s97, 0
    s_add_u32 m0, s76, 2048
    s_nop 0
    buffer_load_dwordx4 v218, s[48:51], s77 offen nt lds
    buffer_load_dwordx4 v219, s[48:51], s77 offen offset:1024 nt lds
    v_mfma_f32_16x16x32_bf16 v[72:75], v[208:211], v[172:175], 0
    ds_read_b128 v[172:175], v225 offset:3072
    v_mfma_f32_16x16x32_bf16 v[76:79], v[208:211], v[176:179], 0
    ds_read_b128 v[176:179], v225 offset:4096
    v_mfma_f32_16x16x32_bf16 v[60:63], v[212:215], v[180:183], v[60:63]
    ds_read_b128 v[180:183], v225 offset:5120
    v_mfma_f32_16x16x32_bf16 v[64:67], v[212:215], v[184:187], v[64:67]
    ds_read_b128 v[184:187], v225 offset:6144
    v_mfma_f32_16x16x32_bf16 v[68:71], v[212:215], v[188:191], v[68:71]
    ds_read_b128 v[188:191], v225 offset:7168
    v_mfma_f32_16x16x32_bf16 v[72:75], v[212:215], v[192:195], v[72:75]
    ds_read_b128 v[192:195], v225 offset:8192
    v_mfma_f32_16x16x32_bf16 v[76:79], v[212:215], v[196:199], v[76:79]
    ds_read_b128 v[196:199], v225 offset:9216
    s_waitcnt lgkmcnt(10)
    v_mfma_f32_16x16x32_bf16 v[0:3], v[200:203], v[160:163], v[0:3]
    ds_read_b128 v[208:211], v216 offset:45056
    s_waitcnt lgkmcnt(9)
    v_mfma_f32_16x16x32_bf16 v[4:7], v[200:203], v[164:167], v[4:7]
    ds_read_b128 v[212:215], v217 offset:45056
    s_waitcnt lgkmcnt(9)
    v_mfma_f32_16x16x32_bf16 v[8:11], v[200:203], v[168:171], v[8:11]
    s_waitcnt lgkmcnt(8)
    v_mfma_f32_16x16x32_bf16 v[12:15], v[200:203], v[172:175], v[12:15]
    s_waitcnt lgkmcnt(7)
    v_mfma_f32_16x16x32_bf16 v[16:19], v[200:203], v[176:179], v[16:19]
    s_waitcnt lgkmcnt(6)
    v_mfma_f32_16x16x32_bf16 v[0:3], v[204:207], v[180:183], v[0:3]
    s_waitcnt lgkmcnt(5)
    v_mfma_f32_16x16x32_bf16 v[4:7], v[204:207], v[184:187], v[4:7]
    s_waitcnt lgkmcnt(4)
    v_mfma_f32_16x16x32_bf16 v[8:11], v[204:207], v[188:191], v[8:11]
    s_waitcnt lgkmcnt(3)
    v_mfma_f32_16x16x32_bf16 v[12:15], v[204:207], v[192:195], v[12:15]
    s_waitcnt lgkmcnt(2)
    v_mfma_f32_16x16x32_bf16 v[16:19], v[204:207], v[196:199], v[16:19]
    s_waitcnt lgkmcnt(0)
    s_barrier
    v_mfma_f32_16x16x32_bf16 v[20:23], v[208:211], v[160:163], v[20:23]
    ds_read_b128 v[200:203], v216 offset:6144
    v_mfma_f32_16x16x32_bf16 v[24:27], v[208:211], v[164:167], v[24:27]
    ds_read_b128 v[204:207], v217 offset:6144
    v_mfma_f32_16x16x32_bf16 v[28:31], v[208:211], v[168:171], v[28:31]
    s_add_u32 s77, s97, 16384
    s_add_u32 m0, s76, 4096
    s_nop 0
    buffer_load_dwordx4 v218, s[48:51], s77 offen nt lds
    buffer_load_dwordx4 v219, s[48:51], s77 offen offset:1024 nt lds
    v_mfma_f32_16x16x32_bf16 v[32:35], v[208:211], v[172:175], v[32:35]
    v_mfma_f32_16x16x32_bf16 v[36:39], v[208:211], v[176:179], v[36:39]
    v_mfma_f32_16x16x32_bf16 v[20:23], v[212:215], v[180:183], v[20:23]
    v_mfma_f32_16x16x32_bf16 v[24:27], v[212:215], v[184:187], v[24:27]
    v_mfma_f32_16x16x32_bf16 v[28:31], v[212:215], v[188:191], v[28:31]
    v_mfma_f32_16x16x32_bf16 v[32:35], v[212:215], v[192:195], v[32:35]
    v_mfma_f32_16x16x32_bf16 v[36:39], v[212:215], v[196:199], v[36:39]
    s_waitcnt lgkmcnt(1)
    v_mfma_f32_16x16x32_bf16 v[40:43], v[200:203], v[160:163], v[40:43]
    ds_read_b128 v[208:211], v216 offset:47104
    v_mfma_f32_16x16x32_bf16 v[44:47], v[200:203], v[164:167], v[44:47]
    ds_read_b128 v[212:215], v217 offset:47104
    v_mfma_f32_16x16x32_bf16 v[48:51], v[200:203], v[168:171], v[48:51]
    v_mfma_f32_16x16x32_bf16 v[52:55], v[200:203], v[172:175], v[52:55]
    v_mfma_f32_16x16x32_bf16 v[56:59], v[200:203], v[176:179], v[56:59]
    s_waitcnt lgkmcnt(2)
    v_mfma_f32_16x16x32_bf16 v[40:43], v[204:207], v[180:183], v[40:43]
    v_mfma_f32_16x16x32_bf16 v[44:47], v[204:207], v[184:187], v[44:47]
    v_mfma_f32_16x16x32_bf16 v[48:51], v[204:207], v[188:191], v[48:51]
    v_mfma_f32_16x16x32_bf16 v[52:55], v[204:207], v[192:195], v[52:55]
    v_mfma_f32_16x16x32_bf16 v[56:59], v[204:207], v[196:199], v[56:59]
    s_mul_i32 s88, s96, 80
    v_add_u32 v225, s88, v224
    s_waitcnt lgkmcnt(0)
    s_barrier
    v_mfma_f32_16x16x32_bf16 v[60:63], v[208:211], v[160:163], v[60:63]
    ds_read_b128 v[200:203], v216 offset:8192
    ds_read_b128 v[160:163], v225
    v_mfma_f32_16x16x32_bf16 v[64:67], v[208:211], v[164:167], v[64:67]
    ds_read_b128 v[204:207], v217 offset:8192
    ds_read_b128 v[164:167], v225 offset:1024
    v_mfma_f32_16x16x32_bf16 v[68:71], v[208:211], v[168:171], v[68:71]
    ds_read_b128 v[168:171], v225 offset:2048
    s_add_u32 s77, s94, 32768
    s_add_u32 m0, s76, 6144
    s_nop 0
    buffer_load_dwordx4 v218, s[48:51], s77 offen nt lds
    buffer_load_dwordx4 v219, s[48:51], s77 offen offset:1024 nt lds
    v_mfma_f32_16x16x32_bf16 v[72:75], v[208:211], v[172:175], v[72:75]
    ds_read_b128 v[172:175], v225 offset:3072
    v_mfma_f32_16x16x32_bf16 v[76:79], v[208:211], v[176:179], v[76:79]
    ds_read_b128 v[176:179], v225 offset:4096
    v_mfma_f32_16x16x32_bf16 v[60:63], v[212:215], v[180:183], v[60:63]
    ds_read_b128 v[180:183], v225 offset:5120
    v_mfma_f32_16x16x32_bf16 v[64:67], v[212:215], v[184:187], v[64:67]
    ds_read_b128 v[184:187], v225 offset:6144
    v_mfma_f32_16x16x32_bf16 v[68:71], v[212:215], v[188:191], v[68:71]
    ds_read_b128 v[188:191], v225 offset:7168
    v_mfma_f32_16x16x32_bf16 v[72:75], v[212:215], v[192:195], v[72:75]
    ds_read_b128 v[192:195], v225 offset:8192
    v_mfma_f32_16x16x32_bf16 v[76:79], v[212:215], v[196:199], v[76:79]
    ds_read_b128 v[196:199], v225 offset:9216
    s_waitcnt lgkmcnt(10)
    v_mfma_f32_16x16x32_bf16 v[0:3], v[200:203], v[160:163], v[0:3]
    ds_read_b128 v[208:211], v216 offset:49152
    s_waitcnt lgkmcnt(9)
    v_mfma_f32_16x16x32_bf16 v[4:7], v[200:203], v[164:167], v[4:7]
    ds_read_b128 v[212:215], v217 offset:49152
    s_waitcnt lgkmcnt(9)
    v_mfma_f32_16x16x32_bf16 v[8:11], v[200:203], v[168:171], v[8:11]
    s_waitcnt lgkmcnt(8)
    v_mfma_f32_16x16x32_bf16 v[12:15], v[200:203], v[172:175], v[12:15]
    s_waitcnt lgkmcnt(7)
    v_mfma_f32_16x16x32_bf16 v[16:19], v[200:203], v[176:179], v[16:19]
    s_waitcnt lgkmcnt(6)
    v_mfma_f32_16x16x32_bf16 v[0:3], v[204:207], v[180:183], v[0:3]
    s_waitcnt lgkmcnt(5)
    v_mfma_f32_16x16x32_bf16 v[4:7], v[204:207], v[184:187], v[4:7]
    s_waitcnt lgkmcnt(4)
    v_mfma_f32_16x16x32_bf16 v[8:11], v[204:207], v[188:191], v[8:11]
    s_waitcnt lgkmcnt(3)
    v_mfma_f32_16x16x32_bf16 v[12:15], v[204:207], v[192:195], v[12:15]
    s_waitcnt lgkmcnt(2)
    v_mfma_f32_16x16x32_bf16 v[16:19], v[204:207], v[196:199], v[16:19]
    s_waitcnt vmcnt(6)
    s_waitcnt lgkmcnt(0)
    s_barrier
    v_mfma_f32_16x16x32_bf16 v[20:23], v[208:211], v[160:163], v[20:23]
    ds_read_b128 v[200:203], v216
    v_mfma_f32_16x16x32_bf16 v[24:27], v[208:211], v[164:167], v[24:27]
    ds_read_b128 v[204:207], v217
    v_mfma_f32_16x16x32_bf16 v[28:31], v[208:211], v[168:171], v[28:31]
    s_add_u32 s77, s94, 49152
    s_add_u32 m0, s76, 8192
    s_nop 0
    buffer_load_dwordx4 v218, s[48:51], s77 offen nt lds
    buffer_load_dwordx4 v219, s[48:51], s77 offen offset:1024 nt lds
    v_mfma_f32_16x16x32_bf16 v[32:35], v[208:211], v[172:175], v[32:35]
    v_mfma_f32_16x16x32_bf16 v[36:39], v[208:211], v[176:179], v[36:39]
    v_mfma_f32_16x16x32_bf16 v[20:23], v[212:215], v[180:183], v[20:23]
    v_mfma_f32_16x16x32_bf16 v[24:27], v[212:215], v[184:187], v[24:27]
    v_mfma_f32_16x16x32_bf16 v[28:31], v[212:215], v[188:191], v[28:31]
    v_mfma_f32_16x16x32_bf16 v[32:35], v[212:215], v[192:195], v[32:35]
    v_mfma_f32_16x16x32_bf16 v[36:39], v[212:215], v[196:199], v[36:39]
    s_waitcnt lgkmcnt(1)
    v_mfma_f32_16x16x32_bf16 v[40:43], v[200:203], v[160:163], v[40:43]
    ds_read_b128 v[208:211], v216 offset:40960
    v_mfma_f32_16x16x32_bf16 v[44:47], v[200:203], v[164:167], v[44:47]
    ds_read_b128 v[212:215], v217 offset:40960
    v_mfma_f32_16x16x32_bf16 v[48:51], v[200:203], v[168:171], v[48:51]
    v_mfma_f32_16x16x32_bf16 v[52:55], v[200:203], v[172:175], v[52:55]
    v_mfma_f32_16x16x32_bf16 v[56:59], v[200:203], v[176:179], v[56:59]
    s_waitcnt lgkmcnt(2)
    v_mfma_f32_16x16x32_bf16 v[40:43], v[204:207], v[180:183], v[40:43]
    v_mfma_f32_16x16x32_bf16 v[44:47], v[204:207], v[184:187], v[44:47]
    v_mfma_f32_16x16x32_bf16 v[48:51], v[204:207], v[188:191], v[48:51]
    v_mfma_f32_16x16x32_bf16 v[52:55], v[204:207], v[192:195], v[52:55]
    v_mfma_f32_16x16x32_bf16 v[56:59], v[204:207], v[196:199], v[56:59]
    s_mul_i32 s88, s97, 80
    v_add_u32 v225, s88, v224
    s_waitcnt vmcnt(6)
    s_waitcnt lgkmcnt(0)
    s_barrier
    v_mfma_f32_16x16x32_bf16 v[60:63], v[208:211], v[160:163], v[60:63]
    ds_read_b128 v[200:203], v216 offset:2048
    ds_read_b128 v[160:163], v225
    v_mfma_f32_16x16x32_bf16 v[64:67], v[208:211], v[164:167], v[64:67]
    ds_read_b128 v[204:207], v217 offset:2048
    ds_read_b128 v[164:167], v225 offset:1024
    v_mfma_f32_16x16x32_bf16 v[68:71], v[208:211], v[168:171], v[68:71]
    ds_read_b128 v[168:171], v225 offset:2048
    s_add_u32 s77, s95, 32768
    s_add_u32 m0, s76, 0
    s_nop 0
    buffer_load_dwordx4 v218, s[48:51], s77 offen nt lds
    buffer_load_dwordx4 v219, s[48:51], s77 offen offset:1024 nt lds
    v_mfma_f32_16x16x32_bf16 v[72:75], v[208:211], v[172:175], v[72:75]
    ds_read_b128 v[172:175], v225 offset:3072
    v_mfma_f32_16x16x32_bf16 v[76:79], v[208:211], v[176:179], v[76:79]
    ds_read_b128 v[176:179], v225 offset:4096
    v_mfma_f32_16x16x32_bf16 v[60:63], v[212:215], v[180:183], v[60:63]
    ds_read_b128 v[180:183], v225 offset:5120
    v_mfma_f32_16x16x32_bf16 v[64:67], v[212:215], v[184:187], v[64:67]
    ds_read_b128 v[184:187], v225 offset:6144
    v_mfma_f32_16x16x32_bf16 v[68:71], v[212:215], v[188:191], v[68:71]
    ds_read_b128 v[188:191], v225 offset:7168
    v_mfma_f32_16x16x32_bf16 v[72:75], v[212:215], v[192:195], v[72:75]
    ds_read_b128 v[192:195], v225 offset:8192
    v_mfma_f32_16x16x32_bf16 v[76:79], v[212:215], v[196:199], v[76:79]
    ds_read_b128 v[196:199], v225 offset:9216
    s_waitcnt lgkmcnt(10)
    v_mfma_f32_16x16x32_bf16 v[0:3], v[200:203], v[160:163], v[0:3]
    ds_read_b128 v[208:211], v216 offset:43008
    s_waitcnt lgkmcnt(9)
    v_mfma_f32_16x16x32_bf16 v[4:7], v[200:203], v[164:167], v[4:7]
    ds_read_b128 v[212:215], v217 offset:43008
    s_waitcnt lgkmcnt(9)
    v_mfma_f32_16x16x32_bf16 v[8:11], v[200:203], v[168:171], v[8:11]
    s_waitcnt lgkmcnt(8)
    v_mfma_f32_16x16x32_bf16 v[12:15], v[200:203], v[172:175], v[12:15]
    s_waitcnt lgkmcnt(7)
    v_mfma_f32_16x16x32_bf16 v[16:19], v[200:203], v[176:179], v[16:19]
    s_waitcnt lgkmcnt(6)
    v_mfma_f32_16x16x32_bf16 v[0:3], v[204:207], v[180:183], v[0:3]
    s_waitcnt lgkmcnt(5)
    v_mfma_f32_16x16x32_bf16 v[4:7], v[204:207], v[184:187], v[4:7]
    s_waitcnt lgkmcnt(4)
    v_mfma_f32_16x16x32_bf16 v[8:11], v[204:207], v[188:191], v[8:11]
    s_waitcnt lgkmcnt(3)
    v_mfma_f32_16x16x32_bf16 v[12:15], v[204:207], v[192:195], v[12:15]
    s_waitcnt lgkmcnt(2)
    v_mfma_f32_16x16x32_bf16 v[16:19], v[204:207], v[196:199], v[16:19]
    s_waitcnt vmcnt(6)
    s_waitcnt lgkmcnt(0)
    s_barrier
    v_mfma_f32_16x16x32_bf16 v[20:23], v[208:211], v[160:163], v[20:23]
    ds_read_b128 v[200:203], v216 offset:4096
    v_mfma_f32_16x16x32_bf16 v[24:27], v[208:211], v[164:167], v[24:27]
    ds_read_b128 v[204:207], v217 offset:4096
    v_mfma_f32_16x16x32_bf16 v[28:31], v[208:211], v[168:171], v[28:31]
    s_add_u32 s77, s95, 49152
    s_add_u32 m0, s76, 2048
    s_nop 0
    buffer_load_dwordx4 v218, s[48:51], s77 offen nt lds
    buffer_load_dwordx4 v219, s[48:51], s77 offen offset:1024 nt lds
    v_mfma_f32_16x16x32_bf16 v[32:35], v[208:211], v[172:175], v[32:35]
    v_mfma_f32_16x16x32_bf16 v[36:39], v[208:211], v[176:179], v[36:39]
    v_max3_f32 v248, v0, v1, v2
    v_max_f32 v248, v248, v3
    v_mfma_f32_16x16x32_bf16 v[20:23], v[212:215], v[180:183], v[20:23]
    v_max3_f32 v249, v4, v5, v6
    v_max_f32 v249, v249, v7
    v_mfma_f32_16x16x32_bf16 v[24:27], v[212:215], v[184:187], v[24:27]
    v_max3_f32 v250, v8, v9, v10
    v_max_f32 v250, v250, v11
    v_mfma_f32_16x16x32_bf16 v[28:31], v[212:215], v[188:191], v[28:31]
    v_max3_f32 v251, v12, v13, v14
    v_max_f32 v251, v251, v15
    v_mfma_f32_16x16x32_bf16 v[32:35], v[212:215], v[192:195], v[32:35]
    v_max3_f32 v252, v16, v17, v18
    v_max_f32 v252, v252, v19
    v_mfma_f32_16x16x32_bf16 v[36:39], v[212:215], v[196:199], v[36:39]
    s_waitcnt lgkmcnt(1)
    v_mfma_f32_16x16x32_bf16 v[40:43], v[200:203], v[160:163], v[40:43]
    ds_read_b128 v[208:211], v216 offset:45056
    v_mfma_f32_16x16x32_bf16 v[44:47], v[200:203], v[164:167], v[44:47]
    ds_read_b128 v[212:215], v217 offset:45056
    v_mfma_f32_16x16x32_bf16 v[48:51], v[200:203], v[168:171], v[48:51]
    v_mfma_f32_16x16x32_bf16 v[52:55], v[200:203], v[172:175], v[52:55]
    v_mfma_f32_16x16x32_bf16 v[56:59], v[200:203], v[176:179], v[56:59]
    v_max3_f32 v248, v248, v20, v21
    v_max3_f32 v248, v248, v22, v23
    s_waitcnt lgkmcnt(2)
    v_mfma_f32_16x16x32_bf16 v[40:43], v[204:207], v[180:183], v[40:43]
    v_max3_f32 v249, v249, v24, v25
    v_max3_f32 v249, v249, v26, v27
    v_mfma_f32_16x16x32_bf16 v[44:47], v[204:207], v[184:187], v[44:47]
    v_max3_f32 v250, v250, v28, v29
    v_max3_f32 v250, v250, v30, v31
    v_mfma_f32_16x16x32_bf16 v[48:51], v[204:207], v[188:191], v[48:51]
    v_max3_f32 v251, v251, v32, v33
    v_max3_f32 v251, v251, v34, v35
    v_mfma_f32_16x16x32_bf16 v[52:55], v[204:207], v[192:195], v[52:55]
    v_max3_f32 v252, v252, v36, v37
    v_max3_f32 v252, v252, v38, v39
    v_mfma_f32_16x16x32_bf16 v[56:59], v[204:207], v[196:199], v[56:59]
    s_mul_i32 s88, s94, 80
    v_add_u32 v225, s88, v224
    s_waitcnt vmcnt(6)
    s_waitcnt lgkmcnt(0)
    s_barrier
    v_mfma_f32_16x16x32_bf16 v[60:63], v[208:211], v[160:163], v[60:63]
    ds_read_b128 v[200:203], v216 offset:6144
    ds_read_b128 v[160:163], v225
    v_mfma_f32_16x16x32_bf16 v[64:67], v[208:211], v[164:167], v[64:67]
    ds_read_b128 v[204:207], v217 offset:6144
    ds_read_b128 v[164:167], v225 offset:1024
    v_mfma_f32_16x16x32_bf16 v[68:71], v[208:211], v[168:171], v[68:71]
    ds_read_b128 v[168:171], v225 offset:2048
    s_add_u32 s77, s96, 32768
    s_add_u32 m0, s76, 4096
    s_nop 0
    buffer_load_dwordx4 v218, s[48:51], s77 offen nt lds
    buffer_load_dwordx4 v219, s[48:51], s77 offen offset:1024 nt lds
    v_mfma_f32_16x16x32_bf16 v[72:75], v[208:211], v[172:175], v[72:75]
    ds_read_b128 v[172:175], v225 offset:3072
    v_mfma_f32_16x16x32_bf16 v[76:79], v[208:211], v[176:179], v[76:79]
    ds_read_b128 v[176:179], v225 offset:4096
    v_max3_f32 v248, v248, v40, v41
    v_max3_f32 v248, v248, v42, v43
    v_mfma_f32_16x16x32_bf16 v[60:63], v[212:215], v[180:183], v[60:63]
    ds_read_b128 v[180:183], v225 offset:5120
    v_max3_f32 v249, v249, v44, v45
    v_max3_f32 v249, v249, v46, v47
    v_mfma_f32_16x16x32_bf16 v[64:67], v[212:215], v[184:187], v[64:67]
    ds_read_b128 v[184:187], v225 offset:6144
    v_max3_f32 v250, v250, v48, v49
    v_max3_f32 v250, v250, v50, v51
    v_mfma_f32_16x16x32_bf16 v[68:71], v[212:215], v[188:191], v[68:71]
    ds_read_b128 v[188:191], v225 offset:7168
    v_max3_f32 v251, v251, v52, v53
    v_max3_f32 v251, v251, v54, v55
    v_mfma_f32_16x16x32_bf16 v[72:75], v[212:215], v[192:195], v[72:75]
    ds_read_b128 v[192:195], v225 offset:8192
    v_max3_f32 v252, v252, v56, v57
    v_max3_f32 v252, v252, v58, v59
    v_mfma_f32_16x16x32_bf16 v[76:79], v[212:215], v[196:199], v[76:79]
    ds_read_b128 v[196:199], v225 offset:9216
    s_waitcnt lgkmcnt(10)
    v_mfma_f32_16x16x32_bf16 v[80:83], v[200:203], v[160:163], 0
    ds_read_b128 v[208:211], v216 offset:47104
    s_waitcnt lgkmcnt(9)
    v_mfma_f32_16x16x32_bf16 v[84:87], v[200:203], v[164:167], 0
    ds_read_b128 v[212:215], v217 offset:47104
    s_waitcnt lgkmcnt(9)
    v_mfma_f32_16x16x32_bf16 v[88:91], v[200:203], v[168:171], 0
    s_waitcnt lgkmcnt(8)
    v_mfma_f32_16x16x32_bf16 v[92:95], v[200:203], v[172:175], 0
    s_waitcnt lgkmcnt(7)
    v_mfma_f32_16x16x32_bf16 v[96:99], v[200:203], v[176:179], 0
    v_max3_f32 v248, v248, v60, v61
    v_max3_f32 v248, v248, v62, v63
    s_waitcnt lgkmcnt(6)
    v_mfma_f32_16x16x32_bf16 v[80:83], v[204:207], v[180:183], v[80:83]
    v_max3_f32 v249, v249, v64, v65
    v_max3_f32 v249, v249, v66, v67
    s_waitcnt lgkmcnt(5)
    v_mfma_f32_16x16x32_bf16 v[84:87], v[204:207], v[184:187], v[84:87]
    v_max3_f32 v250, v250, v68, v69
    v_max3_f32 v250, v250, v70, v71
    s_waitcnt lgkmcnt(4)
    v_mfma_f32_16x16x32_bf16 v[88:91], v[204:207], v[188:191], v[88:91]
    v_max3_f32 v251, v251, v72, v73
    v_max3_f32 v251, v251, v74, v75
    s_waitcnt lgkmcnt(3)
    v_mfma_f32_16x16x32_bf16 v[92:95], v[204:207], v[192:195], v[92:95]
    v_max3_f32 v252, v252, v76, v77
    v_max3_f32 v252, v252, v78, v79
    s_waitcnt lgkmcnt(2)
    v_mfma_f32_16x16x32_bf16 v[96:99], v[204:207], v[196:199], v[96:99]
    v_mov_b32 v240, v248
    v_mov_b32 v241, v249
    s_waitcnt vmcnt(6)
    s_waitcnt lgkmcnt(0)
    s_barrier
    v_mfma_f32_16x16x32_bf16 v[100:103], v[208:211], v[160:163], 0
    ds_read_b128 v[200:203], v216 offset:8192
    v_mov_b32 v242, v250
    v_mov_b32 v244, v251
    v_mfma_f32_16x16x32_bf16 v[104:107], v[208:211], v[164:167], 0
    ds_read_b128 v[204:207], v217 offset:8192
    v_mov_b32 v246, v252
    v_permlane32_swap_b32 v248, v240
    v_mfma_f32_16x16x32_bf16 v[108:111], v[208:211], v[168:171], 0
    s_add_u32 s77, s96, 49152
    s_add_u32 m0, s76, 6144
    s_nop 0
    buffer_load_dwordx4 v218, s[48:51], s77 offen nt lds
    buffer_load_dwordx4 v219, s[48:51], s77 offen offset:1024 nt lds
    v_permlane32_swap_b32 v249, v241
    v_permlane32_swap_b32 v250, v242
    v_mfma_f32_16x16x32_bf16 v[112:115], v[208:211], v[172:175], 0
    v_permlane32_swap_b32 v251, v244
    v_permlane32_swap_b32 v252, v246
    v_mfma_f32_16x16x32_bf16 v[116:119], v[208:211], v[176:179], 0
    v_max_f32 v248, v248, v240
    v_max_f32 v249, v249, v241
    v_mfma_f32_16x16x32_bf16 v[100:103], v[212:215], v[180:183], v[100:103]
    v_max_f32 v250, v250, v242
    v_max_f32 v251, v251, v244
    v_mfma_f32_16x16x32_bf16 v[104:107], v[212:215], v[184:187], v[104:107]
    v_max_f32 v252, v252, v246
    v_mov_b32 v240, v248
    v_mfma_f32_16x16x32_bf16 v[108:111], v[212:215], v[188:191], v[108:111]
    v_mov_b32 v241, v249
    v_mov_b32 v242, v250
    v_mfma_f32_16x16x32_bf16 v[112:115], v[212:215], v[192:195], v[112:115]
    v_mov_b32 v244, v251
    v_mov_b32 v246, v252
    v_mfma_f32_16x16x32_bf16 v[116:119], v[212:215], v[196:199], v[116:119]
    v_permlane16_swap_b32 v248, v240
    v_permlane16_swap_b32 v249, v241
    s_waitcnt lgkmcnt(1)
    v_mfma_f32_16x16x32_bf16 v[120:123], v[200:203], v[160:163], 0
    ds_read_b128 v[208:211], v216 offset:49152
    v_permlane16_swap_b32 v250, v242
    v_permlane16_swap_b32 v251, v244
    v_mfma_f32_16x16x32_bf16 v[124:127], v[200:203], v[164:167], 0
    ds_read_b128 v[212:215], v217 offset:49152
    v_permlane16_swap_b32 v252, v246
    v_max_f32 v248, v248, v240
    v_mfma_f32_16x16x32_bf16 v[128:131], v[200:203], v[168:171], 0
    v_max_f32 v249, v249, v241
    v_max_f32 v250, v250, v242
    v_mfma_f32_16x16x32_bf16 v[132:135], v[200:203], v[172:175], 0
    v_max_f32 v251, v251, v244
    v_max_f32 v252, v252, v246
    v_mfma_f32_16x16x32_bf16 v[136:139], v[200:203], v[176:179], 0
    v_mul_f32 v234, s80, v248
    v_mul_f32 v235, s80, v249
    s_waitcnt lgkmcnt(2)
    v_mfma_f32_16x16x32_bf16 v[120:123], v[204:207], v[180:183], v[120:123]
    v_mul_f32 v236, s80, v250
    v_mul_f32 v238, s80, v251
    v_mfma_f32_16x16x32_bf16 v[124:127], v[204:207], v[184:187], v[124:127]
    v_mul_f32 v239, s80, v252
    v_fma_f32 v0, v0, s78, v234
    v_mfma_f32_16x16x32_bf16 v[128:131], v[204:207], v[188:191], v[128:131]
    v_fma_f32 v1, v1, s78, v234
    v_fma_f32 v2, v2, s78, v234
    v_mfma_f32_16x16x32_bf16 v[132:135], v[204:207], v[192:195], v[132:135]
    v_fma_f32 v3, v3, s78, v234
    v_exp_f32 v0, v0
    v_mfma_f32_16x16x32_bf16 v[136:139], v[204:207], v[196:199], v[136:139]
    s_mul_i32 s88, s95, 80
    v_add_u32 v225, s88, v224
    v_exp_f32 v1, v1
    v_exp_f32 v2, v2
    s_waitcnt vmcnt(6)
    s_waitcnt lgkmcnt(0)
    s_barrier
    v_mfma_f32_16x16x32_bf16 v[140:143], v[208:211], v[160:163], 0
    ds_read_b128 v[200:203], v216
    ds_read_b128 v[160:163], v225
    v_exp_f32 v3, v3
    v_add_f32 v240, v0, v1
    v_mfma_f32_16x16x32_bf16 v[144:147], v[208:211], v[164:167], 0
    ds_read_b128 v[204:207], v217
    ds_read_b128 v[164:167], v225 offset:1024
    v_add_f32 v240, v240, v2
    v_add_f32 v240, v240, v3
    v_mfma_f32_16x16x32_bf16 v[148:151], v[208:211], v[168:171], 0
    ds_read_b128 v[168:171], v225 offset:2048
    s_add_u32 s77, s97, 32768
    s_add_u32 m0, s76, 8192
    s_nop 0
    buffer_load_dwordx4 v218, s[48:51], s77 offen nt lds
    buffer_load_dwordx4 v219, s[48:51], s77 offen offset:1024 nt lds
    v_fma_f32 v4, v4, s78, v235
    v_fma_f32 v5, v5, s78, v235
    v_mfma_f32_16x16x32_bf16 v[152:155], v[208:211], v[172:175], 0
    ds_read_b128 v[172:175], v225 offset:3072
    v_fma_f32 v6, v6, s78, v235
    v_fma_f32 v7, v7, s78, v235
    v_mfma_f32_16x16x32_bf16 v[156:159], v[208:211], v[176:179], 0
    ds_read_b128 v[176:179], v225 offset:4096
    v_exp_f32 v4, v4
    v_exp_f32 v5, v5
    v_mfma_f32_16x16x32_bf16 v[140:143], v[212:215], v[180:183], v[140:143]
    ds_read_b128 v[180:183], v225 offset:5120
    v_exp_f32 v6, v6
    v_exp_f32 v7, v7
    v_mfma_f32_16x16x32_bf16 v[144:147], v[212:215], v[184:187], v[144:147]
    ds_read_b128 v[184:187], v225 offset:6144
    v_add_f32 v241, v4, v5
    v_add_f32 v241, v241, v6
    v_mfma_f32_16x16x32_bf16 v[148:151], v[212:215], v[188:191], v[148:151]
    ds_read_b128 v[188:191], v225 offset:7168
    v_add_f32 v241, v241, v7
    v_fma_f32 v8, v8, s78, v236
    v_mfma_f32_16x16x32_bf16 v[152:155], v[212:215], v[192:195], v[152:155]
    ds_read_b128 v[192:195], v225 offset:8192
    v_fma_f32 v9, v9, s78, v236
    v_fma_f32 v10, v10, s78, v236
    v_mfma_f32_16x16x32_bf16 v[156:159], v[212:215], v[196:199], v[156:159]
    ds_read_b128 v[196:199], v225 offset:9216
    v_fma_f32 v11, v11, s78, v236
    v_exp_f32 v8, v8
    s_waitcnt lgkmcnt(10)
    v_mfma_f32_16x16x32_bf16 v[80:83], v[200:203], v[160:163], v[80:83]
    ds_read_b128 v[208:211], v216 offset:40960
    v_exp_f32 v9, v9
    v_exp_f32 v10, v10
    s_waitcnt lgkmcnt(9)
    v_mfma_f32_16x16x32_bf16 v[84:87], v[200:203], v[164:167], v[84:87]
    ds_read_b128 v[212:215], v217 offset:40960
    v_exp_f32 v11, v11
    v_add_f32 v242, v8, v9
    s_waitcnt lgkmcnt(9)
    v_mfma_f32_16x16x32_bf16 v[88:91], v[200:203], v[168:171], v[88:91]
    v_add_f32 v242, v242, v10
    v_add_f32 v242, v242, v11
    s_waitcnt lgkmcnt(8)
    v_mfma_f32_16x16x32_bf16 v[92:95], v[200:203], v[172:175], v[92:95]
    v_fma_f32 v12, v12, s78, v238
    v_fma_f32 v13, v13, s78, v238
    s_waitcnt lgkmcnt(7)
    v_mfma_f32_16x16x32_bf16 v[96:99], v[200:203], v[176:179], v[96:99]
    v_fma_f32 v14, v14, s78, v238
    v_fma_f32 v15, v15, s78, v238
    s_waitcnt lgkmcnt(6)
    v_mfma_f32_16x16x32_bf16 v[80:83], v[204:207], v[180:183], v[80:83]
    v_exp_f32 v12, v12
    v_exp_f32 v13, v13
    s_waitcnt lgkmcnt(5)
    v_mfma_f32_16x16x32_bf16 v[84:87], v[204:207], v[184:187], v[84:87]
    v_exp_f32 v14, v14
    v_exp_f32 v15, v15
    s_waitcnt lgkmcnt(4)
    v_mfma_f32_16x16x32_bf16 v[88:91], v[204:207], v[188:191], v[88:91]
    v_add_f32 v244, v12, v13
    v_add_f32 v244, v244, v14
    s_waitcnt lgkmcnt(3)
    v_mfma_f32_16x16x32_bf16 v[92:95], v[204:207], v[192:195], v[92:95]
    v_add_f32 v244, v244, v15
    v_fma_f32 v16, v16, s78, v239
    s_waitcnt lgkmcnt(2)
    v_mfma_f32_16x16x32_bf16 v[96:99], v[204:207], v[196:199], v[96:99]
    v_fma_f32 v17, v17, s78, v239
    v_fma_f32 v18, v18, s78, v239
    s_waitcnt vmcnt(6)
    s_waitcnt lgkmcnt(0)
    s_barrier
    v_mfma_f32_16x16x32_bf16 v[100:103], v[208:211], v[160:163], v[100:103]
    ds_read_b128 v[200:203], v216 offset:2048
    v_fma_f32 v19, v19, s78, v239
    v_exp_f32 v16, v16
    v_mfma_f32_16x16x32_bf16 v[104:107], v[208:211], v[164:167], v[104:107]
    ds_read_b128 v[204:207], v217 offset:2048
    v_exp_f32 v17, v17
    v_exp_f32 v18, v18
    v_mfma_f32_16x16x32_bf16 v[108:111], v[208:211], v[168:171], v[108:111]
    s_add_u32 s77, s97, 49152
    s_add_u32 m0, s76, 0
    s_nop 0
    buffer_load_dwordx4 v218, s[48:51], s77 offen nt lds
    buffer_load_dwordx4 v219, s[48:51], s77 offen offset:1024 nt lds
    v_exp_f32 v19, v19
    v_add_f32 v246, v16, v17
    v_mfma_f32_16x16x32_bf16 v[112:115], v[208:211], v[172:175], v[112:115]
    v_add_f32 v246, v246, v18
    v_add_f32 v246, v246, v19
    v_mfma_f32_16x16x32_bf16 v[116:119], v[208:211], v[176:179], v[116:119]
    v_fma_f32 v20, v20, s78, v234
    v_fma_f32 v21, v21, s78, v234
    v_mfma_f32_16x16x32_bf16 v[100:103], v[212:215], v[180:183], v[100:103]
    v_fma_f32 v22, v22, s78, v234
    v_fma_f32 v23, v23, s78, v234
    v_mfma_f32_16x16x32_bf16 v[104:107], v[212:215], v[184:187], v[104:107]
    v_exp_f32 v20, v20
    v_exp_f32 v21, v21
    v_mfma_f32_16x16x32_bf16 v[108:111], v[212:215], v[188:191], v[108:111]
    v_exp_f32 v22, v22
    v_exp_f32 v23, v23
    v_mfma_f32_16x16x32_bf16 v[112:115], v[212:215], v[192:195], v[112:115]
    v_add_f32 v240, v240, v20
    v_add_f32 v240, v240, v21
    v_mfma_f32_16x16x32_bf16 v[116:119], v[212:215], v[196:199], v[116:119]
    v_add_f32 v240, v240, v22
    v_add_f32 v240, v240, v23
    s_waitcnt lgkmcnt(1)
    v_mfma_f32_16x16x32_bf16 v[120:123], v[200:203], v[160:163], v[120:123]
    ds_read_b128 v[208:211], v216 offset:43008
    v_fma_f32 v24, v24, s78, v235
    v_fma_f32 v25, v25, s78, v235
    v_mfma_f32_16x16x32_bf16 v[124:127], v[200:203], v[164:167], v[124:127]
    ds_read_b128 v[212:215], v217 offset:43008
    v_fma_f32 v26, v26, s78, v235
    v_fma_f32 v27, v27, s78, v235
    v_mfma_f32_16x16x32_bf16 v[128:131], v[200:203], v[168:171], v[128:131]
    v_exp_f32 v24, v24
    v_exp_f32 v25, v25
    v_mfma_f32_16x16x32_bf16 v[132:135], v[200:203], v[172:175], v[132:135]
    v_exp_f32 v26, v26
    v_exp_f32 v27, v27
    v_mfma_f32_16x16x32_bf16 v[136:139], v[200:203], v[176:179], v[136:139]
    v_add_f32 v241, v241, v24
    v_add_f32 v241, v241, v25
    s_waitcnt lgkmcnt(2)
    v_mfma_f32_16x16x32_bf16 v[120:123], v[204:207], v[180:183], v[120:123]
    v_add_f32 v241, v241, v26
    v_add_f32 v241, v241, v27
    v_mfma_f32_16x16x32_bf16 v[124:127], v[204:207], v[184:187], v[124:127]
    v_fma_f32 v28, v28, s78, v236
    v_fma_f32 v29, v29, s78, v236
    v_mfma_f32_16x16x32_bf16 v[128:131], v[204:207], v[188:191], v[128:131]
    v_fma_f32 v30, v30, s78, v236
    v_fma_f32 v31, v31, s78, v236
    v_mfma_f32_16x16x32_bf16 v[132:135], v[204:207], v[192:195], v[132:135]
    v_exp_f32 v28, v28
    v_exp_f32 v29, v29
    v_mfma_f32_16x16x32_bf16 v[136:139], v[204:207], v[196:199], v[136:139]
    s_mul_i32 s88, s96, 80
    v_add_u32 v225, s88, v224
    v_exp_f32 v30, v30
    v_exp_f32 v31, v31
    s_waitcnt vmcnt(6)
    s_waitcnt lgkmcnt(0)
    s_barrier
    v_mfma_f32_16x16x32_bf16 v[140:143], v[208:211], v[160:163], v[140:143]
    ds_read_b128 v[200:203], v216 offset:4096
    ds_read_b128 v[160:163], v225
    v_add_f32 v242, v242, v28
    v_add_f32 v242, v242, v29
    v_mfma_f32_16x16x32_bf16 v[144:147], v[208:211], v[164:167], v[144:147]
    ds_read_b128 v[204:207], v217 offset:4096
    ds_read_b128 v[164:167], v225 offset:1024
    v_add_f32 v242, v242, v30
    v_add_f32 v242, v242, v31
    v_mfma_f32_16x16x32_bf16 v[148:151], v[208:211], v[168:171], v[148:151]
    ds_read_b128 v[168:171], v225 offset:2048
    v_fma_f32 v32, v32, s78, v238
    v_fma_f32 v33, v33, s78, v238
    v_mfma_f32_16x16x32_bf16 v[152:155], v[208:211], v[172:175], v[152:155]
    ds_read_b128 v[172:175], v225 offset:3072
    v_fma_f32 v34, v34, s78, v238
    v_fma_f32 v35, v35, s78, v238
    v_mfma_f32_16x16x32_bf16 v[156:159], v[208:211], v[176:179], v[156:159]
    ds_read_b128 v[176:179], v225 offset:4096
    v_exp_f32 v32, v32
    v_exp_f32 v33, v33
    v_mfma_f32_16x16x32_bf16 v[140:143], v[212:215], v[180:183], v[140:143]
    ds_read_b128 v[180:183], v225 offset:5120
    v_exp_f32 v34, v34
    v_exp_f32 v35, v35
    v_mfma_f32_16x16x32_bf16 v[144:147], v[212:215], v[184:187], v[144:147]
    ds_read_b128 v[184:187], v225 offset:6144
    v_add_f32 v244, v244, v32
    v_add_f32 v244, v244, v33
    v_mfma_f32_16x16x32_bf16 v[148:151], v[212:215], v[188:191], v[148:151]
    ds_read_b128 v[188:191], v225 offset:7168
    v_add_f32 v244, v244, v34
    v_add_f32 v244, v244, v35
    v_mfma_f32_16x16x32_bf16 v[152:155], v[212:215], v[192:195], v[152:155]
    ds_read_b128 v[192:195], v225 offset:8192
    v_fma_f32 v36, v36, s78, v239
    v_fma_f32 v37, v37, s78, v239
    v_mfma_f32_16x16x32_bf16 v[156:159], v[212:215], v[196:199], v[156:159]
    ds_read_b128 v[196:199], v225 offset:9216
    v_fma_f32 v38, v38, s78, v239
    v_fma_f32 v39, v39, s78, v239
    s_waitcnt lgkmcnt(10)
    v_mfma_f32_16x16x32_bf16 v[80:83], v[200:203], v[160:163], v[80:83]
    ds_read_b128 v[208:211], v216 offset:45056
    v_exp_f32 v36, v36
    v_exp_f32 v37, v37
    s_waitcnt lgkmcnt(9)
    v_mfma_f32_16x16x32_bf16 v[84:87], v[200:203], v[164:167], v[84:87]
    ds_read_b128 v[212:215], v217 offset:45056
    v_exp_f32 v38, v38
    v_exp_f32 v39, v39
    s_waitcnt lgkmcnt(9)
    v_mfma_f32_16x16x32_bf16 v[88:91], v[200:203], v[168:171], v[88:91]
    v_add_f32 v246, v246, v36
    v_add_f32 v246, v246, v37
    s_waitcnt lgkmcnt(8)
    v_mfma_f32_16x16x32_bf16 v[92:95], v[200:203], v[172:175], v[92:95]
    v_add_f32 v246, v246, v38
    v_add_f32 v246, v246, v39
    s_waitcnt lgkmcnt(7)
    v_mfma_f32_16x16x32_bf16 v[96:99], v[200:203], v[176:179], v[96:99]
    v_fma_f32 v40, v40, s78, v234
    v_fma_f32 v41, v41, s78, v234
    s_waitcnt lgkmcnt(6)
    v_mfma_f32_16x16x32_bf16 v[80:83], v[204:207], v[180:183], v[80:83]
    v_fma_f32 v42, v42, s78, v234
    v_fma_f32 v43, v43, s78, v234
    s_waitcnt lgkmcnt(5)
    v_mfma_f32_16x16x32_bf16 v[84:87], v[204:207], v[184:187], v[84:87]
    v_exp_f32 v40, v40
    v_exp_f32 v41, v41
    s_waitcnt lgkmcnt(4)
    v_mfma_f32_16x16x32_bf16 v[88:91], v[204:207], v[188:191], v[88:91]
    v_exp_f32 v42, v42
    v_exp_f32 v43, v43
    s_waitcnt lgkmcnt(3)
    v_mfma_f32_16x16x32_bf16 v[92:95], v[204:207], v[192:195], v[92:95]
    v_add_f32 v240, v240, v40
    v_add_f32 v240, v240, v41
    s_waitcnt lgkmcnt(2)
    v_mfma_f32_16x16x32_bf16 v[96:99], v[204:207], v[196:199], v[96:99]
    v_add_f32 v240, v240, v42
    v_add_f32 v240, v240, v43
    s_waitcnt vmcnt(4)
    s_waitcnt lgkmcnt(0)
    s_barrier
    v_mfma_f32_16x16x32_bf16 v[100:103], v[208:211], v[160:163], v[100:103]
    ds_read_b128 v[200:203], v216 offset:6144
    v_fma_f32 v44, v44, s78, v235
    v_fma_f32 v45, v45, s78, v235
    v_mfma_f32_16x16x32_bf16 v[104:107], v[208:211], v[164:167], v[104:107]
    ds_read_b128 v[204:207], v217 offset:6144
    v_fma_f32 v46, v46, s78, v235
    v_fma_f32 v47, v47, s78, v235
    v_mfma_f32_16x16x32_bf16 v[108:111], v[208:211], v[168:171], v[108:111]
    s_mov_b32 s77, 0
    s_add_u32 m0, s76, 4096
    s_nop 0
    buffer_load_dwordx4 v220, s[52:55], s77 offen nt lds
    buffer_load_dwordx4 v221, s[52:55], s77 offen offset:1024 nt lds
    v_exp_f32 v44, v44
    v_exp_f32 v45, v45
    v_mfma_f32_16x16x32_bf16 v[112:115], v[208:211], v[172:175], v[112:115]
    v_exp_f32 v46, v46
    v_exp_f32 v47, v47
    v_mfma_f32_16x16x32_bf16 v[116:119], v[208:211], v[176:179], v[116:119]
    v_add_f32 v241, v241, v44
    v_add_f32 v241, v241, v45
    v_mfma_f32_16x16x32_bf16 v[100:103], v[212:215], v[180:183], v[100:103]
    v_add_f32 v241, v241, v46
    v_add_f32 v241, v241, v47
    v_mfma_f32_16x16x32_bf16 v[104:107], v[212:215], v[184:187], v[104:107]
    v_fma_f32 v48, v48, s78, v236
    v_fma_f32 v49, v49, s78, v236
    v_mfma_f32_16x16x32_bf16 v[108:111], v[212:215], v[188:191], v[108:111]
    v_fma_f32 v50, v50, s78, v236
    v_fma_f32 v51, v51, s78, v236
    v_mfma_f32_16x16x32_bf16 v[112:115], v[212:215], v[192:195], v[112:115]
    v_exp_f32 v48, v48
    v_exp_f32 v49, v49
    v_mfma_f32_16x16x32_bf16 v[116:119], v[212:215], v[196:199], v[116:119]
    v_exp_f32 v50, v50
    v_exp_f32 v51, v51
    s_waitcnt lgkmcnt(1)
    v_mfma_f32_16x16x32_bf16 v[120:123], v[200:203], v[160:163], v[120:123]
    ds_read_b128 v[208:211], v216 offset:47104
    v_add_f32 v242, v242, v48
    v_add_f32 v242, v242, v49
    v_mfma_f32_16x16x32_bf16 v[124:127], v[200:203], v[164:167], v[124:127]
    ds_read_b128 v[212:215], v217 offset:47104
    v_add_f32 v242, v242, v50
    v_add_f32 v242, v242, v51
    v_mfma_f32_16x16x32_bf16 v[128:131], v[200:203], v[168:171], v[128:131]
    v_fma_f32 v52, v52, s78, v238
    v_fma_f32 v53, v53, s78, v238
    v_mfma_f32_16x16x32_bf16 v[132:135], v[200:203], v[172:175], v[132:135]
    v_fma_f32 v54, v54, s78, v238
    v_fma_f32 v55, v55, s78, v238
    v_mfma_f32_16x16x32_bf16 v[136:139], v[200:203], v[176:179], v[136:139]
    v_exp_f32 v52, v52
    v_exp_f32 v53, v53
    s_waitcnt lgkmcnt(2)
    v_mfma_f32_16x16x32_bf16 v[120:123], v[204:207], v[180:183], v[120:123]
    v_exp_f32 v54, v54
    v_exp_f32 v55, v55
    v_mfma_f32_16x16x32_bf16 v[124:127], v[204:207], v[184:187], v[124:127]
    v_add_f32 v244, v244, v52
    v_add_f32 v244, v244, v53
    v_mfma_f32_16x16x32_bf16 v[128:131], v[204:207], v[188:191], v[128:131]
    v_add_f32 v244, v244, v54
    v_add_f32 v244, v244, v55
    v_mfma_f32_16x16x32_bf16 v[132:135], v[204:207], v[192:195], v[132:135]
    v_fma_f32 v56, v56, s78, v239
    v_fma_f32 v57, v57, s78, v239
    v_mfma_f32_16x16x32_bf16 v[136:139], v[204:207], v[196:199], v[136:139]
    s_mul_i32 s88, s97, 80
    v_add_u32 v225, s88, v224
    v_fma_f32 v58, v58, s78, v239
    v_fma_f32 v59, v59, s78, v239
    s_waitcnt vmcnt(4)
    s_waitcnt lgkmcnt(0)
    s_barrier
    v_mfma_f32_16x16x32_bf16 v[140:143], v[208:211], v[160:163], v[140:143]
    ds_read_b128 v[200:203], v216 offset:8192
    ds_read_b128 v[160:163], v225
    v_exp_f32 v56, v56
    v_exp_f32 v57, v57
    v_mfma_f32_16x16x32_bf16 v[144:147], v[208:211], v[164:167], v[144:147]
    ds_read_b128 v[204:207], v217 offset:8192
    ds_read_b128 v[164:167], v225 offset:1024
    v_exp_f32 v58, v58
    v_exp_f32 v59, v59
    v_mfma_f32_16x16x32_bf16 v[148:151], v[208:211], v[168:171], v[148:151]
    ds_read_b128 v[168:171], v225 offset:2048
    s_mov_b32 s77, 65536
    s_add_u32 m0, s76, 6144
    s_nop 0
    buffer_load_dwordx4 v220, s[52:55], s77 offen nt lds
    buffer_load_dwordx4 v221, s[52:55], s77 offen offset:1024 nt lds
    v_add_f32 v246, v246, v56
    v_add_f32 v246, v246, v57
    v_mfma_f32_16x16x32_bf16 v[152:155], v[208:211], v[172:175], v[152:155]
    ds_read_b128 v[172:175], v225 offset:3072
    v_add_f32 v246, v246, v58
    v_add_f32 v246, v246, v59
    v_mfma_f32_16x16x32_bf16 v[156:159], v[208:211], v[176:179], v[156:159]
    ds_read_b128 v[176:179], v225 offset:4096
    v_fma_f32 v60, v60, s78, v234
    v_fma_f32 v61, v61, s78, v234
    v_mfma_f32_16x16x32_bf16 v[140:143], v[212:215], v[180:183], v[140:143]
    ds_read_b128 v[180:183], v225 offset:5120
    v_fma_f32 v62, v62, s78, v234
    v_fma_f32 v63, v63, s78, v234
    v_mfma_f32_16x16x32_bf16 v[144:147], v[212:215], v[184:187], v[144:147]
    ds_read_b128 v[184:187], v225 offset:6144
    v_exp_f32 v60, v60
    v_exp_f32 v61, v61
    v_mfma_f32_16x16x32_bf16 v[148:151], v[212:215], v[188:191], v[148:151]
    ds_read_b128 v[188:191], v225 offset:7168
    v_exp_f32 v62, v62
    v_exp_f32 v63, v63
    v_mfma_f32_16x16x32_bf16 v[152:155], v[212:215], v[192:195], v[152:155]
    ds_read_b128 v[192:195], v225 offset:8192
    v_add_f32 v240, v240, v60
    v_add_f32 v240, v240, v61
    v_mfma_f32_16x16x32_bf16 v[156:159], v[212:215], v[196:199], v[156:159]
    ds_read_b128 v[196:199], v225 offset:9216
    v_add_f32 v240, v240, v62
    v_add_f32 v240, v240, v63
    s_waitcnt lgkmcnt(10)
    v_mfma_f32_16x16x32_bf16 v[80:83], v[200:203], v[160:163], v[80:83]
    ds_read_b128 v[208:211], v216 offset:49152
    v_fma_f32 v64, v64, s78, v235
    v_fma_f32 v65, v65, s78, v235
    s_waitcnt lgkmcnt(9)
    v_mfma_f32_16x16x32_bf16 v[84:87], v[200:203], v[164:167], v[84:87]
    ds_read_b128 v[212:215], v217 offset:49152
    v_fma_f32 v66, v66, s78, v235
    v_fma_f32 v67, v67, s78, v235
    s_waitcnt lgkmcnt(9)
    v_mfma_f32_16x16x32_bf16 v[88:91], v[200:203], v[168:171], v[88:91]
    v_exp_f32 v64, v64
    v_exp_f32 v65, v65
    s_waitcnt lgkmcnt(8)
    v_mfma_f32_16x16x32_bf16 v[92:95], v[200:203], v[172:175], v[92:95]
    v_exp_f32 v66, v66
    v_exp_f32 v67, v67
    s_waitcnt lgkmcnt(7)
    v_mfma_f32_16x16x32_bf16 v[96:99], v[200:203], v[176:179], v[96:99]
    v_add_f32 v241, v241, v64
    v_add_f32 v241, v241, v65
    s_waitcnt lgkmcnt(6)
    v_mfma_f32_16x16x32_bf16 v[80:83], v[204:207], v[180:183], v[80:83]
    v_add_f32 v241, v241, v66
    v_add_f32 v241, v241, v67
    s_waitcnt lgkmcnt(5)
    v_mfma_f32_16x16x32_bf16 v[84:87], v[204:207], v[184:187], v[84:87]
    v_fma_f32 v68, v68, s78, v236
    v_fma_f32 v69, v69, s78, v236
    s_waitcnt lgkmcnt(4)
    v_mfma_f32_16x16x32_bf16 v[88:91], v[204:207], v[188:191], v[88:91]
    v_fma_f32 v70, v70, s78, v236
    v_fma_f32 v71, v71, s78, v236
    s_waitcnt lgkmcnt(3)
    v_mfma_f32_16x16x32_bf16 v[92:95], v[204:207], v[192:195], v[92:95]
    v_exp_f32 v68, v68
    v_exp_f32 v69, v69
    s_waitcnt lgkmcnt(2)
    v_mfma_f32_16x16x32_bf16 v[96:99], v[204:207], v[196:199], v[96:99]
    v_exp_f32 v70, v70
    v_exp_f32 v71, v71
    s_waitcnt vmcnt(4)
    s_waitcnt lgkmcnt(0)
    s_barrier
    v_mfma_f32_16x16x32_bf16 v[100:103], v[208:211], v[160:163], v[100:103]
    ds_read_b128 v[200:203], v216
    v_add_f32 v242, v242, v68
    v_add_f32 v242, v242, v69
    v_mfma_f32_16x16x32_bf16 v[104:107], v[208:211], v[164:167], v[104:107]
    ds_read_b128 v[204:207], v217
    v_add_f32 v242, v242, v70
    v_add_f32 v242, v242, v71
    v_mfma_f32_16x16x32_bf16 v[108:111], v[208:211], v[168:171], v[108:111]
    s_mov_b32 s77, 131072
    s_add_u32 m0, s76, 8192
    s_nop 0
    buffer_load_dwordx4 v220, s[52:55], s77 offen nt lds
    buffer_load_dwordx4 v221, s[52:55], s77 offen offset:1024 nt lds
    v_fma_f32 v72, v72, s78, v238
    v_fma_f32 v73, v73, s78, v238
    v_mfma_f32_16x16x32_bf16 v[112:115], v[208:211], v[172:175], v[112:115]
    v_fma_f32 v74, v74, s78, v238
    v_fma_f32 v75, v75, s78, v238
    v_mfma_f32_16x16x32_bf16 v[116:119], v[208:211], v[176:179], v[116:119]
    v_exp_f32 v72, v72
    v_exp_f32 v73, v73
    v_mfma_f32_16x16x32_bf16 v[100:103], v[212:215], v[180:183], v[100:103]
    v_exp_f32 v74, v74
    v_exp_f32 v75, v75
    v_mfma_f32_16x16x32_bf16 v[104:107], v[212:215], v[184:187], v[104:107]
    v_add_f32 v244, v244, v72
    v_add_f32 v244, v244, v73
    v_mfma_f32_16x16x32_bf16 v[108:111], v[212:215], v[188:191], v[108:111]
    v_add_f32 v244, v244, v74
    v_add_f32 v244, v244, v75
    v_mfma_f32_16x16x32_bf16 v[112:115], v[212:215], v[192:195], v[112:115]
    v_fma_f32 v76, v76, s78, v239
    v_fma_f32 v77, v77, s78, v239
    v_mfma_f32_16x16x32_bf16 v[116:119], v[212:215], v[196:199], v[116:119]
    v_fma_f32 v78, v78, s78, v239
    v_fma_f32 v79, v79, s78, v239
    s_waitcnt lgkmcnt(1)
    v_mfma_f32_16x16x32_bf16 v[120:123], v[200:203], v[160:163], v[120:123]
    ds_read_b128 v[208:211], v216 offset:40960
    v_exp_f32 v76, v76
    v_exp_f32 v77, v77
    v_mfma_f32_16x16x32_bf16 v[124:127], v[200:203], v[164:167], v[124:127]
    ds_read_b128 v[212:215], v217 offset:40960
    v_exp_f32 v78, v78
    v_exp_f32 v79, v79
    v_mfma_f32_16x16x32_bf16 v[128:131], v[200:203], v[168:171], v[128:131]
    v_add_f32 v246, v246, v76
    v_add_f32 v246, v246, v77
    v_mfma_f32_16x16x32_bf16 v[132:135], v[200:203], v[172:175], v[132:135]
    v_add_f32 v246, v246, v78
    v_add_f32 v246, v246, v79
    v_mfma_f32_16x16x32_bf16 v[136:139], v[200:203], v[176:179], v[136:139]
    v_max3_f32 v248, v248, v80, v81
    v_max3_f32 v248, v248, v82, v83
    s_waitcnt lgkmcnt(2)
    v_mfma_f32_16x16x32_bf16 v[120:123], v[204:207], v[180:183], v[120:123]
    v_max3_f32 v249, v249, v84, v85
    v_max3_f32 v249, v249, v86, v87
    v_mfma_f32_16x16x32_bf16 v[124:127], v[204:207], v[184:187], v[124:127]
    v_max3_f32 v250, v250, v88, v89
    v_max3_f32 v250, v250, v90, v91
    v_mfma_f32_16x16x32_bf16 v[128:131], v[204:207], v[188:191], v[128:131]
    v_max3_f32 v251, v251, v92, v93
    v_max3_f32 v251, v251, v94, v95
    v_mfma_f32_16x16x32_bf16 v[132:135], v[204:207], v[192:195], v[132:135]
    v_max3_f32 v252, v252, v96, v97
    v_max3_f32 v252, v252, v98, v99
    v_mfma_f32_16x16x32_bf16 v[136:139], v[204:207], v[196:199], v[136:139]
    v_max3_f32 v248, v248, v100, v101
    v_max3_f32 v248, v248, v102, v103
    s_waitcnt lgkmcnt(1)
    v_mfma_f32_16x16x32_bf16 v[140:143], v[208:211], v[160:163], v[140:143]
    v_max3_f32 v249, v249, v104, v105
    v_max3_f32 v249, v249, v106, v107
    v_mfma_f32_16x16x32_bf16 v[144:147], v[208:211], v[164:167], v[144:147]
    v_max3_f32 v250, v250, v108, v109
    v_max3_f32 v250, v250, v110, v111
    v_mfma_f32_16x16x32_bf16 v[148:151], v[208:211], v[168:171], v[148:151]
    v_max3_f32 v251, v251, v112, v113
    v_max3_f32 v251, v251, v114, v115
    v_mfma_f32_16x16x32_bf16 v[152:155], v[208:211], v[172:175], v[152:155]
    v_max3_f32 v252, v252, v116, v117
    v_max3_f32 v252, v252, v118, v119
    v_mfma_f32_16x16x32_bf16 v[156:159], v[208:211], v[176:179], v[156:159]
    v_max3_f32 v248, v248, v120, v121
    v_max3_f32 v248, v248, v122, v123
    s_waitcnt lgkmcnt(0)
    v_mfma_f32_16x16x32_bf16 v[140:143], v[212:215], v[180:183], v[140:143]
    v_max3_f32 v249, v249, v124, v125
    v_max3_f32 v249, v249, v126, v127
    v_mfma_f32_16x16x32_bf16 v[144:147], v[212:215], v[184:187], v[144:147]
    v_max3_f32 v250, v250, v128, v129
    v_max3_f32 v250, v250, v130, v131
    v_mfma_f32_16x16x32_bf16 v[148:151], v[212:215], v[188:191], v[148:151]
    v_max3_f32 v251, v251, v132, v133
    v_max3_f32 v251, v251, v134, v135
    v_mfma_f32_16x16x32_bf16 v[152:155], v[212:215], v[192:195], v[152:155]
    v_max3_f32 v252, v252, v136, v137
    v_max3_f32 v252, v252, v138, v139
    v_mfma_f32_16x16x32_bf16 v[156:159], v[212:215], v[196:199], v[156:159]
    v_max3_f32 v248, v248, v140, v141
    v_max3_f32 v248, v248, v142, v143
    v_max3_f32 v249, v249, v144, v145
    v_max3_f32 v249, v249, v146, v147
    v_max3_f32 v250, v250, v148, v149
    v_max3_f32 v250, v250, v150, v151
    v_max3_f32 v251, v251, v152, v153
    v_max3_f32 v251, v251, v154, v155
    v_max3_f32 v252, v252, v156, v157
    v_max3_f32 v252, v252, v158, v159
    v_mov_b32 v206, v248
    v_mov_b32 v207, v249
    v_mov_b32 v208, v250
    v_mov_b32 v209, v251
    v_mov_b32 v210, v252
    v_permlane32_swap_b32 v248, v206
    v_permlane32_swap_b32 v249, v207
    v_permlane32_swap_b32 v250, v208
    v_permlane32_swap_b32 v251, v209
    v_permlane32_swap_b32 v252, v210
    v_max_f32 v248, v248, v206
    v_max_f32 v249, v249, v207
    v_max_f32 v250, v250, v208
    v_max_f32 v251, v251, v209
    v_max_f32 v252, v252, v210
    v_mov_b32 v206, v248
    v_mov_b32 v207, v249
    v_mov_b32 v208, v250
    v_mov_b32 v209, v251
    v_mov_b32 v210, v252
    v_permlane16_swap_b32 v248, v206
    v_permlane16_swap_b32 v249, v207
    v_permlane16_swap_b32 v250, v208
    v_permlane16_swap_b32 v251, v209
    v_permlane16_swap_b32 v252, v210
    v_max_f32 v176, v248, v206
    v_max_f32 v178, v249, v207
    v_max_f32 v180, v250, v208
    v_max_f32 v182, v251, v209
    v_max_f32 v184, v252, v210
    v_mul_f32 v186, s80, v176
    v_mul_f32 v188, s80, v178
    v_mul_f32 v190, s80, v180
    v_mul_f32 v192, s80, v182
    v_mul_f32 v194, s80, v184
    v_sub_f32 v234, v186, v234
    v_sub_f32 v235, v188, v235
    v_sub_f32 v236, v190, v236
    v_sub_f32 v238, v192, v238
    v_sub_f32 v239, v194, v239
    v_exp_f32 v234, v234
    v_exp_f32 v235, v235
    v_exp_f32 v236, v236
    v_exp_f32 v238, v238
    v_exp_f32 v239, v239
    v_pk_fma_f32 v[80:81], v[80:81], s[78:79], v[186:187] op_sel_hi:[1,0,0]
    v_pk_fma_f32 v[82:83], v[82:83], s[78:79], v[186:187] op_sel_hi:[1,0,0]
    v_pk_fma_f32 v[84:85], v[84:85], s[78:79], v[188:189] op_sel_hi:[1,0,0]
    v_pk_fma_f32 v[86:87], v[86:87], s[78:79], v[188:189] op_sel_hi:[1,0,0]
    v_pk_fma_f32 v[88:89], v[88:89], s[78:79], v[190:191] op_sel_hi:[1,0,0]
    v_pk_fma_f32 v[90:91], v[90:91], s[78:79], v[190:191] op_sel_hi:[1,0,0]
    v_pk_fma_f32 v[92:93], v[92:93], s[78:79], v[192:193] op_sel_hi:[1,0,0]
    v_pk_fma_f32 v[94:95], v[94:95], s[78:79], v[192:193] op_sel_hi:[1,0,0]
    v_pk_fma_f32 v[96:97], v[96:97], s[78:79], v[194:195] op_sel_hi:[1,0,0]
    v_pk_fma_f32 v[98:99], v[98:99], s[78:79], v[194:195] op_sel_hi:[1,0,0]
    v_exp_f32 v80, v80
    v_exp_f32 v81, v81
    v_exp_f32 v82, v82
    v_exp_f32 v83, v83
    v_exp_f32 v84, v84
    v_exp_f32 v85, v85
    v_exp_f32 v86, v86
    v_exp_f32 v87, v87
    v_exp_f32 v88, v88
    v_exp_f32 v89, v89
    v_exp_f32 v90, v90
    v_exp_f32 v91, v91
    v_exp_f32 v92, v92
    v_exp_f32 v93, v93
    v_exp_f32 v94, v94
    v_exp_f32 v95, v95
    v_exp_f32 v96, v96
    v_exp_f32 v97, v97
    v_exp_f32 v98, v98
    v_exp_f32 v99, v99
    v_pk_add_f32 v[196:197], v[80:81], v[82:83]
    v_pk_add_f32 v[198:199], v[84:85], v[86:87]
    v_pk_add_f32 v[200:201], v[88:89], v[90:91]
    v_pk_add_f32 v[202:203], v[92:93], v[94:95]
    v_pk_add_f32 v[204:205], v[96:97], v[98:99]
    v_pk_fma_f32 v[100:101], v[100:101], s[78:79], v[186:187] op_sel_hi:[1,0,0]
    v_pk_fma_f32 v[102:103], v[102:103], s[78:79], v[186:187] op_sel_hi:[1,0,0]
    v_pk_fma_f32 v[104:105], v[104:105], s[78:79], v[188:189] op_sel_hi:[1,0,0]
    v_pk_fma_f32 v[106:107], v[106:107], s[78:79], v[188:189] op_sel_hi:[1,0,0]
    v_pk_fma_f32 v[108:109], v[108:109], s[78:79], v[190:191] op_sel_hi:[1,0,0]
    v_pk_fma_f32 v[110:111], v[110:111], s[78:79], v[190:191] op_sel_hi:[1,0,0]
    v_pk_fma_f32 v[112:113], v[112:113], s[78:79], v[192:193] op_sel_hi:[1,0,0]
    v_pk_fma_f32 v[114:115], v[114:115], s[78:79], v[192:193] op_sel_hi:[1,0,0]
    v_pk_fma_f32 v[116:117], v[116:117], s[78:79], v[194:195] op_sel_hi:[1,0,0]
    v_pk_fma_f32 v[118:119], v[118:119], s[78:79], v[194:195] op_sel_hi:[1,0,0]
    v_exp_f32 v100, v100
    v_exp_f32 v101, v101
    v_exp_f32 v102, v102
    v_exp_f32 v103, v103
    v_exp_f32 v104, v104
    v_exp_f32 v105, v105
    v_exp_f32 v106, v106
    v_exp_f32 v107, v107
    v_exp_f32 v108, v108
    v_exp_f32 v109, v109
    v_exp_f32 v110, v110
    v_exp_f32 v111, v111
    v_exp_f32 v112, v112
    v_exp_f32 v113, v113
    v_exp_f32 v114, v114
    v_exp_f32 v115, v115
    v_exp_f32 v116, v116
    v_exp_f32 v117, v117
    v_exp_f32 v118, v118
    v_exp_f32 v119, v119
    v_pk_add_f32 v[196:197], v[196:197], v[100:101]
    v_pk_add_f32 v[198:199], v[198:199], v[104:105]
    v_pk_add_f32 v[200:201], v[200:201], v[108:109]
    v_pk_add_f32 v[202:203], v[202:203], v[112:113]
    v_pk_add_f32 v[204:205], v[204:205], v[116:117]
    v_pk_add_f32 v[196:197], v[196:197], v[102:103]
    v_pk_add_f32 v[198:199], v[198:199], v[106:107]
    v_pk_add_f32 v[200:201], v[200:201], v[110:111]
    v_pk_add_f32 v[202:203], v[202:203], v[114:115]
    v_pk_add_f32 v[204:205], v[204:205], v[118:119]
    v_pk_fma_f32 v[120:121], v[120:121], s[78:79], v[186:187] op_sel_hi:[1,0,0]
    v_pk_fma_f32 v[122:123], v[122:123], s[78:79], v[186:187] op_sel_hi:[1,0,0]
    v_pk_fma_f32 v[124:125], v[124:125], s[78:79], v[188:189] op_sel_hi:[1,0,0]
    v_pk_fma_f32 v[126:127], v[126:127], s[78:79], v[188:189] op_sel_hi:[1,0,0]
    v_pk_fma_f32 v[128:129], v[128:129], s[78:79], v[190:191] op_sel_hi:[1,0,0]
    v_pk_fma_f32 v[130:131], v[130:131], s[78:79], v[190:191] op_sel_hi:[1,0,0]
    v_pk_fma_f32 v[132:133], v[132:133], s[78:79], v[192:193] op_sel_hi:[1,0,0]
    v_pk_fma_f32 v[134:135], v[134:135], s[78:79], v[192:193] op_sel_hi:[1,0,0]
    v_pk_fma_f32 v[136:137], v[136:137], s[78:79], v[194:195] op_sel_hi:[1,0,0]
    v_pk_fma_f32 v[138:139], v[138:139], s[78:79], v[194:195] op_sel_hi:[1,0,0]
    v_exp_f32 v120, v120
    v_exp_f32 v121, v121
    v_exp_f32 v122, v122
    v_exp_f32 v123, v123
    v_exp_f32 v124, v124
    v_exp_f32 v125, v125
    v_exp_f32 v126, v126
    v_exp_f32 v127, v127
    v_exp_f32 v128, v128
    v_exp_f32 v129, v129
    v_exp_f32 v130, v130
    v_exp_f32 v131, v131
    v_exp_f32 v132, v132
    v_exp_f32 v133, v133
    v_exp_f32 v134, v134
    v_exp_f32 v135, v135
    v_exp_f32 v136, v136
    v_exp_f32 v137, v137
    v_exp_f32 v138, v138
    v_exp_f32 v139, v139
    v_pk_add_f32 v[196:197], v[196:197], v[120:121]
    v_pk_add_f32 v[198:199], v[198:199], v[124:125]
    v_pk_add_f32 v[200:201], v[200:201], v[128:129]
    v_pk_add_f32 v[202:203], v[202:203], v[132:133]
    v_pk_add_f32 v[204:205], v[204:205], v[136:137]
    v_pk_add_f32 v[196:197], v[196:197], v[122:123]
    v_pk_add_f32 v[198:199], v[198:199], v[126:127]
    v_pk_add_f32 v[200:201], v[200:201], v[130:131]
    v_pk_add_f32 v[202:203], v[202:203], v[134:135]
    v_pk_add_f32 v[204:205], v[204:205], v[138:139]
    v_pk_fma_f32 v[140:141], v[140:141], s[78:79], v[186:187] op_sel_hi:[1,0,0]
    v_pk_fma_f32 v[142:143], v[142:143], s[78:79], v[186:187] op_sel_hi:[1,0,0]
    v_pk_fma_f32 v[144:145], v[144:145], s[78:79], v[188:189] op_sel_hi:[1,0,0]
    v_pk_fma_f32 v[146:147], v[146:147], s[78:79], v[188:189] op_sel_hi:[1,0,0]
    v_pk_fma_f32 v[148:149], v[148:149], s[78:79], v[190:191] op_sel_hi:[1,0,0]
    v_pk_fma_f32 v[150:151], v[150:151], s[78:79], v[190:191] op_sel_hi:[1,0,0]
    v_pk_fma_f32 v[152:153], v[152:153], s[78:79], v[192:193] op_sel_hi:[1,0,0]
    v_pk_fma_f32 v[154:155], v[154:155], s[78:79], v[192:193] op_sel_hi:[1,0,0]
    v_pk_fma_f32 v[156:157], v[156:157], s[78:79], v[194:195] op_sel_hi:[1,0,0]
    v_pk_fma_f32 v[158:159], v[158:159], s[78:79], v[194:195] op_sel_hi:[1,0,0]
    v_exp_f32 v140, v140
    v_exp_f32 v141, v141
    v_exp_f32 v142, v142
    v_exp_f32 v143, v143
    v_exp_f32 v144, v144
    v_exp_f32 v145, v145
    v_exp_f32 v146, v146
    v_exp_f32 v147, v147
    v_exp_f32 v148, v148
    v_exp_f32 v149, v149
    v_exp_f32 v150, v150
    v_exp_f32 v151, v151
    v_exp_f32 v152, v152
    v_exp_f32 v153, v153
    v_exp_f32 v154, v154
    v_exp_f32 v155, v155
    v_exp_f32 v156, v156
    v_exp_f32 v157, v157
    v_exp_f32 v158, v158
    v_exp_f32 v159, v159
    v_pk_add_f32 v[196:197], v[196:197], v[140:141]
    v_pk_add_f32 v[198:199], v[198:199], v[144:145]
    v_pk_add_f32 v[200:201], v[200:201], v[148:149]
    v_pk_add_f32 v[202:203], v[202:203], v[152:153]
    v_pk_add_f32 v[204:205], v[204:205], v[156:157]
    v_pk_add_f32 v[196:197], v[196:197], v[142:143]
    v_pk_add_f32 v[198:199], v[198:199], v[146:147]
    v_pk_add_f32 v[200:201], v[200:201], v[150:151]
    v_pk_add_f32 v[202:203], v[202:203], v[154:155]
    v_pk_add_f32 v[204:205], v[204:205], v[158:159]
    v_add_f32 v196, v196, v197
    v_add_f32 v198, v198, v199
    v_add_f32 v200, v200, v201
    v_add_f32 v202, v202, v203
    v_add_f32 v204, v204, v205
    v_fmac_f32 v196, v240, v234
    v_fmac_f32 v198, v241, v235
    v_fmac_f32 v200, v242, v236
    v_fmac_f32 v202, v244, v238
    v_fmac_f32 v204, v246, v239
    v_mov_b32 v206, v196
    v_mov_b32 v207, v198
    v_mov_b32 v208, v200
    v_mov_b32 v209, v202
    v_mov_b32 v210, v204
    v_permlane32_swap_b32 v196, v206
    v_permlane32_swap_b32 v198, v207
    v_permlane32_swap_b32 v200, v208
    v_permlane32_swap_b32 v202, v209
    v_permlane32_swap_b32 v204, v210
    v_add_f32 v196, v196, v206
    v_add_f32 v198, v198, v207
    v_add_f32 v200, v200, v208
    v_add_f32 v202, v202, v209
    v_add_f32 v204, v204, v210
    v_mov_b32 v206, v196
    v_mov_b32 v207, v198
    v_mov_b32 v208, v200
    v_mov_b32 v209, v202
    v_mov_b32 v210, v204
    v_permlane16_swap_b32 v196, v206
    v_permlane16_swap_b32 v198, v207
    v_permlane16_swap_b32 v200, v208
    v_permlane16_swap_b32 v202, v209
    v_permlane16_swap_b32 v204, v210
    v_add_f32 v177, v196, v206
    v_add_f32 v179, v198, v207
    v_add_f32 v181, v200, v208
    v_add_f32 v183, v202, v209
    v_add_f32 v185, v204, v210
    s_mov_b64 exec, 0xffff
    ds_write_b64 v226, v[176:177] offset:2048
    ds_write_b64 v226, v[178:179] offset:2176
    ds_write_b64 v226, v[180:181] offset:2304
    ds_write_b64 v226, v[182:183] offset:2432
    ds_write_b64 v226, v[184:185] offset:2560
    s_mov_b64 exec, -1
    s_waitcnt vmcnt(4)
    s_waitcnt lgkmcnt(0)
    s_barrier
    s_mov_b32 s77, 196608
    s_add_u32 m0, s76, 0
    s_nop 0
    buffer_load_dwordx4 v220, s[52:55], s77 offen nt lds
    buffer_load_dwordx4 v221, s[52:55], s77 offen offset:1024 nt lds
    ds_read_b64 v[160:161], v227 offset:2048
    ds_read_b64 v[162:163], v227 offset:12288
    ds_read_b64 v[164:165], v227 offset:22528
    ds_read_b64 v[166:167], v227 offset:32768
    ds_read_b64 v[168:169], v227 offset:2176
    ds_read_b64 v[170:171], v227 offset:12416
    ds_read_b64 v[172:173], v227 offset:22656
    ds_read_b64 v[174:175], v227 offset:32896
    ds_read_b64 v[176:177], v227 offset:2304
    ds_read_b64 v[178:179], v227 offset:12544
    ds_read_b64 v[180:181], v227 offset:22784
    ds_read_b64 v[182:183], v227 offset:33024
    ds_read_b64 v[196:197], v227 offset:2432
    ds_read_b64 v[198:199], v227 offset:12672
    ds_read_b64 v[200:201], v227 offset:22912
    s_waitcnt lgkmcnt(14)
    ds_read_b64 v[202:203], v227 offset:33152
    s_waitcnt lgkmcnt(14)
    ds_read_b64 v[204:205], v227 offset:2560
    s_waitcnt lgkmcnt(14)
    ds_read_b64 v[206:207], v227 offset:12800
    s_waitcnt lgkmcnt(14)
    ds_read_b64 v[208:209], v227 offset:23040
    s_waitcnt lgkmcnt(14)
    ds_read_b64 v[210:211], v227 offset:33280
    v_max3_f32 v248, v160, v162, v164
    v_max_f32 v248, v248, v166
    v_mul_f32 v248, s80, v248
    v_fma_f32 v160, v160, s78, v248
    v_fma_f32 v162, v162, s78, v248
    v_fma_f32 v164, v164, s78, v248
    v_fma_f32 v166, v166, s78, v248
    v_sub_f32 v186, v248, v186
    s_waitcnt lgkmcnt(13)
    v_max3_f32 v249, v168, v170, v172
    s_waitcnt lgkmcnt(12)
    v_max_f32 v249, v249, v174
    v_mul_f32 v249, s80, v249
    v_fma_f32 v168, v168, s78, v249
    v_fma_f32 v170, v170, s78, v249
    v_fma_f32 v172, v172, s78, v249
    v_fma_f32 v174, v174, s78, v249
    v_sub_f32 v188, v249, v188
    s_waitcnt lgkmcnt(9)
    v_max3_f32 v250, v176, v178, v180
    s_waitcnt lgkmcnt(8)
    v_max_f32 v250, v250, v182
    v_mul_f32 v250, s80, v250
    v_fma_f32 v176, v176, s78, v250
    v_fma_f32 v178, v178, s78, v250
    v_fma_f32 v180, v180, s78, v250
    v_fma_f32 v182, v182, s78, v250
    v_sub_f32 v190, v250, v190
    s_waitcnt lgkmcnt(5)
    v_max3_f32 v251, v196, v198, v200
    s_waitcnt lgkmcnt(4)
    v_max_f32 v251, v251, v202
    v_mul_f32 v251, s80, v251
    v_fma_f32 v196, v196, s78, v251
    v_fma_f32 v198, v198, s78, v251
    v_fma_f32 v200, v200, s78, v251
    v_fma_f32 v202, v202, s78, v251
    v_sub_f32 v192, v251, v192
    s_waitcnt lgkmcnt(1)
    v_max3_f32 v252, v204, v206, v208
    s_waitcnt lgkmcnt(0)
    v_max_f32 v252, v252, v210
    v_mul_f32 v252, s80, v252
    v_fma_f32 v204, v204, s78, v252
    v_fma_f32 v206, v206, s78, v252
    v_fma_f32 v208, v208, s78, v252
    v_fma_f32 v210, v210, s78, v252
    v_sub_f32 v194, v252, v194
    v_exp_f32 v160, v160
    v_exp_f32 v162, v162
    v_exp_f32 v164, v164
    v_exp_f32 v166, v166
    v_exp_f32 v186, v186
    v_exp_f32 v168, v168
    v_exp_f32 v170, v170
    v_exp_f32 v172, v172
    v_exp_f32 v174, v174
    v_exp_f32 v188, v188
    v_exp_f32 v176, v176
    v_exp_f32 v178, v178
    v_exp_f32 v180, v180
    v_exp_f32 v182, v182
    v_exp_f32 v190, v190
    v_exp_f32 v196, v196
    v_exp_f32 v198, v198
    v_exp_f32 v200, v200
    v_exp_f32 v202, v202
    v_exp_f32 v192, v192
    v_exp_f32 v204, v204
    v_exp_f32 v206, v206
    v_exp_f32 v208, v208
    v_exp_f32 v210, v210
    v_exp_f32 v194, v194
    v_mul_f32 v248, v160, v161
    v_fmac_f32 v248, v162, v163
    v_fmac_f32 v248, v164, v165
    v_fmac_f32 v248, v166, v167
    v_mul_f32 v249, v168, v169
    v_fmac_f32 v249, v170, v171
    v_fmac_f32 v249, v172, v173
    v_fmac_f32 v249, v174, v175
    v_mul_f32 v250, v176, v177
    v_fmac_f32 v250, v178, v179
    v_fmac_f32 v250, v180, v181
    v_fmac_f32 v250, v182, v183
    v_mul_f32 v251, v196, v197
    v_fmac_f32 v251, v198, v199
    v_fmac_f32 v251, v200, v201
    v_fmac_f32 v251, v202, v203
    v_mul_f32 v252, v204, v205
    v_fmac_f32 v252, v206, v207
    v_fmac_f32 v252, v208, v209
    v_fmac_f32 v252, v210, v211
    v_rcp_f32 v248, v248
    v_rcp_f32 v249, v249
    v_rcp_f32 v250, v250
    v_rcp_f32 v251, v251
    v_rcp_f32 v252, v252
    v_mul_f32 v248, v248, v186
    v_mul_f32 v249, v249, v188
    v_mul_f32 v250, v250, v190
    v_mul_f32 v251, v251, v192
    v_mul_f32 v252, v252, v194
    v_mul_f32 v186, v248, v234
    v_mul_f32 v188, v249, v235
    v_mul_f32 v190, v250, v236
    v_mul_f32 v192, v251, v238
    v_mul_f32 v194, v252, v239
    v_add_u32 v216, s93, v216
    v_add_u32 v217, s93, v217
    v_subrev_u32 v233, s93, v233
    v_xor_b32 v234, 32, v233
    v_xor_b32 v235, 64, v233
    v_xor_b32 v236, 96, v233
    ds_read_b64_tr_b16 v[160:161], v233 offset:4096
    ds_read_b64_tr_b16 v[164:165], v234 offset:4096
    ds_read_b64_tr_b16 v[168:169], v235 offset:4096
    ds_read_b64_tr_b16 v[172:173], v236 offset:4096
    ds_read_b64_tr_b16 v[162:163], v233 offset:45056
    ds_read_b64_tr_b16 v[166:167], v234 offset:45056
    ds_read_b64_tr_b16 v[170:171], v235 offset:45056
    ds_read_b64_tr_b16 v[174:175], v236 offset:45056
    v_pk_mul_f32 v[0:1], v[0:1], v[186:187] op_sel_hi:[1,0]
    v_pk_mul_f32 v[2:3], v[2:3], v[186:187] op_sel_hi:[1,0]
    v_pk_mul_f32 v[20:21], v[20:21], v[186:187] op_sel_hi:[1,0]
    v_pk_mul_f32 v[22:23], v[22:23], v[186:187] op_sel_hi:[1,0]
    v_cvt_pk_bf16_f32 v0, v0, v1
    v_cvt_pk_bf16_f32 v1, v2, v3
    v_cvt_pk_bf16_f32 v2, v20, v21
    v_cvt_pk_bf16_f32 v3, v22, v23
    ds_write_b128 v228, v[0:3]
    v_pk_mul_f32 v[4:5], v[4:5], v[188:189] op_sel_hi:[1,0]
    v_pk_mul_f32 v[6:7], v[6:7], v[188:189] op_sel_hi:[1,0]
    v_pk_mul_f32 v[24:25], v[24:25], v[188:189] op_sel_hi:[1,0]
    v_pk_mul_f32 v[26:27], v[26:27], v[188:189] op_sel_hi:[1,0]
    v_cvt_pk_bf16_f32 v4, v4, v5
    v_cvt_pk_bf16_f32 v5, v6, v7
    v_cvt_pk_bf16_f32 v6, v24, v25
    v_cvt_pk_bf16_f32 v7, v26, v27
    ds_write_b128 v228, v[4:7] offset:1024
    v_pk_mul_f32 v[8:9], v[8:9], v[190:191] op_sel_hi:[1,0]
    v_pk_mul_f32 v[10:11], v[10:11], v[190:191] op_sel_hi:[1,0]
    v_pk_mul_f32 v[28:29], v[28:29], v[190:191] op_sel_hi:[1,0]
    v_pk_mul_f32 v[30:31], v[30:31], v[190:191] op_sel_hi:[1,0]
    v_cvt_pk_bf16_f32 v8, v8, v9
    v_cvt_pk_bf16_f32 v9, v10, v11
    v_cvt_pk_bf16_f32 v10, v28, v29
    v_cvt_pk_bf16_f32 v11, v30, v31
    ds_write_b128 v228, v[8:11] offset:2048
    v_pk_mul_f32 v[12:13], v[12:13], v[192:193] op_sel_hi:[1,0]
    v_pk_mul_f32 v[14:15], v[14:15], v[192:193] op_sel_hi:[1,0]
    v_pk_mul_f32 v[32:33], v[32:33], v[192:193] op_sel_hi:[1,0]
    v_pk_mul_f32 v[34:35], v[34:35], v[192:193] op_sel_hi:[1,0]
    v_cvt_pk_bf16_f32 v12, v12, v13
    v_cvt_pk_bf16_f32 v13, v14, v15
    v_cvt_pk_bf16_f32 v14, v32, v33
    v_cvt_pk_bf16_f32 v15, v34, v35
    ds_write_b128 v228, v[12:15] offset:3072
    v_pk_mul_f32 v[16:17], v[16:17], v[194:195] op_sel_hi:[1,0]
    v_pk_mul_f32 v[18:19], v[18:19], v[194:195] op_sel_hi:[1,0]
    v_pk_mul_f32 v[36:37], v[36:37], v[194:195] op_sel_hi:[1,0]
    v_pk_mul_f32 v[38:39], v[38:39], v[194:195] op_sel_hi:[1,0]
    v_cvt_pk_bf16_f32 v16, v16, v17
    v_cvt_pk_bf16_f32 v17, v18, v19
    v_cvt_pk_bf16_f32 v18, v36, v37
    v_cvt_pk_bf16_f32 v19, v38, v39
    ds_write_b128 v228, v[16:19] offset:4096
    v_pk_mul_f32 v[40:41], v[40:41], v[186:187] op_sel_hi:[1,0]
    v_pk_mul_f32 v[42:43], v[42:43], v[186:187] op_sel_hi:[1,0]
    v_pk_mul_f32 v[60:61], v[60:61], v[186:187] op_sel_hi:[1,0]
    v_pk_mul_f32 v[62:63], v[62:63], v[186:187] op_sel_hi:[1,0]
    v_cvt_pk_bf16_f32 v40, v40, v41
    v_cvt_pk_bf16_f32 v41, v42, v43
    v_cvt_pk_bf16_f32 v42, v60, v61
    v_cvt_pk_bf16_f32 v43, v62, v63
    ds_write_b128 v228, v[40:43] offset:20480
    v_pk_mul_f32 v[44:45], v[44:45], v[188:189] op_sel_hi:[1,0]
    v_pk_mul_f32 v[46:47], v[46:47], v[188:189] op_sel_hi:[1,0]
    v_pk_mul_f32 v[64:65], v[64:65], v[188:189] op_sel_hi:[1,0]
    v_pk_mul_f32 v[66:67], v[66:67], v[188:189] op_sel_hi:[1,0]
    v_cvt_pk_bf16_f32 v44, v44, v45
    v_cvt_pk_bf16_f32 v45, v46, v47
    v_cvt_pk_bf16_f32 v46, v64, v65
    v_cvt_pk_bf16_f32 v47, v66, v67
    ds_write_b128 v228, v[44:47] offset:21504
    v_pk_mul_f32 v[48:49], v[48:49], v[190:191] op_sel_hi:[1,0]
    v_pk_mul_f32 v[50:51], v[50:51], v[190:191] op_sel_hi:[1,0]
    v_pk_mul_f32 v[68:69], v[68:69], v[190:191] op_sel_hi:[1,0]
    v_pk_mul_f32 v[70:71], v[70:71], v[190:191] op_sel_hi:[1,0]
    v_cvt_pk_bf16_f32 v48, v48, v49
    v_cvt_pk_bf16_f32 v49, v50, v51
    v_cvt_pk_bf16_f32 v50, v68, v69
    v_cvt_pk_bf16_f32 v51, v70, v71
    s_waitcnt lgkmcnt(14)
    ds_write_b128 v228, v[48:51] offset:22528
    v_pk_mul_f32 v[52:53], v[52:53], v[192:193] op_sel_hi:[1,0]
    v_pk_mul_f32 v[54:55], v[54:55], v[192:193] op_sel_hi:[1,0]
    v_pk_mul_f32 v[72:73], v[72:73], v[192:193] op_sel_hi:[1,0]
    v_pk_mul_f32 v[74:75], v[74:75], v[192:193] op_sel_hi:[1,0]
    v_cvt_pk_bf16_f32 v52, v52, v53
    v_cvt_pk_bf16_f32 v53, v54, v55
    v_cvt_pk_bf16_f32 v54, v72, v73
    v_cvt_pk_bf16_f32 v55, v74, v75
    s_waitcnt lgkmcnt(14)
    ds_write_b128 v228, v[52:55] offset:23552
    v_pk_mul_f32 v[56:57], v[56:57], v[194:195] op_sel_hi:[1,0]
    v_pk_mul_f32 v[58:59], v[58:59], v[194:195] op_sel_hi:[1,0]
    v_pk_mul_f32 v[76:77], v[76:77], v[194:195] op_sel_hi:[1,0]
    v_pk_mul_f32 v[78:79], v[78:79], v[194:195] op_sel_hi:[1,0]
    v_cvt_pk_bf16_f32 v56, v56, v57
    v_cvt_pk_bf16_f32 v57, v58, v59
    v_cvt_pk_bf16_f32 v58, v76, v77
    v_cvt_pk_bf16_f32 v59, v78, v79
    s_waitcnt lgkmcnt(14)
    ds_write_b128 v228, v[56:59] offset:24576
    s_waitcnt lgkmcnt(0)
    s_barrier
    ds_read_b128 v[192:195], v224
    ds_read_b128 v[196:199], v224 offset:1024
    ds_read_b128 v[200:203], v224 offset:2048
    ds_read_b128 v[204:207], v224 offset:3072
    ds_read_b128 v[208:211], v224 offset:4096
    s_waitcnt vmcnt(4)
    s_barrier
    s_waitcnt lgkmcnt(4)
    v_mfma_f32_16x16x32_bf16 v[0:3], v[160:163], v[192:195], 0
    ds_read_b64_tr_b16 v[176:177], v233 offset:6144
    ds_read_b64_tr_b16 v[180:181], v234 offset:6144
    v_xor_b32 v238, 64, v237
    v_mfma_f32_16x16x32_bf16 v[20:23], v[164:167], v[192:195], 0
    ds_read_b64_tr_b16 v[184:185], v235 offset:6144
    ds_read_b64_tr_b16 v[188:189], v236 offset:6144
    v_xor_b32 v239, 128, v237
    v_mfma_f32_16x16x32_bf16 v[40:43], v[168:171], v[192:195], 0
    ds_read_b64_tr_b16 v[178:179], v233 offset:47104
    ds_read_b64_tr_b16 v[182:183], v234 offset:47104
    s_mov_b32 s77, 16384
    s_add_u32 m0, s76, 2048
    s_nop 0
    buffer_load_dwordx4 v220, s[52:55], s77 offen nt lds
    buffer_load_dwordx4 v221, s[52:55], s77 offen offset:1024 nt lds
    v_xor_b32 v240, 192, v237
    v_mfma_f32_16x16x32_bf16 v[60:63], v[172:175], v[192:195], 0
    ds_read_b64_tr_b16 v[186:187], v235 offset:47104
    ds_read_b64_tr_b16 v[190:191], v236 offset:47104
    ds_read_b128 v[192:195], v224 offset:5120
    s_mov_b32 s77, 81920
    s_add_u32 m0, s76, 4096
    s_nop 0
    buffer_load_dwordx4 v220, s[52:55], s77 offen nt lds
    buffer_load_dwordx4 v221, s[52:55], s77 offen offset:1024 nt lds
    v_add_u32 v241, 61440, v237
    s_waitcnt lgkmcnt(12)
    v_mfma_f32_16x16x32_bf16 v[4:7], v[160:163], v[196:199], 0
    v_add_u32 v242, 61440, v238
    v_mfma_f32_16x16x32_bf16 v[24:27], v[164:167], v[196:199], 0
    v_add_u32 v244, 130048, v243
    v_mfma_f32_16x16x32_bf16 v[44:47], v[168:171], v[196:199], 0
    v_add_u32 v246, 6144, v245
    v_mfma_f32_16x16x32_bf16 v[64:67], v[172:175], v[196:199], 0
    ds_read_b128 v[196:199], v224 offset:6144
    v_add_u32 v247, 40960, v230
    s_waitcnt lgkmcnt(12)
    v_mfma_f32_16x16x32_bf16 v[8:11], v[160:163], v[200:203], 0
    v_mul_f32 v80, v80, v248
    v_mfma_f32_16x16x32_bf16 v[28:31], v[164:167], v[200:203], 0
    v_mul_f32 v81, v81, v248
    v_mfma_f32_16x16x32_bf16 v[48:51], v[168:171], v[200:203], 0
    v_mul_f32 v82, v82, v248
    v_mfma_f32_16x16x32_bf16 v[68:71], v[172:175], v[200:203], 0
    ds_read_b128 v[200:203], v224 offset:7168
    v_mul_f32 v83, v83, v248
    s_waitcnt lgkmcnt(12)
    v_mfma_f32_16x16x32_bf16 v[12:15], v[160:163], v[204:207], 0
    v_mul_f32 v100, v100, v248
    v_mfma_f32_16x16x32_bf16 v[32:35], v[164:167], v[204:207], 0
    v_mul_f32 v101, v101, v248
    v_mfma_f32_16x16x32_bf16 v[52:55], v[168:171], v[204:207], 0
    v_mul_f32 v102, v102, v248
    v_mfma_f32_16x16x32_bf16 v[72:75], v[172:175], v[204:207], 0
    ds_read_b128 v[204:207], v224 offset:8192
    v_mul_f32 v103, v103, v248
    s_waitcnt lgkmcnt(12)
    v_mfma_f32_16x16x32_bf16 v[16:19], v[160:163], v[208:211], 0
    v_cvt_pk_bf16_f32 v80, v80, v81
    v_mfma_f32_16x16x32_bf16 v[36:39], v[164:167], v[208:211], 0
    v_cvt_pk_bf16_f32 v81, v82, v83
    v_mfma_f32_16x16x32_bf16 v[56:59], v[168:171], v[208:211], 0
    v_cvt_pk_bf16_f32 v82, v100, v101
    v_mfma_f32_16x16x32_bf16 v[76:79], v[172:175], v[208:211], 0
    ds_read_b128 v[208:211], v224 offset:9216
    v_cvt_pk_bf16_f32 v83, v102, v103
    s_waitcnt vmcnt(6)
    s_waitcnt lgkmcnt(5)
    s_barrier
    s_waitcnt lgkmcnt(4)
    v_mfma_f32_16x16x32_bf16 v[0:3], v[176:179], v[192:195], v[0:3]
    ds_read_b64_tr_b16 v[160:161], v233 offset:8192
    ds_read_b64_tr_b16 v[164:165], v234 offset:8192
    v_mul_f32 v84, v84, v249
    v_mfma_f32_16x16x32_bf16 v[20:23], v[180:183], v[192:195], v[20:23]
    ds_read_b64_tr_b16 v[168:169], v235 offset:8192
    ds_read_b64_tr_b16 v[172:173], v236 offset:8192
    v_mul_f32 v85, v85, v249
    v_mfma_f32_16x16x32_bf16 v[40:43], v[184:187], v[192:195], v[40:43]
    ds_read_b64_tr_b16 v[162:163], v233 offset:49152
    ds_read_b64_tr_b16 v[166:167], v234 offset:49152
    s_mov_b32 s77, 147456
    s_add_u32 m0, s76, 6144
    s_nop 0
    buffer_load_dwordx4 v220, s[52:55], s77 offen nt lds
    buffer_load_dwordx4 v221, s[52:55], s77 offen offset:1024 nt lds
    v_mul_f32 v86, v86, v249
    v_mfma_f32_16x16x32_bf16 v[60:63], v[188:191], v[192:195], v[60:63]
    ds_read_b64_tr_b16 v[170:171], v235 offset:49152
    ds_read_b64_tr_b16 v[174:175], v236 offset:49152
    ds_read_b128 v[192:195], v224 offset:10240
    v_mul_f32 v87, v87, v249
    s_waitcnt lgkmcnt(12)
    v_mfma_f32_16x16x32_bf16 v[4:7], v[176:179], v[196:199], v[4:7]
    v_mul_f32 v104, v104, v249
    v_mfma_f32_16x16x32_bf16 v[24:27], v[180:183], v[196:199], v[24:27]
    v_mul_f32 v105, v105, v249
    v_mfma_f32_16x16x32_bf16 v[44:47], v[184:187], v[196:199], v[44:47]
    v_mul_f32 v106, v106, v249
    v_mfma_f32_16x16x32_bf16 v[64:67], v[188:191], v[196:199], v[64:67]
    ds_read_b128 v[196:199], v224 offset:11264
    v_mul_f32 v107, v107, v249
    s_waitcnt lgkmcnt(12)
    v_mfma_f32_16x16x32_bf16 v[8:11], v[176:179], v[200:203], v[8:11]
    v_cvt_pk_bf16_f32 v84, v84, v85
    v_mfma_f32_16x16x32_bf16 v[28:31], v[180:183], v[200:203], v[28:31]
    v_cvt_pk_bf16_f32 v85, v86, v87
    v_mfma_f32_16x16x32_bf16 v[48:51], v[184:187], v[200:203], v[48:51]
    v_cvt_pk_bf16_f32 v86, v104, v105
    v_mfma_f32_16x16x32_bf16 v[68:71], v[188:191], v[200:203], v[68:71]
    ds_read_b128 v[200:203], v224 offset:12288
    v_cvt_pk_bf16_f32 v87, v106, v107
    s_waitcnt lgkmcnt(12)
    v_mfma_f32_16x16x32_bf16 v[12:15], v[176:179], v[204:207], v[12:15]
    v_mul_f32 v88, v88, v250
    v_mfma_f32_16x16x32_bf16 v[32:35], v[180:183], v[204:207], v[32:35]
    v_mul_f32 v89, v89, v250
    v_mfma_f32_16x16x32_bf16 v[52:55], v[184:187], v[204:207], v[52:55]
    v_mul_f32 v90, v90, v250
    v_mfma_f32_16x16x32_bf16 v[72:75], v[188:191], v[204:207], v[72:75]
    ds_read_b128 v[204:207], v224 offset:13312
    v_mul_f32 v91, v91, v250
    s_waitcnt lgkmcnt(12)
    v_mfma_f32_16x16x32_bf16 v[16:19], v[176:179], v[208:211], v[16:19]
    v_mul_f32 v108, v108, v250
    v_mfma_f32_16x16x32_bf16 v[36:39], v[180:183], v[208:211], v[36:39]
    v_mul_f32 v109, v109, v250
    v_mfma_f32_16x16x32_bf16 v[56:59], v[184:187], v[208:211], v[56:59]
    v_mul_f32 v110, v110, v250
    v_mfma_f32_16x16x32_bf16 v[76:79], v[188:191], v[208:211], v[76:79]
    ds_read_b128 v[208:211], v224 offset:14336
    v_mul_f32 v111, v111, v250
    s_waitcnt vmcnt(6)
    s_waitcnt lgkmcnt(5)
    s_barrier
    s_waitcnt lgkmcnt(4)
    v_mfma_f32_16x16x32_bf16 v[0:3], v[160:163], v[192:195], v[0:3]
    ds_read_b64_tr_b16 v[176:177], v233
    ds_read_b64_tr_b16 v[180:181], v234
    v_cvt_pk_bf16_f32 v88, v88, v89
    v_mfma_f32_16x16x32_bf16 v[20:23], v[164:167], v[192:195], v[20:23]
    ds_read_b64_tr_b16 v[184:185], v235
    ds_read_b64_tr_b16 v[188:189], v236
    v_cvt_pk_bf16_f32 v89, v90, v91
    v_mfma_f32_16x16x32_bf16 v[40:43], v[168:171], v[192:195], v[40:43]
    ds_read_b64_tr_b16 v[178:179], v233 offset:40960
    ds_read_b64_tr_b16 v[182:183], v234 offset:40960
    s_mov_b32 s77, 212992
    s_add_u32 m0, s76, 8192
    s_nop 0
    buffer_load_dwordx4 v220, s[52:55], s77 offen nt lds
    buffer_load_dwordx4 v221, s[52:55], s77 offen offset:1024 nt lds
    v_cvt_pk_bf16_f32 v90, v108, v109
    v_mfma_f32_16x16x32_bf16 v[60:63], v[172:175], v[192:195], v[60:63]
    ds_read_b64_tr_b16 v[186:187], v235 offset:40960
    ds_read_b64_tr_b16 v[190:191], v236 offset:40960
    ds_read_b128 v[192:195], v224 offset:15360
    v_cvt_pk_bf16_f32 v91, v110, v111
    s_waitcnt lgkmcnt(12)
    v_mfma_f32_16x16x32_bf16 v[4:7], v[160:163], v[196:199], v[4:7]
    v_mul_f32 v92, v92, v251
    v_mfma_f32_16x16x32_bf16 v[24:27], v[164:167], v[196:199], v[24:27]
    v_mul_f32 v93, v93, v251
    v_mfma_f32_16x16x32_bf16 v[44:47], v[168:171], v[196:199], v[44:47]
    v_mul_f32 v94, v94, v251
    v_mfma_f32_16x16x32_bf16 v[64:67], v[172:175], v[196:199], v[64:67]
    ds_read_b128 v[196:199], v224 offset:16384
    v_mul_f32 v95, v95, v251
    s_waitcnt lgkmcnt(12)
    v_mfma_f32_16x16x32_bf16 v[8:11], v[160:163], v[200:203], v[8:11]
    v_mul_f32 v112, v112, v251
    v_mfma_f32_16x16x32_bf16 v[28:31], v[164:167], v[200:203], v[28:31]
    v_mul_f32 v113, v113, v251
    v_mfma_f32_16x16x32_bf16 v[48:51], v[168:171], v[200:203], v[48:51]
    v_mul_f32 v114, v114, v251
    v_mfma_f32_16x16x32_bf16 v[68:71], v[172:175], v[200:203], v[68:71]
    ds_read_b128 v[200:203], v224 offset:17408
    v_mul_f32 v115, v115, v251
    s_waitcnt lgkmcnt(12)
    v_mfma_f32_16x16x32_bf16 v[12:15], v[160:163], v[204:207], v[12:15]
    v_cvt_pk_bf16_f32 v92, v92, v93
    v_mfma_f32_16x16x32_bf16 v[32:35], v[164:167], v[204:207], v[32:35]
    v_cvt_pk_bf16_f32 v93, v94, v95
    v_mfma_f32_16x16x32_bf16 v[52:55], v[168:171], v[204:207], v[52:55]
    v_cvt_pk_bf16_f32 v94, v112, v113
    v_mfma_f32_16x16x32_bf16 v[72:75], v[172:175], v[204:207], v[72:75]
    ds_read_b128 v[204:207], v224 offset:18432
    v_cvt_pk_bf16_f32 v95, v114, v115
    s_waitcnt lgkmcnt(12)
    v_mfma_f32_16x16x32_bf16 v[16:19], v[160:163], v[208:211], v[16:19]
    v_mul_f32 v96, v96, v252
    v_mfma_f32_16x16x32_bf16 v[36:39], v[164:167], v[208:211], v[36:39]
    v_mul_f32 v97, v97, v252
    v_mfma_f32_16x16x32_bf16 v[56:59], v[168:171], v[208:211], v[56:59]
    v_mul_f32 v98, v98, v252
    v_mfma_f32_16x16x32_bf16 v[76:79], v[172:175], v[208:211], v[76:79]
    ds_read_b128 v[208:211], v224 offset:19456
    v_mul_f32 v99, v99, v252
    s_waitcnt vmcnt(6)
    s_waitcnt lgkmcnt(5)
    s_barrier
    s_waitcnt lgkmcnt(4)
    v_mfma_f32_16x16x32_bf16 v[0:3], v[176:179], v[192:195], v[0:3]
    ds_read_b64_tr_b16 v[160:161], v233 offset:2048
    ds_read_b64_tr_b16 v[164:165], v234 offset:2048
    v_mul_f32 v116, v116, v252
    v_mfma_f32_16x16x32_bf16 v[20:23], v[180:183], v[192:195], v[20:23]
    ds_read_b64_tr_b16 v[168:169], v235 offset:2048
    ds_read_b64_tr_b16 v[172:173], v236 offset:2048
    v_mul_f32 v117, v117, v252
    v_mfma_f32_16x16x32_bf16 v[40:43], v[184:187], v[192:195], v[40:43]
    ds_read_b64_tr_b16 v[162:163], v233 offset:43008
    ds_read_b64_tr_b16 v[166:167], v234 offset:43008
    s_mov_b32 s77, 32768
    s_add_u32 m0, s76, 0
    s_nop 0
    buffer_load_dwordx4 v220, s[52:55], s77 offen nt lds
    buffer_load_dwordx4 v221, s[52:55], s77 offen offset:1024 nt lds
    v_mul_f32 v118, v118, v252
    v_mfma_f32_16x16x32_bf16 v[60:63], v[188:191], v[192:195], v[60:63]
    ds_read_b64_tr_b16 v[170:171], v235 offset:43008
    ds_read_b64_tr_b16 v[174:175], v236 offset:43008
    ds_read_b128 v[192:195], v224 offset:20480
    v_mul_f32 v119, v119, v252
    s_waitcnt lgkmcnt(12)
    v_mfma_f32_16x16x32_bf16 v[4:7], v[176:179], v[196:199], v[4:7]
    v_cvt_pk_bf16_f32 v96, v96, v97
    v_mfma_f32_16x16x32_bf16 v[24:27], v[180:183], v[196:199], v[24:27]
    v_cvt_pk_bf16_f32 v97, v98, v99
    v_mfma_f32_16x16x32_bf16 v[44:47], v[184:187], v[196:199], v[44:47]
    v_cvt_pk_bf16_f32 v98, v116, v117
    v_mfma_f32_16x16x32_bf16 v[64:67], v[188:191], v[196:199], v[64:67]
    ds_read_b128 v[196:199], v224 offset:21504
    v_cvt_pk_bf16_f32 v99, v118, v119
    s_waitcnt lgkmcnt(12)
    v_mfma_f32_16x16x32_bf16 v[8:11], v[176:179], v[200:203], v[8:11]
    v_mfma_f32_16x16x32_bf16 v[28:31], v[180:183], v[200:203], v[28:31]
    v_mfma_f32_16x16x32_bf16 v[48:51], v[184:187], v[200:203], v[48:51]
    v_mfma_f32_16x16x32_bf16 v[68:71], v[188:191], v[200:203], v[68:71]
    ds_read_b128 v[200:203], v224 offset:22528
    s_waitcnt lgkmcnt(12)
    v_mfma_f32_16x16x32_bf16 v[12:15], v[176:179], v[204:207], v[12:15]
    v_mfma_f32_16x16x32_bf16 v[32:35], v[180:183], v[204:207], v[32:35]
    v_mfma_f32_16x16x32_bf16 v[52:55], v[184:187], v[204:207], v[52:55]
    v_mfma_f32_16x16x32_bf16 v[72:75], v[188:191], v[204:207], v[72:75]
    ds_read_b128 v[204:207], v224 offset:23552
    s_waitcnt lgkmcnt(12)
    v_mfma_f32_16x16x32_bf16 v[16:19], v[176:179], v[208:211], v[16:19]
    v_mfma_f32_16x16x32_bf16 v[36:39], v[180:183], v[208:211], v[36:39]
    v_mfma_f32_16x16x32_bf16 v[56:59], v[184:187], v[208:211], v[56:59]
    v_mfma_f32_16x16x32_bf16 v[76:79], v[188:191], v[208:211], v[76:79]
    ds_read_b128 v[208:211], v224 offset:24576
    s_waitcnt vmcnt(6)
    s_waitcnt lgkmcnt(5)
    s_barrier
    s_waitcnt lgkmcnt(4)
    v_mfma_f32_16x16x32_bf16 v[0:3], v[160:163], v[192:195], v[0:3]
    ds_read_b64_tr_b16 v[176:177], v233 offset:4096
    ds_read_b64_tr_b16 v[180:181], v234 offset:4096
    v_mul_f32 v120, v120, v248
    v_mfma_f32_16x16x32_bf16 v[20:23], v[164:167], v[192:195], v[20:23]
    ds_read_b64_tr_b16 v[184:185], v235 offset:4096
    ds_read_b64_tr_b16 v[188:189], v236 offset:4096
    v_mul_f32 v121, v121, v248
    v_mfma_f32_16x16x32_bf16 v[40:43], v[168:171], v[192:195], v[40:43]
    ds_read_b64_tr_b16 v[178:179], v233 offset:45056
    ds_read_b64_tr_b16 v[182:183], v234 offset:45056
    s_mov_b32 s77, 98304
    s_add_u32 m0, s76, 2048
    s_nop 0
    buffer_load_dwordx4 v220, s[52:55], s77 offen nt lds
    buffer_load_dwordx4 v221, s[52:55], s77 offen offset:1024 nt lds
    v_mul_f32 v122, v122, v248
    v_mfma_f32_16x16x32_bf16 v[60:63], v[172:175], v[192:195], v[60:63]
    ds_read_b64_tr_b16 v[186:187], v235 offset:45056
    ds_read_b64_tr_b16 v[190:191], v236 offset:45056
    ds_read_b128 v[192:195], v224 offset:25600
    v_mul_f32 v123, v123, v248
    s_waitcnt lgkmcnt(12)
    v_mfma_f32_16x16x32_bf16 v[4:7], v[160:163], v[196:199], v[4:7]
    v_mul_f32 v140, v140, v248
    v_mfma_f32_16x16x32_bf16 v[24:27], v[164:167], v[196:199], v[24:27]
    v_mul_f32 v141, v141, v248
    v_mfma_f32_16x16x32_bf16 v[44:47], v[168:171], v[196:199], v[44:47]
    v_mul_f32 v142, v142, v248
    v_mfma_f32_16x16x32_bf16 v[64:67], v[172:175], v[196:199], v[64:67]
    ds_read_b128 v[196:199], v224 offset:26624
    v_mul_f32 v143, v143, v248
    s_waitcnt lgkmcnt(12)
    v_mfma_f32_16x16x32_bf16 v[8:11], v[160:163], v[200:203], v[8:11]
    ds_write_b128 v228, v[80:83]
    v_cvt_pk_bf16_f32 v120, v120, v121
    v_mfma_f32_16x16x32_bf16 v[28:31], v[164:167], v[200:203], v[28:31]
    v_cvt_pk_bf16_f32 v121, v122, v123
    v_mfma_f32_16x16x32_bf16 v[48:51], v[168:171], v[200:203], v[48:51]
    v_cvt_pk_bf16_f32 v122, v140, v141
    v_mfma_f32_16x16x32_bf16 v[68:71], v[172:175], v[200:203], v[68:71]
    ds_read_b128 v[200:203], v224 offset:27648
    v_cvt_pk_bf16_f32 v123, v142, v143
    s_waitcnt lgkmcnt(13)
    v_mfma_f32_16x16x32_bf16 v[12:15], v[160:163], v[204:207], v[12:15]
    v_mul_f32 v124, v124, v249
    v_mfma_f32_16x16x32_bf16 v[32:35], v[164:167], v[204:207], v[32:35]
    v_mul_f32 v125, v125, v249
    v_mfma_f32_16x16x32_bf16 v[52:55], v[168:171], v[204:207], v[52:55]
    v_mul_f32 v126, v126, v249
    v_mfma_f32_16x16x32_bf16 v[72:75], v[172:175], v[204:207], v[72:75]
    ds_read_b128 v[204:207], v224 offset:28672
    v_mul_f32 v127, v127, v249
    s_waitcnt lgkmcnt(13)
    v_mfma_f32_16x16x32_bf16 v[16:19], v[160:163], v[208:211], v[16:19]
    v_mul_f32 v144, v144, v249
    v_mfma_f32_16x16x32_bf16 v[36:39], v[164:167], v[208:211], v[36:39]
    v_mul_f32 v145, v145, v249
    v_mfma_f32_16x16x32_bf16 v[56:59], v[168:171], v[208:211], v[56:59]
    ds_write_b128 v228, v[84:87] offset:1024
    v_mul_f32 v146, v146, v249
    v_mfma_f32_16x16x32_bf16 v[76:79], v[172:175], v[208:211], v[76:79]
    ds_read_b128 v[208:211], v224 offset:29696
    v_mul_f32 v147, v147, v249
    s_waitcnt vmcnt(6)
    s_waitcnt lgkmcnt(7)
    s_barrier
    s_waitcnt lgkmcnt(6)
    v_mfma_f32_16x16x32_bf16 v[0:3], v[176:179], v[192:195], v[0:3]
    ds_read_b64_tr_b16 v[160:161], v233 offset:6144
    ds_read_b64_tr_b16 v[164:165], v234 offset:6144
    v_cvt_pk_bf16_f32 v124, v124, v125
    v_mfma_f32_16x16x32_bf16 v[20:23], v[180:183], v[192:195], v[20:23]
    ds_read_b64_tr_b16 v[168:169], v235 offset:6144
    ds_read_b64_tr_b16 v[172:173], v236 offset:6144
    v_cvt_pk_bf16_f32 v125, v126, v127
    v_mfma_f32_16x16x32_bf16 v[40:43], v[184:187], v[192:195], v[40:43]
    ds_read_b64_tr_b16 v[162:163], v233 offset:47104
    ds_read_b64_tr_b16 v[166:167], v234 offset:47104
    s_mov_b32 s77, 163840
    s_add_u32 m0, s76, 4096
    s_nop 0
    buffer_load_dwordx4 v220, s[52:55], s77 offen nt lds
    buffer_load_dwordx4 v221, s[52:55], s77 offen offset:1024 nt lds
    v_cvt_pk_bf16_f32 v126, v144, v145
    v_mfma_f32_16x16x32_bf16 v[60:63], v[188:191], v[192:195], v[60:63]
    ds_read_b64_tr_b16 v[170:171], v235 offset:47104
    ds_read_b64_tr_b16 v[174:175], v236 offset:47104
    ds_read_b128 v[192:195], v224 offset:30720
    v_cvt_pk_bf16_f32 v127, v146, v147
    s_waitcnt lgkmcnt(14)
    v_mfma_f32_16x16x32_bf16 v[4:7], v[176:179], v[196:199], v[4:7]
    v_mul_f32 v128, v128, v250
    v_mfma_f32_16x16x32_bf16 v[24:27], v[180:183], v[196:199], v[24:27]
    v_mul_f32 v129, v129, v250
    v_mfma_f32_16x16x32_bf16 v[44:47], v[184:187], v[196:199], v[44:47]
    v_mul_f32 v130, v130, v250
    v_mfma_f32_16x16x32_bf16 v[64:67], v[188:191], v[196:199], v[64:67]
    ds_read_b128 v[196:199], v224 offset:31744
    v_mul_f32 v131, v131, v250
    s_waitcnt lgkmcnt(13)
    v_mfma_f32_16x16x32_bf16 v[8:11], v[176:179], v[200:203], v[8:11]
    ds_write_b128 v228, v[88:91] offset:2048
    v_mul_f32 v148, v148, v250
    v_mfma_f32_16x16x32_bf16 v[28:31], v[180:183], v[200:203], v[28:31]
    v_mul_f32 v149, v149, v250
    v_mfma_f32_16x16x32_bf16 v[48:51], v[184:187], v[200:203], v[48:51]
    v_mul_f32 v150, v150, v250
    v_mfma_f32_16x16x32_bf16 v[68:71], v[188:191], v[200:203], v[68:71]
    ds_read_b128 v[200:203], v224 offset:32768
    v_mul_f32 v151, v151, v250
    s_waitcnt lgkmcnt(14)
    v_mfma_f32_16x16x32_bf16 v[12:15], v[176:179], v[204:207], v[12:15]
    v_cvt_pk_bf16_f32 v128, v128, v129
    v_mfma_f32_16x16x32_bf16 v[32:35], v[180:183], v[204:207], v[32:35]
    v_cvt_pk_bf16_f32 v129, v130, v131
    v_mfma_f32_16x16x32_bf16 v[52:55], v[184:187], v[204:207], v[52:55]
    v_cvt_pk_bf16_f32 v130, v148, v149
    v_mfma_f32_16x16x32_bf16 v[72:75], v[188:191], v[204:207], v[72:75]
    ds_read_b128 v[204:207], v224 offset:33792
    v_cvt_pk_bf16_f32 v131, v150, v151
    s_waitcnt lgkmcnt(13)
    v_mfma_f32_16x16x32_bf16 v[16:19], v[176:179], v[208:211], v[16:19]
    v_mul_f32 v132, v132, v251
    v_mfma_f32_16x16x32_bf16 v[36:39], v[180:183], v[208:211], v[36:39]
    v_mul_f32 v133, v133, v251
    v_mfma_f32_16x16x32_bf16 v[56:59], v[184:187], v[208:211], v[56:59]
    ds_write_b128 v228, v[92:95] offset:3072
    v_mul_f32 v134, v134, v251
    v_mfma_f32_16x16x32_bf16 v[76:79], v[188:191], v[208:211], v[76:79]
    ds_read_b128 v[208:211], v224 offset:34816
    v_mul_f32 v135, v135, v251
    s_waitcnt vmcnt(6)
    s_waitcnt lgkmcnt(7)
    s_barrier
    s_waitcnt lgkmcnt(6)
    v_mfma_f32_16x16x32_bf16 v[0:3], v[160:163], v[192:195], v[0:3]
    ds_read_b64_tr_b16 v[176:177], v233 offset:8192
    ds_read_b64_tr_b16 v[180:181], v234 offset:8192
    v_mul_f32 v152, v152, v251
    v_mfma_f32_16x16x32_bf16 v[20:23], v[164:167], v[192:195], v[20:23]
    ds_read_b64_tr_b16 v[184:185], v235 offset:8192
    ds_read_b64_tr_b16 v[188:189], v236 offset:8192
    v_mul_f32 v153, v153, v251
    v_mfma_f32_16x16x32_bf16 v[40:43], v[168:171], v[192:195], v[40:43]
    ds_read_b64_tr_b16 v[178:179], v233 offset:49152
    ds_read_b64_tr_b16 v[182:183], v234 offset:49152
    s_mov_b32 s77, 229376
    s_add_u32 m0, s76, 6144
    s_nop 0
    buffer_load_dwordx4 v220, s[52:55], s77 offen nt lds
    buffer_load_dwordx4 v221, s[52:55], s77 offen offset:1024 nt lds
    v_mul_f32 v154, v154, v251
    v_mfma_f32_16x16x32_bf16 v[60:63], v[172:175], v[192:195], v[60:63]
    ds_read_b64_tr_b16 v[186:187], v235 offset:49152
    ds_read_b64_tr_b16 v[190:191], v236 offset:49152
    ds_read_b128 v[192:195], v224 offset:35840
    v_mul_f32 v155, v155, v251
    s_waitcnt lgkmcnt(14)
    v_mfma_f32_16x16x32_bf16 v[4:7], v[160:163], v[196:199], v[4:7]
    v_cvt_pk_bf16_f32 v132, v132, v133
    v_mfma_f32_16x16x32_bf16 v[24:27], v[164:167], v[196:199], v[24:27]
    v_cvt_pk_bf16_f32 v133, v134, v135
    v_mfma_f32_16x16x32_bf16 v[44:47], v[168:171], v[196:199], v[44:47]
    v_cvt_pk_bf16_f32 v134, v152, v153
    v_mfma_f32_16x16x32_bf16 v[64:67], v[172:175], v[196:199], v[64:67]
    ds_read_b128 v[196:199], v224 offset:36864
    v_cvt_pk_bf16_f32 v135, v154, v155
    s_waitcnt lgkmcnt(13)
    v_mfma_f32_16x16x32_bf16 v[8:11], v[160:163], v[200:203], v[8:11]
    ds_write_b128 v228, v[96:99] offset:4096
    v_mul_f32 v136, v136, v252
    v_mfma_f32_16x16x32_bf16 v[28:31], v[164:167], v[200:203], v[28:31]
    v_mul_f32 v137, v137, v252
    v_mfma_f32_16x16x32_bf16 v[48:51], v[168:171], v[200:203], v[48:51]
    v_mul_f32 v138, v138, v252
    v_mfma_f32_16x16x32_bf16 v[68:71], v[172:175], v[200:203], v[68:71]
    ds_read_b128 v[200:203], v224 offset:37888
    v_mul_f32 v139, v139, v252
    s_waitcnt lgkmcnt(14)
    v_mfma_f32_16x16x32_bf16 v[12:15], v[160:163], v[204:207], v[12:15]
    v_mul_f32 v156, v156, v252
    v_mfma_f32_16x16x32_bf16 v[32:35], v[164:167], v[204:207], v[32:35]
    v_mul_f32 v157, v157, v252
    v_mfma_f32_16x16x32_bf16 v[52:55], v[168:171], v[204:207], v[52:55]
    v_mul_f32 v158, v158, v252
    v_mfma_f32_16x16x32_bf16 v[72:75], v[172:175], v[204:207], v[72:75]
    ds_read_b128 v[204:207], v224 offset:38912
    v_mul_f32 v159, v159, v252
    s_waitcnt lgkmcnt(13)
    v_mfma_f32_16x16x32_bf16 v[16:19], v[160:163], v[208:211], v[16:19]
    v_cvt_pk_bf16_f32 v136, v136, v137
    v_mfma_f32_16x16x32_bf16 v[36:39], v[164:167], v[208:211], v[36:39]
    v_cvt_pk_bf16_f32 v137, v138, v139
    v_mfma_f32_16x16x32_bf16 v[56:59], v[168:171], v[208:211], v[56:59]
    v_cvt_pk_bf16_f32 v138, v156, v157
    v_mfma_f32_16x16x32_bf16 v[76:79], v[172:175], v[208:211], v[76:79]
    ds_read_b128 v[208:211], v224 offset:39936
    v_cvt_pk_bf16_f32 v139, v158, v159
    s_waitcnt vmcnt(6)
    s_waitcnt lgkmcnt(3)
    s_barrier
    v_mfma_f32_16x16x32_bf16 v[0:3], v[176:179], v[192:195], v[0:3]
    ds_read_b64_tr_b16 v[160:161], v233
    ds_read_b64_tr_b16 v[164:165], v234
    v_mfma_f32_16x16x32_bf16 v[20:23], v[180:183], v[192:195], v[20:23]
    ds_read_b64_tr_b16 v[168:169], v235
    ds_read_b64_tr_b16 v[172:173], v236
    v_mfma_f32_16x16x32_bf16 v[40:43], v[184:187], v[192:195], v[40:43]
    ds_read_b64_tr_b16 v[162:163], v233 offset:40960
    ds_read_b64_tr_b16 v[166:167], v234 offset:40960
    s_mov_b32 s77, 49152
    s_add_u32 m0, s76, 8192
    s_nop 0
    buffer_load_dwordx4 v220, s[52:55], s77 offen nt lds
    buffer_load_dwordx4 v221, s[52:55], s77 offen offset:1024 nt lds
    v_mfma_f32_16x16x32_bf16 v[60:63], v[188:191], v[192:195], v[60:63]
    ds_read_b64_tr_b16 v[170:171], v235 offset:40960
    ds_read_b64_tr_b16 v[174:175], v236 offset:40960
    ds_read_b128 v[192:195], v224
    v_mfma_f32_16x16x32_bf16 v[4:7], v[176:179], v[196:199], v[4:7]
    v_mfma_f32_16x16x32_bf16 v[24:27], v[180:183], v[196:199], v[24:27]
    v_mfma_f32_16x16x32_bf16 v[44:47], v[184:187], v[196:199], v[44:47]
    v_mfma_f32_16x16x32_bf16 v[64:67], v[188:191], v[196:199], v[64:67]
    ds_read_b128 v[196:199], v224 offset:1024
    s_waitcnt lgkmcnt(12)
    v_mfma_f32_16x16x32_bf16 v[8:11], v[176:179], v[200:203], v[8:11]
    v_mfma_f32_16x16x32_bf16 v[28:31], v[180:183], v[200:203], v[28:31]
    v_mfma_f32_16x16x32_bf16 v[48:51], v[184:187], v[200:203], v[48:51]
    v_mfma_f32_16x16x32_bf16 v[68:71], v[188:191], v[200:203], v[68:71]
    ds_read_b128 v[200:203], v224 offset:2048
    s_waitcnt lgkmcnt(12)
    v_mfma_f32_16x16x32_bf16 v[12:15], v[176:179], v[204:207], v[12:15]
    v_mfma_f32_16x16x32_bf16 v[32:35], v[180:183], v[204:207], v[32:35]
    v_mfma_f32_16x16x32_bf16 v[52:55], v[184:187], v[204:207], v[52:55]
    v_mfma_f32_16x16x32_bf16 v[72:75], v[188:191], v[204:207], v[72:75]
    ds_read_b128 v[204:207], v224 offset:3072
    s_waitcnt lgkmcnt(12)
    v_mfma_f32_16x16x32_bf16 v[16:19], v[176:179], v[208:211], v[16:19]
    v_mfma_f32_16x16x32_bf16 v[36:39], v[180:183], v[208:211], v[36:39]
    v_mfma_f32_16x16x32_bf16 v[56:59], v[184:187], v[208:211], v[56:59]
    v_mfma_f32_16x16x32_bf16 v[76:79], v[188:191], v[208:211], v[76:79]
    ds_read_b128 v[208:211], v224 offset:4096
    s_waitcnt vmcnt(6)
    s_waitcnt lgkmcnt(5)
    s_barrier
    s_waitcnt lgkmcnt(4)
    v_mfma_f32_16x16x32_bf16 v[0:3], v[160:163], v[192:195], v[0:3]
    ds_read_b64_tr_b16 v[176:177], v233 offset:2048
    ds_read_b64_tr_b16 v[180:181], v234 offset:2048
    v_mfma_f32_16x16x32_bf16 v[20:23], v[164:167], v[192:195], v[20:23]
    ds_read_b64_tr_b16 v[184:185], v235 offset:2048
    ds_read_b64_tr_b16 v[188:189], v236 offset:2048
    v_mfma_f32_16x16x32_bf16 v[40:43], v[168:171], v[192:195], v[40:43]
    ds_read_b64_tr_b16 v[178:179], v233 offset:43008
    ds_read_b64_tr_b16 v[182:183], v234 offset:43008
    s_mov_b32 s77, 114688
    s_add_u32 m0, s76, 0
    s_nop 0
    buffer_load_dwordx4 v220, s[52:55], s77 offen nt lds
    buffer_load_dwordx4 v221, s[52:55], s77 offen offset:1024 nt lds
    v_mfma_f32_16x16x32_bf16 v[60:63], v[172:175], v[192:195], v[60:63]
    ds_read_b64_tr_b16 v[186:187], v235 offset:43008
    ds_read_b64_tr_b16 v[190:191], v236 offset:43008
    ds_read_b128 v[192:195], v224 offset:5120
    s_waitcnt lgkmcnt(12)
    v_mfma_f32_16x16x32_bf16 v[4:7], v[160:163], v[196:199], v[4:7]
    v_mfma_f32_16x16x32_bf16 v[24:27], v[164:167], v[196:199], v[24:27]
    v_mfma_f32_16x16x32_bf16 v[44:47], v[168:171], v[196:199], v[44:47]
    v_mfma_f32_16x16x32_bf16 v[64:67], v[172:175], v[196:199], v[64:67]
    ds_read_b128 v[196:199], v224 offset:6144
    s_waitcnt lgkmcnt(12)
    v_mfma_f32_16x16x32_bf16 v[8:11], v[160:163], v[200:203], v[8:11]
    ds_write_b128 v228, v[120:123] offset:20480
    v_mfma_f32_16x16x32_bf16 v[28:31], v[164:167], v[200:203], v[28:31]
    v_mfma_f32_16x16x32_bf16 v[48:51], v[168:171], v[200:203], v[48:51]
    v_mfma_f32_16x16x32_bf16 v[68:71], v[172:175], v[200:203], v[68:71]
    ds_read_b128 v[200:203], v224 offset:7168
    s_waitcnt lgkmcnt(13)
    v_mfma_f32_16x16x32_bf16 v[12:15], v[160:163], v[204:207], v[12:15]
    v_mfma_f32_16x16x32_bf16 v[32:35], v[164:167], v[204:207], v[32:35]
    v_mfma_f32_16x16x32_bf16 v[52:55], v[168:171], v[204:207], v[52:55]
    v_mfma_f32_16x16x32_bf16 v[72:75], v[172:175], v[204:207], v[72:75]
    ds_read_b128 v[204:207], v224 offset:8192
    s_waitcnt lgkmcnt(13)
    v_mfma_f32_16x16x32_bf16 v[16:19], v[160:163], v[208:211], v[16:19]
    v_mfma_f32_16x16x32_bf16 v[36:39], v[164:167], v[208:211], v[36:39]
    v_mfma_f32_16x16x32_bf16 v[56:59], v[168:171], v[208:211], v[56:59]
    ds_write_b128 v228, v[124:127] offset:21504
    v_mfma_f32_16x16x32_bf16 v[76:79], v[172:175], v[208:211], v[76:79]
    ds_read_b128 v[208:211], v224 offset:9216
    s_waitcnt vmcnt(6)
    s_waitcnt lgkmcnt(7)
    s_barrier
    s_waitcnt lgkmcnt(6)
    v_mfma_f32_16x16x32_bf16 v[0:3], v[176:179], v[192:195], v[0:3]
    ds_read_b64_tr_b16 v[160:161], v233 offset:4096
    ds_read_b64_tr_b16 v[164:165], v234 offset:4096
    v_mfma_f32_16x16x32_bf16 v[20:23], v[180:183], v[192:195], v[20:23]
    ds_read_b64_tr_b16 v[168:169], v235 offset:4096
    ds_read_b64_tr_b16 v[172:173], v236 offset:4096
    v_mfma_f32_16x16x32_bf16 v[40:43], v[184:187], v[192:195], v[40:43]
    ds_read_b64_tr_b16 v[162:163], v233 offset:45056
    ds_read_b64_tr_b16 v[166:167], v234 offset:45056
    s_mov_b32 s77, 180224
    s_add_u32 m0, s76, 2048
    s_nop 0
    buffer_load_dwordx4 v220, s[52:55], s77 offen nt lds
    buffer_load_dwordx4 v221, s[52:55], s77 offen offset:1024 nt lds
    v_mfma_f32_16x16x32_bf16 v[60:63], v[188:191], v[192:195], v[60:63]
    ds_read_b64_tr_b16 v[170:171], v235 offset:45056
    ds_read_b64_tr_b16 v[174:175], v236 offset:45056
    ds_read_b128 v[192:195], v224 offset:10240
    s_waitcnt lgkmcnt(14)
    v_mfma_f32_16x16x32_bf16 v[4:7], v[176:179], v[196:199], v[4:7]
    v_mfma_f32_16x16x32_bf16 v[24:27], v[180:183], v[196:199], v[24:27]
    v_mfma_f32_16x16x32_bf16 v[44:47], v[184:187], v[196:199], v[44:47]
    v_mfma_f32_16x16x32_bf16 v[64:67], v[188:191], v[196:199], v[64:67]
    ds_read_b128 v[196:199], v224 offset:11264
    s_waitcnt lgkmcnt(13)
    v_mfma_f32_16x16x32_bf16 v[8:11], v[176:179], v[200:203], v[8:11]
    ds_write_b128 v228, v[128:131] offset:22528
    v_mfma_f32_16x16x32_bf16 v[28:31], v[180:183], v[200:203], v[28:31]
    v_mfma_f32_16x16x32_bf16 v[48:51], v[184:187], v[200:203], v[48:51]
    v_mfma_f32_16x16x32_bf16 v[68:71], v[188:191], v[200:203], v[68:71]
    ds_read_b128 v[200:203], v224 offset:12288
    s_waitcnt lgkmcnt(14)
    v_mfma_f32_16x16x32_bf16 v[12:15], v[176:179], v[204:207], v[12:15]
    v_mfma_f32_16x16x32_bf16 v[32:35], v[180:183], v[204:207], v[32:35]
    v_mfma_f32_16x16x32_bf16 v[52:55], v[184:187], v[204:207], v[52:55]
    v_mfma_f32_16x16x32_bf16 v[72:75], v[188:191], v[204:207], v[72:75]
    ds_read_b128 v[204:207], v224 offset:13312
    s_waitcnt lgkmcnt(13)
    v_mfma_f32_16x16x32_bf16 v[16:19], v[176:179], v[208:211], v[16:19]
    v_mfma_f32_16x16x32_bf16 v[36:39], v[180:183], v[208:211], v[36:39]
    v_mfma_f32_16x16x32_bf16 v[56:59], v[184:187], v[208:211], v[56:59]
    ds_write_b128 v228, v[132:135] offset:23552
    v_mfma_f32_16x16x32_bf16 v[76:79], v[188:191], v[208:211], v[76:79]
    ds_read_b128 v[208:211], v224 offset:14336
    s_waitcnt vmcnt(6)
    s_waitcnt lgkmcnt(7)
    s_barrier
    s_waitcnt lgkmcnt(6)
    v_mfma_f32_16x16x32_bf16 v[0:3], v[160:163], v[192:195], v[0:3]
    ds_read_b64_tr_b16 v[176:177], v233 offset:6144
    ds_read_b64_tr_b16 v[180:181], v234 offset:6144
    v_mfma_f32_16x16x32_bf16 v[20:23], v[164:167], v[192:195], v[20:23]
    ds_read_b64_tr_b16 v[184:185], v235 offset:6144
    ds_read_b64_tr_b16 v[188:189], v236 offset:6144
    v_mfma_f32_16x16x32_bf16 v[40:43], v[168:171], v[192:195], v[40:43]
    ds_read_b64_tr_b16 v[178:179], v233 offset:47104
    ds_read_b64_tr_b16 v[182:183], v234 offset:47104
    s_mov_b32 s77, 245760
    s_add_u32 m0, s76, 4096
    s_nop 0
    buffer_load_dwordx4 v220, s[52:55], s77 offen nt lds
    buffer_load_dwordx4 v221, s[52:55], s77 offen offset:1024 nt lds
    v_mfma_f32_16x16x32_bf16 v[60:63], v[172:175], v[192:195], v[60:63]
    ds_read_b64_tr_b16 v[186:187], v235 offset:47104
    ds_read_b64_tr_b16 v[190:191], v236 offset:47104
    ds_read_b128 v[192:195], v224 offset:15360
    s_waitcnt lgkmcnt(14)
    v_mfma_f32_16x16x32_bf16 v[4:7], v[160:163], v[196:199], v[4:7]
    v_mfma_f32_16x16x32_bf16 v[24:27], v[164:167], v[196:199], v[24:27]
    v_mfma_f32_16x16x32_bf16 v[44:47], v[168:171], v[196:199], v[44:47]
    v_mfma_f32_16x16x32_bf16 v[64:67], v[172:175], v[196:199], v[64:67]
    ds_read_b128 v[196:199], v224 offset:16384
    s_waitcnt lgkmcnt(13)
    v_mfma_f32_16x16x32_bf16 v[8:11], v[160:163], v[200:203], v[8:11]
    ds_write_b128 v228, v[136:139] offset:24576
    v_mfma_f32_16x16x32_bf16 v[28:31], v[164:167], v[200:203], v[28:31]
    v_mfma_f32_16x16x32_bf16 v[48:51], v[168:171], v[200:203], v[48:51]
    v_mfma_f32_16x16x32_bf16 v[68:71], v[172:175], v[200:203], v[68:71]
    ds_read_b128 v[200:203], v224 offset:17408
    s_waitcnt lgkmcnt(14)
    v_mfma_f32_16x16x32_bf16 v[12:15], v[160:163], v[204:207], v[12:15]
    v_mfma_f32_16x16x32_bf16 v[32:35], v[164:167], v[204:207], v[32:35]
    v_mfma_f32_16x16x32_bf16 v[52:55], v[168:171], v[204:207], v[52:55]
    v_mfma_f32_16x16x32_bf16 v[72:75], v[172:175], v[204:207], v[72:75]
    ds_read_b128 v[204:207], v224 offset:18432
    s_waitcnt lgkmcnt(13)
    v_mfma_f32_16x16x32_bf16 v[16:19], v[160:163], v[208:211], v[16:19]
    v_mfma_f32_16x16x32_bf16 v[36:39], v[164:167], v[208:211], v[36:39]
    v_mfma_f32_16x16x32_bf16 v[56:59], v[168:171], v[208:211], v[56:59]
    v_mfma_f32_16x16x32_bf16 v[76:79], v[172:175], v[208:211], v[76:79]
    ds_read_b128 v[208:211], v224 offset:19456
    s_waitcnt vmcnt(6)
    s_waitcnt lgkmcnt(3)
    s_barrier
    v_mfma_f32_16x16x32_bf16 v[0:3], v[176:179], v[192:195], v[0:3]
    ds_read_b64_tr_b16 v[160:161], v233 offset:8192
    ds_read_b64_tr_b16 v[164:165], v234 offset:8192
    v_mfma_f32_16x16x32_bf16 v[20:23], v[180:183], v[192:195], v[20:23]
    ds_read_b64_tr_b16 v[168:169], v235 offset:8192
    ds_read_b64_tr_b16 v[172:173], v236 offset:8192
    v_mfma_f32_16x16x32_bf16 v[40:43], v[184:187], v[192:195], v[40:43]
    ds_read_b64_tr_b16 v[162:163], v233 offset:49152
    ds_read_b64_tr_b16 v[166:167], v234 offset:49152
    s_add_u32 s99, s99, 28672
    s_sub_u32 s77, s99, 458752
    s_cselect_b32 s99, s99, s77
    s_add_u32 s77, s99, 0
    s_add_u32 m0, s76, 6144
    s_nop 0
    buffer_load_dwordx4 v245, s[56:59], s77 offen lds
    buffer_load_dwordx4 v246, s[56:59], s77 offen offset:1024 lds
    v_mfma_f32_16x16x32_bf16 v[60:63], v[188:191], v[192:195], v[60:63]
    ds_read_b64_tr_b16 v[170:171], v235 offset:49152
    ds_read_b64_tr_b16 v[174:175], v236 offset:49152
    ds_read_b128 v[192:195], v224 offset:20480
    v_mfma_f32_16x16x32_bf16 v[4:7], v[176:179], v[196:199], v[4:7]
    v_mfma_f32_16x16x32_bf16 v[24:27], v[180:183], v[196:199], v[24:27]
    v_mfma_f32_16x16x32_bf16 v[44:47], v[184:187], v[196:199], v[44:47]
    v_mfma_f32_16x16x32_bf16 v[64:67], v[188:191], v[196:199], v[64:67]
    ds_read_b128 v[196:199], v224 offset:21504
    s_waitcnt lgkmcnt(12)
    v_mfma_f32_16x16x32_bf16 v[8:11], v[176:179], v[200:203], v[8:11]
    v_mfma_f32_16x16x32_bf16 v[28:31], v[180:183], v[200:203], v[28:31]
    v_mfma_f32_16x16x32_bf16 v[48:51], v[184:187], v[200:203], v[48:51]
    v_mfma_f32_16x16x32_bf16 v[68:71], v[188:191], v[200:203], v[68:71]
    ds_read_b128 v[200:203], v224 offset:22528
    s_waitcnt lgkmcnt(12)
    v_mfma_f32_16x16x32_bf16 v[12:15], v[176:179], v[204:207], v[12:15]
    v_mfma_f32_16x16x32_bf16 v[32:35], v[180:183], v[204:207], v[32:35]
    v_mfma_f32_16x16x32_bf16 v[52:55], v[184:187], v[204:207], v[52:55]
    v_mfma_f32_16x16x32_bf16 v[72:75], v[188:191], v[204:207], v[72:75]
    ds_read_b128 v[204:207], v224 offset:23552
    s_waitcnt lgkmcnt(12)
    v_mfma_f32_16x16x32_bf16 v[16:19], v[176:179], v[208:211], v[16:19]
    v_mfma_f32_16x16x32_bf16 v[36:39], v[180:183], v[208:211], v[36:39]
    v_mfma_f32_16x16x32_bf16 v[56:59], v[184:187], v[208:211], v[56:59]
    v_mfma_f32_16x16x32_bf16 v[76:79], v[188:191], v[208:211], v[76:79]
    ds_read_b128 v[208:211], v224 offset:24576
    s_waitcnt vmcnt(6)
    s_waitcnt lgkmcnt(5)
    s_barrier
    s_waitcnt lgkmcnt(4)
    v_mfma_f32_16x16x32_bf16 v[0:3], v[160:163], v[192:195], v[0:3]
    ds_read_b64_tr_b16 v[176:177], v233
    ds_read_b64_tr_b16 v[180:181], v234
    v_mfma_f32_16x16x32_bf16 v[20:23], v[164:167], v[192:195], v[20:23]
    ds_read_b64_tr_b16 v[184:185], v235
    ds_read_b64_tr_b16 v[188:189], v236
    ds_read_b128 v[140:143], v224 offset:35840
    v_mfma_f32_16x16x32_bf16 v[40:43], v[168:171], v[192:195], v[40:43]
    ds_read_b64_tr_b16 v[178:179], v233 offset:40960
    ds_read_b64_tr_b16 v[182:183], v234 offset:40960
    s_add_u32 s77, s99, 14336
    s_add_u32 m0, s76, 8192
    s_nop 0
    buffer_load_dwordx4 v245, s[56:59], s77 offen lds
    buffer_load_dwordx4 v246, s[56:59], s77 offen offset:1024 lds
    v_mfma_f32_16x16x32_bf16 v[60:63], v[172:175], v[192:195], v[60:63]
    ds_read_b64_tr_b16 v[186:187], v235 offset:40960
    ds_read_b64_tr_b16 v[190:191], v236 offset:40960
    ds_read_b128 v[192:195], v224 offset:25600
    s_waitcnt lgkmcnt(13)
    v_mfma_f32_16x16x32_bf16 v[4:7], v[160:163], v[196:199], v[4:7]
    v_mfma_f32_16x16x32_bf16 v[24:27], v[164:167], v[196:199], v[24:27]
    ds_read_b128 v[144:147], v224 offset:36864
    v_mfma_f32_16x16x32_bf16 v[44:47], v[168:171], v[196:199], v[44:47]
    v_mfma_f32_16x16x32_bf16 v[64:67], v[172:175], v[196:199], v[64:67]
    ds_read_b128 v[196:199], v224 offset:26624
    s_waitcnt lgkmcnt(14)
    v_mfma_f32_16x16x32_bf16 v[8:11], v[160:163], v[200:203], v[8:11]
    v_mfma_f32_16x16x32_bf16 v[28:31], v[164:167], v[200:203], v[28:31]
    ds_read_b128 v[148:151], v224 offset:37888
    v_mfma_f32_16x16x32_bf16 v[48:51], v[168:171], v[200:203], v[48:51]
    v_mfma_f32_16x16x32_bf16 v[68:71], v[172:175], v[200:203], v[68:71]
    s_waitcnt lgkmcnt(14)
    ds_read_b128 v[200:203], v224 offset:27648
    v_mfma_f32_16x16x32_bf16 v[12:15], v[160:163], v[204:207], v[12:15]
    v_mfma_f32_16x16x32_bf16 v[32:35], v[164:167], v[204:207], v[32:35]
    s_waitcnt lgkmcnt(14)
    ds_read_b128 v[152:155], v224 offset:38912
    v_mfma_f32_16x16x32_bf16 v[52:55], v[168:171], v[204:207], v[52:55]
    v_mfma_f32_16x16x32_bf16 v[72:75], v[172:175], v[204:207], v[72:75]
    s_waitcnt lgkmcnt(14)
    ds_read_b128 v[204:207], v224 offset:28672
    v_mfma_f32_16x16x32_bf16 v[16:19], v[160:163], v[208:211], v[16:19]
    v_mfma_f32_16x16x32_bf16 v[36:39], v[164:167], v[208:211], v[36:39]
    s_waitcnt lgkmcnt(14)
    ds_read_b128 v[156:159], v224 offset:39936
    v_mfma_f32_16x16x32_bf16 v[56:59], v[168:171], v[208:211], v[56:59]
    v_mfma_f32_16x16x32_bf16 v[76:79], v[172:175], v[208:211], v[76:79]
    s_waitcnt lgkmcnt(14)
    ds_read_b128 v[208:211], v224 offset:29696
    s_waitcnt vmcnt(6)
    s_waitcnt lgkmcnt(9)
    s_barrier
    s_waitcnt lgkmcnt(8)
    v_mfma_f32_16x16x32_bf16 v[0:3], v[176:179], v[192:195], v[0:3]
    ds_read_b64_tr_b16 v[160:161], v233 offset:2048
    ds_read_b64_tr_b16 v[164:165], v234 offset:2048
    v_mfma_f32_16x16x32_bf16 v[20:23], v[180:183], v[192:195], v[20:23]
    ds_read_b64_tr_b16 v[168:169], v235 offset:2048
    ds_read_b64_tr_b16 v[172:173], v236 offset:2048
    v_mfma_f32_16x16x32_bf16 v[40:43], v[184:187], v[192:195], v[40:43]
    ds_read_b64_tr_b16 v[162:163], v233 offset:43008
    ds_read_b64_tr_b16 v[166:167], v234 offset:43008
    s_add_u32 s99, s99, 28672
    s_sub_u32 s77, s99, 458752
    s_cselect_b32 s99, s99, s77
    s_add_u32 s77, s99, 0
    s_add_u32 m0, s76, 0
    s_nop 0
    buffer_load_dwordx4 v245, s[56:59], s77 offen lds
    buffer_load_dwordx4 v246, s[56:59], s77 offen offset:1024 lds
    v_mfma_f32_16x16x32_bf16 v[60:63], v[188:191], v[192:195], v[60:63]
    ds_read_b64_tr_b16 v[170:171], v235 offset:43008
    s_waitcnt lgkmcnt(14)
    ds_read_b64_tr_b16 v[174:175], v236 offset:43008
    s_waitcnt lgkmcnt(14)
    ds_read_b128 v[192:195], v224 offset:30720
    v_mfma_f32_16x16x32_bf16 v[4:7], v[176:179], v[196:199], v[4:7]
    v_mfma_f32_16x16x32_bf16 v[24:27], v[180:183], v[196:199], v[24:27]
    v_mfma_f32_16x16x32_bf16 v[44:47], v[184:187], v[196:199], v[44:47]
    v_mfma_f32_16x16x32_bf16 v[64:67], v[188:191], v[196:199], v[64:67]
    s_waitcnt lgkmcnt(14)
    ds_read_b128 v[196:199], v224 offset:31744
    s_waitcnt lgkmcnt(14)
    v_mfma_f32_16x16x32_bf16 v[8:11], v[176:179], v[200:203], v[8:11]
    v_mfma_f32_16x16x32_bf16 v[28:31], v[180:183], v[200:203], v[28:31]
    v_mfma_f32_16x16x32_bf16 v[48:51], v[184:187], v[200:203], v[48:51]
    v_mfma_f32_16x16x32_bf16 v[68:71], v[188:191], v[200:203], v[68:71]
    ds_read_b128 v[200:203], v224 offset:32768
    s_waitcnt lgkmcnt(13)
    v_mfma_f32_16x16x32_bf16 v[12:15], v[176:179], v[204:207], v[12:15]
    v_mfma_f32_16x16x32_bf16 v[32:35], v[180:183], v[204:207], v[32:35]
    v_mfma_f32_16x16x32_bf16 v[52:55], v[184:187], v[204:207], v[52:55]
    v_mfma_f32_16x16x32_bf16 v[72:75], v[188:191], v[204:207], v[72:75]
    ds_read_b128 v[204:207], v224 offset:33792
    s_waitcnt lgkmcnt(12)
    v_mfma_f32_16x16x32_bf16 v[16:19], v[176:179], v[208:211], v[16:19]
    v_mfma_f32_16x16x32_bf16 v[36:39], v[180:183], v[208:211], v[36:39]
    v_mfma_f32_16x16x32_bf16 v[56:59], v[184:187], v[208:211], v[56:59]
    v_mfma_f32_16x16x32_bf16 v[76:79], v[188:191], v[208:211], v[76:79]
    ds_read_b128 v[208:211], v224 offset:34816
    s_waitcnt vmcnt(6)
    s_waitcnt lgkmcnt(5)
    s_barrier
    s_waitcnt lgkmcnt(4)
    v_mfma_f32_16x16x32_bf16 v[0:3], v[160:163], v[192:195], v[0:3]
    ds_read_b64_tr_b16 v[176:177], v233 offset:4096
    ds_read_b64_tr_b16 v[180:181], v234 offset:4096
    v_mfma_f32_16x16x32_bf16 v[20:23], v[164:167], v[192:195], v[20:23]
    ds_read_b64_tr_b16 v[184:185], v235 offset:4096
    ds_read_b64_tr_b16 v[188:189], v236 offset:4096
    v_mfma_f32_16x16x32_bf16 v[40:43], v[168:171], v[192:195], v[40:43]
    ds_read_b64_tr_b16 v[178:179], v233 offset:45056
    ds_read_b64_tr_b16 v[182:183], v234 offset:45056
    v_mfma_f32_16x16x32_bf16 v[60:63], v[172:175], v[192:195], v[60:63]
    ds_read_b64_tr_b16 v[186:187], v235 offset:45056
    ds_read_b64_tr_b16 v[190:191], v236 offset:45056
    s_waitcnt lgkmcnt(11)
    v_mfma_f32_16x16x32_bf16 v[4:7], v[160:163], v[196:199], v[4:7]
    s_add_u32 s77, s99, 14336
    s_add_u32 m0, s76, 2048
    s_nop 0
    buffer_load_dwordx4 v245, s[56:59], s77 offen lds
    buffer_load_dwordx4 v246, s[56:59], s77 offen offset:1024 lds
    v_mfma_f32_16x16x32_bf16 v[24:27], v[164:167], v[196:199], v[24:27]
    v_add_u32 v233, s93, v233
    v_add_u32 v234, s93, v234
    v_add_u32 v235, s93, v235
    v_add_u32 v236, s93, v236
    v_mfma_f32_16x16x32_bf16 v[44:47], v[168:171], v[196:199], v[44:47]
    v_mfma_f32_16x16x32_bf16 v[64:67], v[172:175], v[196:199], v[64:67]
    s_waitcnt lgkmcnt(0)
    s_barrier
    v_mfma_f32_16x16x32_bf16 v[0:3], v[176:179], v[140:143], v[0:3]
    s_add_u32 s99, s99, 28672
    s_sub_u32 s77, s99, 458752
    s_cselect_b32 s99, s99, s77
    s_add_u32 s77, s99, 0
    s_add_u32 m0, s76, 4096
    s_nop 0
    buffer_load_dwordx4 v245, s[56:59], s77 offen lds
    buffer_load_dwordx4 v246, s[56:59], s77 offen offset:1024 lds
    v_mfma_f32_16x16x32_bf16 v[20:23], v[180:183], v[140:143], v[20:23]
    s_cmp_eq_u32 s92, 1
    s_cbranch_scc1 L_sk17
    s_mov_b32 s88, 0
    buffer_load_dwordx4 v[80:83], v222, s[28:31], s88 offen
L_sk17:
    s_cmp_eq_u32 s92, 1
    s_cbranch_scc1 L_sk18
    s_mov_b32 s88, 14336
    buffer_load_dwordx4 v[84:87], v222, s[28:31], s88 offen
L_sk18:
    v_mfma_f32_16x16x32_bf16 v[40:43], v[184:187], v[140:143], v[40:43]
    s_cmp_eq_u32 s92, 1
    s_cbranch_scc1 L_sk19
    s_mov_b32 s88, 28672
    buffer_load_dwordx4 v[88:91], v222, s[28:31], s88 offen
L_sk19:
    s_cmp_eq_u32 s92, 1
    s_cbranch_scc1 L_sk20
    s_mov_b32 s88, 43008
    buffer_load_dwordx4 v[92:95], v222, s[28:31], s88 offen
L_sk20:
    v_mfma_f32_16x16x32_bf16 v[60:63], v[188:191], v[140:143], v[60:63]
    v_mfma_f32_16x16x32_bf16 v[8:11], v[160:163], v[200:203], v[8:11]
    v_mfma_f32_16x16x32_bf16 v[28:31], v[164:167], v[200:203], v[28:31]
    v_mfma_f32_16x16x32_bf16 v[48:51], v[168:171], v[200:203], v[48:51]
    v_cvt_pk_bf16_f32 v0, v0, v1
    v_cvt_pk_bf16_f32 v1, v2, v3
    v_cvt_pk_bf16_f32 v2, v20, v21
    v_mfma_f32_16x16x32_bf16 v[68:71], v[172:175], v[200:203], v[68:71]
    v_cvt_pk_bf16_f32 v3, v22, v23
    v_cvt_pk_bf16_f32 v40, v40, v41
    v_cvt_pk_bf16_f32 v41, v42, v43
    v_mfma_f32_16x16x32_bf16 v[4:7], v[176:179], v[144:147], v[4:7]
    v_cvt_pk_bf16_f32 v42, v60, v61
    v_cvt_pk_bf16_f32 v43, v62, v63
    ds_write_b128 v232, v[0:3]
    v_mfma_f32_16x16x32_bf16 v[24:27], v[180:183], v[144:147], v[24:27]
    ds_write_b128 v232, v[40:43] offset:5120
    v_mfma_f32_16x16x32_bf16 v[44:47], v[184:187], v[144:147], v[44:47]
    v_mfma_f32_16x16x32_bf16 v[64:67], v[188:191], v[144:147], v[64:67]
    v_mfma_f32_16x16x32_bf16 v[12:15], v[160:163], v[204:207], v[12:15]
    v_mfma_f32_16x16x32_bf16 v[32:35], v[164:167], v[204:207], v[32:35]
    s_cmp_eq_u32 s92, 1
    s_cbranch_scc1 L_sk21
    s_mov_b32 s88, 57344
    buffer_load_dwordx4 v[96:99], v222, s[28:31], s88 offen
L_sk21:
    s_cmp_eq_u32 s92, 1
    s_cbranch_scc1 L_sk22
    s_mov_b32 s88, 0
    buffer_load_dwordx4 v[100:103], v223, s[28:31], s88 offen
L_sk22:
    v_mfma_f32_16x16x32_bf16 v[52:55], v[168:171], v[204:207], v[52:55]
    s_cmp_eq_u32 s92, 1
    s_cbranch_scc1 L_sk23
    s_mov_b32 s88, 14336
    buffer_load_dwordx4 v[104:107], v223, s[28:31], s88 offen
L_sk23:
    s_cmp_eq_u32 s92, 1
    s_cbranch_scc1 L_sk24
    s_mov_b32 s88, 28672
    buffer_load_dwordx4 v[108:111], v223, s[28:31], s88 offen
L_sk24:
    v_cvt_pk_bf16_f32 v4, v4, v5
    v_cvt_pk_bf16_f32 v5, v6, v7
    v_cvt_pk_bf16_f32 v6, v24, v25
    v_mfma_f32_16x16x32_bf16 v[72:75], v[172:175], v[204:207], v[72:75]
    v_cvt_pk_bf16_f32 v7, v26, v27
    v_cvt_pk_bf16_f32 v44, v44, v45
    v_cvt_pk_bf16_f32 v45, v46, v47
    v_mfma_f32_16x16x32_bf16 v[8:11], v[176:179], v[148:151], v[8:11]
    v_cvt_pk_bf16_f32 v46, v64, v65
    v_cvt_pk_bf16_f32 v47, v66, v67
    ds_write_b128 v232, v[4:7] offset:1024
    v_mfma_f32_16x16x32_bf16 v[28:31], v[180:183], v[148:151], v[28:31]
    ds_write_b128 v232, v[44:47] offset:6144
    v_mfma_f32_16x16x32_bf16 v[48:51], v[184:187], v[148:151], v[48:51]
    v_mfma_f32_16x16x32_bf16 v[68:71], v[188:191], v[148:151], v[68:71]
    v_mfma_f32_16x16x32_bf16 v[16:19], v[160:163], v[208:211], v[16:19]
    v_mfma_f32_16x16x32_bf16 v[36:39], v[164:167], v[208:211], v[36:39]
    v_mfma_f32_16x16x32_bf16 v[56:59], v[168:171], v[208:211], v[56:59]
    v_cvt_pk_bf16_f32 v8, v8, v9
    v_cvt_pk_bf16_f32 v9, v10, v11
    v_cvt_pk_bf16_f32 v10, v28, v29
    v_mfma_f32_16x16x32_bf16 v[76:79], v[172:175], v[208:211], v[76:79]
    v_cvt_pk_bf16_f32 v11, v30, v31
    v_cvt_pk_bf16_f32 v48, v48, v49
    v_cvt_pk_bf16_f32 v49, v50, v51
    v_mfma_f32_16x16x32_bf16 v[12:15], v[176:179], v[152:155], v[12:15]
    s_waitcnt vmcnt(8)
    s_waitcnt vmcnt(6)
    ds_read_b64_tr_b16 v[160:161], v233 offset:6144
    ds_read_b64_tr_b16 v[164:165], v234 offset:6144
    ds_read_b64_tr_b16 v[168:169], v235 offset:6144
    ds_read_b64_tr_b16 v[172:173], v236 offset:6144
    ds_read_b64_tr_b16 v[162:163], v233 offset:8192
    ds_read_b64_tr_b16 v[166:167], v234 offset:8192
    ds_read_b64_tr_b16 v[170:171], v235 offset:8192
    ds_read_b64_tr_b16 v[174:175], v236 offset:8192
    v_cvt_pk_bf16_f32 v50, v68, v69
    v_cvt_pk_bf16_f32 v51, v70, v71
    ds_write_b128 v232, v[8:11] offset:2048
    v_mfma_f32_16x16x32_bf16 v[32:35], v[180:183], v[152:155], v[32:35]
    s_cmp_eq_u32 s92, 1
    s_cbranch_scc1 L_sk25
    s_mov_b32 s88, 43008
    buffer_load_dwordx4 v[112:115], v223, s[28:31], s88 offen
L_sk25:
    s_cmp_eq_u32 s92, 1
    s_cbranch_scc1 L_sk26
    s_mov_b32 s88, 57344
    buffer_load_dwordx4 v[116:119], v223, s[28:31], s88 offen
L_sk26:
    ds_write_b128 v232, v[48:51] offset:7168
    v_mfma_f32_16x16x32_bf16 v[52:55], v[184:187], v[152:155], v[52:55]
    v_mfma_f32_16x16x32_bf16 v[72:75], v[188:191], v[152:155], v[72:75]
    v_mfma_f32_16x16x32_bf16 v[16:19], v[176:179], v[156:159], v[16:19]
    v_mfma_f32_16x16x32_bf16 v[36:39], v[180:183], v[156:159], v[36:39]
    v_mfma_f32_16x16x32_bf16 v[56:59], v[184:187], v[156:159], v[56:59]
    v_cvt_pk_bf16_f32 v12, v12, v13
    v_cvt_pk_bf16_f32 v13, v14, v15
    v_cvt_pk_bf16_f32 v14, v32, v33
    v_mfma_f32_16x16x32_bf16 v[76:79], v[188:191], v[156:159], v[76:79]
    v_cvt_pk_bf16_f32 v15, v34, v35
    v_cvt_pk_bf16_f32 v52, v52, v53
    v_cvt_pk_bf16_f32 v53, v54, v55
    v_cvt_pk_bf16_f32 v54, v72, v73
    v_cvt_pk_bf16_f32 v55, v74, v75
    ds_write_b128 v232, v[12:15] offset:3072
    s_waitcnt lgkmcnt(14)
    ds_write_b128 v232, v[52:55] offset:8192
    v_cvt_pk_bf16_f32 v16, v16, v17
    v_cvt_pk_bf16_f32 v17, v18, v19
    v_cvt_pk_bf16_f32 v18, v36, v37
    v_cvt_pk_bf16_f32 v19, v38, v39
    v_cvt_pk_bf16_f32 v56, v56, v57
    v_cvt_pk_bf16_f32 v57, v58, v59
    v_cvt_pk_bf16_f32 v58, v76, v77
    v_cvt_pk_bf16_f32 v59, v78, v79
    s_waitcnt lgkmcnt(14)
    ds_write_b128 v232, v[16:19] offset:4096
    s_waitcnt lgkmcnt(14)
    ds_write_b128 v232, v[56:59] offset:9216
    s_setprio 0
    s_waitcnt lgkmcnt(0)
    s_barrier
    s_cmp_lg_u32 s83, 7
    s_cbranch_scc1 L_o0
    s_waitcnt vmcnt(0)
    s_add_u32 s98, s98, 262144
    s_sub_u32 s77, s98, 3670016
    s_cselect_b32 s98, s98, s77
    s_add_u32 s77, s98, 0
    s_add_u32 m0, s76, 0
    s_nop 0
    buffer_load_dwordx4 v243, s[32:35], s77 offen lds
    buffer_load_dwordx4 v244, s[32:35], s77 offen offset:1024 lds
    s_add_u32 s77, s98, 32768
    s_add_u32 m0, s76, 2048
    s_nop 0
    buffer_load_dwordx4 v243, s[32:35], s77 offen lds
    buffer_load_dwordx4 v244, s[32:35], s77 offen offset:1024 lds
    s_add_u32 s98, s98, 262144
    s_sub_u32 s77, s98, 3670016
    s_cselect_b32 s98, s98, s77
    s_add_u32 s77, s98, 0
    s_add_u32 m0, s76, 4096
    s_nop 0
    buffer_load_dwordx4 v243, s[32:35], s77 offen lds
    buffer_load_dwordx4 v244, s[32:35], s77 offen offset:1024 lds
    s_add_u32 s77, s98, 32768
    s_add_u32 m0, s76, 6144
    s_nop 0
    buffer_load_dwordx4 v243, s[32:35], s77 offen lds
    buffer_load_dwordx4 v244, s[32:35], s77 offen offset:1024 lds
    s_add_u32 s98, s98, 262144
    s_sub_u32 s77, s98, 3670016
    s_cselect_b32 s98, s98, s77
    s_add_u32 s77, s98, 0
    s_add_u32 m0, s76, 8192
    s_nop 0
    buffer_load_dwordx4 v243, s[32:35], s77 offen lds
    buffer_load_dwordx4 v244, s[32:35], s77 offen offset:1024 lds
    s_barrier
    s_cmp_eq_u32 s92, 1
    s_cbranch_scc1 L_sk27
    ds_write_b128 v229, v[80:83] offset:0
L_sk27:
    s_cmp_eq_u32 s92, 1
    s_cbranch_scc1 L_sk28
    ds_write_b128 v229, v[84:87] offset:4096
L_sk28:
    s_cmp_eq_u32 s92, 1
    s_cbranch_scc1 L_sk29
    ds_write_b128 v229, v[88:91] offset:8192
L_sk29:
    s_cmp_eq_u32 s92, 1
    s_cbranch_scc1 L_sk30
    ds_write_b128 v229, v[92:95] offset:12288
L_sk30:
    s_cmp_eq_u32 s92, 1
    s_cbranch_scc1 L_sk31
    ds_write_b128 v229, v[96:99] offset:16384
L_sk31:
    s_waitcnt vmcnt(0) lgkmcnt(0)
    s_barrier
    ds_read_b64_tr_b16 v[160:161], v233
    ds_read_b64_tr_b16 v[164:165], v234
    ds_read_b64_tr_b16 v[168:169], v235
    ds_read_b64_tr_b16 v[172:173], v236
    ds_read_b64_tr_b16 v[162:163], v233 offset:2048
    ds_read_b64_tr_b16 v[166:167], v234 offset:2048
    ds_read_b64_tr_b16 v[170:171], v235 offset:2048
    ds_read_b64_tr_b16 v[174:175], v236 offset:2048
    ds_read_b128 v[192:195], v237
    ds_read_b128 v[196:199], v237 offset:4096
    ds_read_b128 v[200:203], v237 offset:8192
    ds_read_b128 v[204:207], v237 offset:12288
    ds_read_b128 v[208:211], v237 offset:16384
    s_waitcnt lgkmcnt(0)
    s_add_u32 s77, s98, 32768
    s_add_u32 m0, s76, 0
    s_nop 0
    buffer_load_dwordx4 v243, s[32:35], s77 offen lds
    buffer_load_dwordx4 v244, s[32:35], s77 offen offset:1024 lds
    s_add_u32 s98, s98, 262144
    s_sub_u32 s77, s98, 3670016
    s_cselect_b32 s98, s98, s77
    s_add_u32 s77, s98, 0
    s_add_u32 m0, s76, 2048
    s_nop 0
    buffer_load_dwordx4 v243, s[32:35], s77 offen lds
    buffer_load_dwordx4 v244, s[32:35], s77 offen offset:1024 lds
    s_branch L_oend0
L_o0:
    ds_read_b128 v[192:195], v230
    ds_read_b128 v[196:199], v230 offset:1024
    ds_read_b128 v[200:203], v230 offset:2048
    ds_read_b128 v[204:207], v230 offset:3072
    ds_read_b128 v[208:211], v230 offset:4096
    s_setprio 3
    s_waitcnt vmcnt(4)
    s_waitcnt lgkmcnt(4)
    v_mfma_f32_16x16x32_bf16 v[0:3], v[160:163], v[192:195], 0
    ds_read_b64_tr_b16 v[176:177], v233
    ds_read_b64_tr_b16 v[180:181], v234
    v_mfma_f32_16x16x32_bf16 v[20:23], v[164:167], v[192:195], 0
    ds_read_b64_tr_b16 v[184:185], v235
    ds_read_b64_tr_b16 v[188:189], v236
    v_mfma_f32_16x16x32_bf16 v[40:43], v[168:171], v[192:195], 0
    s_add_u32 s77, s99, 14336
    s_add_u32 m0, s76, 6144
    s_nop 0
    buffer_load_dwordx4 v245, s[56:59], s77 offen lds
    buffer_load_dwordx4 v246, s[56:59], s77 offen offset:1024 lds
    v_mfma_f32_16x16x32_bf16 v[60:63], v[172:175], v[192:195], 0
    ds_read_b128 v[192:195], v230 offset:5120
    s_add_u32 s99, s99, 28672
    s_sub_u32 s77, s99, 458752
    s_cselect_b32 s99, s99, s77
    s_add_u32 s77, s99, 0
    s_add_u32 m0, s76, 8192
    s_nop 0
    buffer_load_dwordx4 v245, s[56:59], s77 offen lds
    buffer_load_dwordx4 v246, s[56:59], s77 offen offset:1024 lds
    s_waitcnt lgkmcnt(8)
    v_mfma_f32_16x16x32_bf16 v[4:7], v[160:163], v[196:199], 0
    v_mfma_f32_16x16x32_bf16 v[24:27], v[164:167], v[196:199], 0
    s_waitcnt lgkmcnt(1)
    s_add_u32 s77, s99, 14336
    s_add_u32 m0, s76, 0
    s_nop 0
    buffer_load_dwordx4 v245, s[56:59], s77 offen lds
    buffer_load_dwordx4 v246, s[56:59], s77 offen offset:1024 lds
    v_mfma_f32_16x16x32_bf16 v[44:47], v[168:171], v[196:199], 0
    v_mfma_f32_16x16x32_bf16 v[64:67], v[172:175], v[196:199], 0
    ds_read_b128 v[196:199], v230 offset:6144
    v_mfma_f32_16x16x32_bf16 v[8:11], v[160:163], v[200:203], 0
    v_mfma_f32_16x16x32_bf16 v[28:31], v[164:167], v[200:203], 0
    s_waitcnt vmcnt(8)
    v_mfma_f32_16x16x32_bf16 v[48:51], v[168:171], v[200:203], 0
    ds_read_b64_tr_b16 v[178:179], v233 offset:2048
    ds_read_b64_tr_b16 v[182:183], v234 offset:2048
    v_mfma_f32_16x16x32_bf16 v[68:71], v[172:175], v[200:203], 0
    ds_read_b64_tr_b16 v[186:187], v235 offset:2048
    ds_read_b64_tr_b16 v[190:191], v236 offset:2048
    ds_read_b128 v[200:203], v230 offset:7168
    v_mfma_f32_16x16x32_bf16 v[12:15], v[160:163], v[204:207], 0
    v_mfma_f32_16x16x32_bf16 v[32:35], v[164:167], v[204:207], 0
    v_mfma_f32_16x16x32_bf16 v[52:55], v[168:171], v[204:207], 0
    v_mfma_f32_16x16x32_bf16 v[72:75], v[172:175], v[204:207], 0
    ds_read_b128 v[204:207], v230 offset:8192
    s_waitcnt lgkmcnt(2)
    s_add_u32 s99, s99, 28672
    s_sub_u32 s77, s99, 458752
    s_cselect_b32 s99, s99, s77
    s_add_u32 s77, s99, 0
    s_add_u32 m0, s76, 2048
    s_nop 0
    buffer_load_dwordx4 v245, s[56:59], s77 offen lds
    buffer_load_dwordx4 v246, s[56:59], s77 offen offset:1024 lds
    v_mfma_f32_16x16x32_bf16 v[16:19], v[160:163], v[208:211], 0
    v_mfma_f32_16x16x32_bf16 v[36:39], v[164:167], v[208:211], 0
    v_mfma_f32_16x16x32_bf16 v[56:59], v[168:171], v[208:211], 0
    v_mfma_f32_16x16x32_bf16 v[76:79], v[172:175], v[208:211], 0
    ds_read_b128 v[208:211], v230 offset:9216
    s_setprio 2
    s_waitcnt vmcnt(8)
    v_mfma_f32_16x16x32_bf16 v[0:3], v[176:179], v[192:195], v[0:3]
    ds_read_b64_tr_b16 v[160:161], v233 offset:4096
    ds_read_b64_tr_b16 v[164:165], v234 offset:4096
    v_mfma_f32_16x16x32_bf16 v[20:23], v[180:183], v[192:195], v[20:23]
    ds_read_b64_tr_b16 v[168:169], v235 offset:4096
    ds_read_b64_tr_b16 v[172:173], v236 offset:4096
    v_mfma_f32_16x16x32_bf16 v[40:43], v[184:187], v[192:195], v[40:43]
    v_mfma_f32_16x16x32_bf16 v[60:63], v[188:191], v[192:195], v[60:63]
    ds_read_b128 v[192:195], v230 offset:10240
    v_mfma_f32_16x16x32_bf16 v[4:7], v[176:179], v[196:199], v[4:7]
    v_mfma_f32_16x16x32_bf16 v[24:27], v[180:183], v[196:199], v[24:27]
    s_waitcnt lgkmcnt(1)
    s_add_u32 s77, s99, 14336
    s_add_u32 m0, s76, 4096
    s_nop 0
    buffer_load_dwordx4 v245, s[56:59], s77 offen lds
    buffer_load_dwordx4 v246, s[56:59], s77 offen offset:1024 lds
    v_mfma_f32_16x16x32_bf16 v[44:47], v[184:187], v[196:199], v[44:47]
    v_mfma_f32_16x16x32_bf16 v[64:67], v[188:191], v[196:199], v[64:67]
    ds_read_b128 v[196:199], v230 offset:11264
    v_mfma_f32_16x16x32_bf16 v[8:11], v[176:179], v[200:203], v[8:11]
    v_mfma_f32_16x16x32_bf16 v[28:31], v[180:183], v[200:203], v[28:31]
    s_waitcnt vmcnt(8)
    v_mfma_f32_16x16x32_bf16 v[48:51], v[184:187], v[200:203], v[48:51]
    ds_read_b64_tr_b16 v[162:163], v233 offset:6144
    ds_read_b64_tr_b16 v[166:167], v234 offset:6144
    v_mfma_f32_16x16x32_bf16 v[68:71], v[188:191], v[200:203], v[68:71]
    ds_read_b64_tr_b16 v[170:171], v235 offset:6144
    ds_read_b64_tr_b16 v[174:175], v236 offset:6144
    ds_read_b128 v[200:203], v230 offset:12288
    v_mfma_f32_16x16x32_bf16 v[12:15], v[176:179], v[204:207], v[12:15]
    v_mfma_f32_16x16x32_bf16 v[32:35], v[180:183], v[204:207], v[32:35]
    v_mfma_f32_16x16x32_bf16 v[52:55], v[184:187], v[204:207], v[52:55]
    v_mfma_f32_16x16x32_bf16 v[72:75], v[188:191], v[204:207], v[72:75]
    ds_read_b128 v[204:207], v230 offset:13312
    s_waitcnt lgkmcnt(2)
    s_add_u32 s99, s99, 28672
    s_sub_u32 s77, s99, 458752
    s_cselect_b32 s99, s99, s77
    s_add_u32 s77, s99, 0
    s_add_u32 m0, s76, 6144
    s_nop 0
    buffer_load_dwordx4 v245, s[56:59], s77 offen lds
    buffer_load_dwordx4 v246, s[56:59], s77 offen offset:1024 lds
    v_mfma_f32_16x16x32_bf16 v[16:19], v[176:179], v[208:211], v[16:19]
    v_mfma_f32_16x16x32_bf16 v[36:39], v[180:183], v[208:211], v[36:39]
    v_mfma_f32_16x16x32_bf16 v[56:59], v[184:187], v[208:211], v[56:59]
    v_mfma_f32_16x16x32_bf16 v[76:79], v[188:191], v[208:211], v[76:79]
    ds_read_b128 v[208:211], v230 offset:14336
    s_setprio 1
    s_waitcnt vmcnt(8)
    v_mfma_f32_16x16x32_bf16 v[0:3], v[160:163], v[192:195], v[0:3]
    ds_read_b64_tr_b16 v[176:177], v233 offset:8192
    ds_read_b64_tr_b16 v[180:181], v234 offset:8192
    v_mfma_f32_16x16x32_bf16 v[20:23], v[164:167], v[192:195], v[20:23]
    ds_read_b64_tr_b16 v[184:185], v235 offset:8192
    ds_read_b64_tr_b16 v[188:189], v236 offset:8192
    v_mfma_f32_16x16x32_bf16 v[40:43], v[168:171], v[192:195], v[40:43]
    v_mfma_f32_16x16x32_bf16 v[60:63], v[172:175], v[192:195], v[60:63]
    ds_read_b128 v[192:195], v230 offset:15360
    v_mfma_f32_16x16x32_bf16 v[4:7], v[160:163], v[196:199], v[4:7]
    v_mfma_f32_16x16x32_bf16 v[24:27], v[164:167], v[196:199], v[24:27]
    s_waitcnt lgkmcnt(1)
    s_add_u32 s77, s99, 14336
    s_add_u32 m0, s76, 8192
    s_nop 0
    buffer_load_dwordx4 v245, s[56:59], s77 offen lds
    buffer_load_dwordx4 v246, s[56:59], s77 offen offset:1024 lds
    v_mfma_f32_16x16x32_bf16 v[44:47], v[168:171], v[196:199], v[44:47]
    v_mfma_f32_16x16x32_bf16 v[64:67], v[172:175], v[196:199], v[64:67]
    ds_read_b128 v[196:199], v230 offset:16384
    v_mfma_f32_16x16x32_bf16 v[8:11], v[160:163], v[200:203], v[8:11]
    v_mfma_f32_16x16x32_bf16 v[28:31], v[164:167], v[200:203], v[28:31]
    s_waitcnt vmcnt(8)
    v_mfma_f32_16x16x32_bf16 v[48:51], v[168:171], v[200:203], v[48:51]
    ds_read_b64_tr_b16 v[178:179], v233
    ds_read_b64_tr_b16 v[182:183], v234
    v_mfma_f32_16x16x32_bf16 v[68:71], v[172:175], v[200:203], v[68:71]
    ds_read_b64_tr_b16 v[186:187], v235
    ds_read_b64_tr_b16 v[190:191], v236
    ds_read_b128 v[200:203], v230 offset:17408
    v_mfma_f32_16x16x32_bf16 v[12:15], v[160:163], v[204:207], v[12:15]
    v_mfma_f32_16x16x32_bf16 v[32:35], v[164:167], v[204:207], v[32:35]
    v_mfma_f32_16x16x32_bf16 v[52:55], v[168:171], v[204:207], v[52:55]
    v_mfma_f32_16x16x32_bf16 v[72:75], v[172:175], v[204:207], v[72:75]
    ds_read_b128 v[204:207], v230 offset:18432
    s_waitcnt lgkmcnt(2)
    s_add_u32 s99, s99, 28672
    s_sub_u32 s77, s99, 458752
    s_cselect_b32 s99, s99, s77
    s_add_u32 s77, s99, 0
    s_add_u32 m0, s76, 0
    s_nop 0
    buffer_load_dwordx4 v245, s[56:59], s77 offen lds
    buffer_load_dwordx4 v246, s[56:59], s77 offen offset:1024 lds
    v_mfma_f32_16x16x32_bf16 v[16:19], v[160:163], v[208:211], v[16:19]
    v_mfma_f32_16x16x32_bf16 v[36:39], v[164:167], v[208:211], v[36:39]
    v_mfma_f32_16x16x32_bf16 v[56:59], v[168:171], v[208:211], v[56:59]
    v_mfma_f32_16x16x32_bf16 v[76:79], v[172:175], v[208:211], v[76:79]
    ds_read_b128 v[208:211], v230 offset:19456
    s_setprio 0
    s_waitcnt vmcnt(8)
    v_mfma_f32_16x16x32_bf16 v[0:3], v[176:179], v[192:195], v[0:3]
    ds_read_b64_tr_b16 v[160:161], v233 offset:2048
    ds_read_b64_tr_b16 v[164:165], v234 offset:2048
    v_mfma_f32_16x16x32_bf16 v[20:23], v[180:183], v[192:195], v[20:23]
    ds_read_b64_tr_b16 v[168:169], v235 offset:2048
    ds_read_b64_tr_b16 v[172:173], v236 offset:2048
    v_mfma_f32_16x16x32_bf16 v[40:43], v[184:187], v[192:195], v[40:43]
    v_mfma_f32_16x16x32_bf16 v[60:63], v[188:191], v[192:195], v[60:63]
    ds_read_b128 v[192:195], v230 offset:20480
    v_mfma_f32_16x16x32_bf16 v[4:7], v[176:179], v[196:199], v[4:7]
    v_mfma_f32_16x16x32_bf16 v[24:27], v[180:183], v[196:199], v[24:27]
    s_waitcnt lgkmcnt(1)
    s_add_u32 s77, s99, 14336
    s_add_u32 m0, s76, 2048
    s_nop 0
    buffer_load_dwordx4 v245, s[56:59], s77 offen lds
    buffer_load_dwordx4 v246, s[56:59], s77 offen offset:1024 lds
    v_mfma_f32_16x16x32_bf16 v[44:47], v[184:187], v[196:199], v[44:47]
    v_mfma_f32_16x16x32_bf16 v[64:67], v[188:191], v[196:199], v[64:67]
    ds_read_b128 v[196:199], v230 offset:21504
    v_mfma_f32_16x16x32_bf16 v[8:11], v[176:179], v[200:203], v[8:11]
    v_mfma_f32_16x16x32_bf16 v[28:31], v[180:183], v[200:203], v[28:31]
    s_waitcnt vmcnt(8)
    v_mfma_f32_16x16x32_bf16 v[48:51], v[184:187], v[200:203], v[48:51]
    ds_read_b64_tr_b16 v[162:163], v233 offset:4096
    ds_read_b64_tr_b16 v[166:167], v234 offset:4096
    v_mfma_f32_16x16x32_bf16 v[68:71], v[188:191], v[200:203], v[68:71]
    ds_read_b64_tr_b16 v[170:171], v235 offset:4096
    ds_read_b64_tr_b16 v[174:175], v236 offset:4096
    ds_read_b128 v[200:203], v230 offset:22528
    v_mfma_f32_16x16x32_bf16 v[12:15], v[176:179], v[204:207], v[12:15]
    v_mfma_f32_16x16x32_bf16 v[32:35], v[180:183], v[204:207], v[32:35]
    v_mfma_f32_16x16x32_bf16 v[52:55], v[184:187], v[204:207], v[52:55]
    v_mfma_f32_16x16x32_bf16 v[72:75], v[188:191], v[204:207], v[72:75]
    ds_read_b128 v[204:207], v230 offset:23552
    s_waitcnt lgkmcnt(2)
    s_add_u32 s99, s99, 28672
    s_sub_u32 s77, s99, 458752
    s_cselect_b32 s99, s99, s77
    s_add_u32 s77, s99, 0
    s_add_u32 m0, s76, 4096
    s_nop 0
    buffer_load_dwordx4 v245, s[56:59], s77 offen lds
    buffer_load_dwordx4 v246, s[56:59], s77 offen offset:1024 lds
    v_mfma_f32_16x16x32_bf16 v[16:19], v[176:179], v[208:211], v[16:19]
    v_mfma_f32_16x16x32_bf16 v[36:39], v[180:183], v[208:211], v[36:39]
    v_mfma_f32_16x16x32_bf16 v[56:59], v[184:187], v[208:211], v[56:59]
    v_mfma_f32_16x16x32_bf16 v[76:79], v[188:191], v[208:211], v[76:79]
    ds_read_b128 v[208:211], v230 offset:24576
    s_setprio 3
    s_waitcnt vmcnt(8)
    v_mfma_f32_16x16x32_bf16 v[0:3], v[160:163], v[192:195], v[0:3]
    ds_read_b64_tr_b16 v[176:177], v233 offset:6144
    ds_read_b64_tr_b16 v[180:181], v234 offset:6144
    v_mfma_f32_16x16x32_bf16 v[20:23], v[164:167], v[192:195], v[20:23]
    ds_read_b64_tr_b16 v[184:185], v235 offset:6144
    ds_read_b64_tr_b16 v[188:189], v236 offset:6144
    v_mfma_f32_16x16x32_bf16 v[40:43], v[168:171], v[192:195], v[40:43]
    v_mfma_f32_16x16x32_bf16 v[60:63], v[172:175], v[192:195], v[60:63]
    ds_read_b128 v[192:195], v230 offset:25600
    v_mfma_f32_16x16x32_bf16 v[4:7], v[160:163], v[196:199], v[4:7]
    v_mfma_f32_16x16x32_bf16 v[24:27], v[164:167], v[196:199], v[24:27]
    s_waitcnt lgkmcnt(1)
    s_add_u32 s77, s99, 14336
    s_add_u32 m0, s76, 6144
    s_nop 0
    buffer_load_dwordx4 v245, s[56:59], s77 offen lds
    buffer_load_dwordx4 v246, s[56:59], s77 offen offset:1024 lds
    v_mfma_f32_16x16x32_bf16 v[44:47], v[168:171], v[196:199], v[44:47]
    v_mfma_f32_16x16x32_bf16 v[64:67], v[172:175], v[196:199], v[64:67]
    ds_read_b128 v[196:199], v230 offset:26624
    v_mfma_f32_16x16x32_bf16 v[8:11], v[160:163], v[200:203], v[8:11]
    v_mfma_f32_16x16x32_bf16 v[28:31], v[164:167], v[200:203], v[28:31]
    s_waitcnt vmcnt(8)
    v_mfma_f32_16x16x32_bf16 v[48:51], v[168:171], v[200:203], v[48:51]
    ds_read_b64_tr_b16 v[178:179], v233 offset:8192
    ds_read_b64_tr_b16 v[182:183], v234 offset:8192
    v_mfma_f32_16x16x32_bf16 v[68:71], v[172:175], v[200:203], v[68:71]
    ds_read_b64_tr_b16 v[186:187], v235 offset:8192
    ds_read_b64_tr_b16 v[190:191], v236 offset:8192
    ds_read_b128 v[200:203], v230 offset:27648
    v_mfma_f32_16x16x32_bf16 v[12:15], v[160:163], v[204:207], v[12:15]
    v_mfma_f32_16x16x32_bf16 v[32:35], v[164:167], v[204:207], v[32:35]
    v_mfma_f32_16x16x32_bf16 v[52:55], v[168:171], v[204:207], v[52:55]
    v_mfma_f32_16x16x32_bf16 v[72:75], v[172:175], v[204:207], v[72:75]
    ds_read_b128 v[204:207], v230 offset:28672
    s_waitcnt lgkmcnt(2)
    s_add_u32 s99, s99, 28672
    s_sub_u32 s77, s99, 458752
    s_cselect_b32 s99, s99, s77
    s_add_u32 s77, s99, 0
    s_add_u32 m0, s76, 8192
    s_nop 0
    buffer_load_dwordx4 v245, s[56:59], s77 offen lds
    buffer_load_dwordx4 v246, s[56:59], s77 offen offset:1024 lds
    v_mfma_f32_16x16x32_bf16 v[16:19], v[160:163], v[208:211], v[16:19]
    v_mfma_f32_16x16x32_bf16 v[36:39], v[164:167], v[208:211], v[36:39]
    v_mfma_f32_16x16x32_bf16 v[56:59], v[168:171], v[208:211], v[56:59]
    v_mfma_f32_16x16x32_bf16 v[76:79], v[172:175], v[208:211], v[76:79]
    ds_read_b128 v[208:211], v230 offset:29696
    s_setprio 2
    s_waitcnt vmcnt(8)
    v_mfma_f32_16x16x32_bf16 v[0:3], v[176:179], v[192:195], v[0:3]
    ds_read_b64_tr_b16 v[160:161], v233
    ds_read_b64_tr_b16 v[164:165], v234
    v_mfma_f32_16x16x32_bf16 v[20:23], v[180:183], v[192:195], v[20:23]
    ds_read_b64_tr_b16 v[168:169], v235
    ds_read_b64_tr_b16 v[172:173], v236
    v_mfma_f32_16x16x32_bf16 v[40:43], v[184:187], v[192:195], v[40:43]
    v_mfma_f32_16x16x32_bf16 v[60:63], v[188:191], v[192:195], v[60:63]
    ds_read_b128 v[192:195], v230 offset:30720
    v_mfma_f32_16x16x32_bf16 v[4:7], v[176:179], v[196:199], v[4:7]
    v_mfma_f32_16x16x32_bf16 v[24:27], v[180:183], v[196:199], v[24:27]
    s_waitcnt lgkmcnt(1)
    s_add_u32 s77, s99, 14336
    s_add_u32 m0, s76, 0
    s_nop 0
    buffer_load_dwordx4 v245, s[56:59], s77 offen lds
    buffer_load_dwordx4 v246, s[56:59], s77 offen offset:1024 lds
    v_mfma_f32_16x16x32_bf16 v[44:47], v[184:187], v[196:199], v[44:47]
    v_mfma_f32_16x16x32_bf16 v[64:67], v[188:191], v[196:199], v[64:67]
    ds_read_b128 v[196:199], v230 offset:31744
    v_mfma_f32_16x16x32_bf16 v[8:11], v[176:179], v[200:203], v[8:11]
    v_mfma_f32_16x16x32_bf16 v[28:31], v[180:183], v[200:203], v[28:31]
    s_waitcnt vmcnt(8)
    v_mfma_f32_16x16x32_bf16 v[48:51], v[184:187], v[200:203], v[48:51]
    ds_read_b64_tr_b16 v[162:163], v233 offset:2048
    ds_read_b64_tr_b16 v[166:167], v234 offset:2048
    v_mfma_f32_16x16x32_bf16 v[68:71], v[188:191], v[200:203], v[68:71]
    ds_read_b64_tr_b16 v[170:171], v235 offset:2048
    ds_read_b64_tr_b16 v[174:175], v236 offset:2048
    ds_read_b128 v[200:203], v230 offset:32768
    v_mfma_f32_16x16x32_bf16 v[12:15], v[176:179], v[204:207], v[12:15]
    v_mfma_f32_16x16x32_bf16 v[32:35], v[180:183], v[204:207], v[32:35]
    v_mfma_f32_16x16x32_bf16 v[52:55], v[184:187], v[204:207], v[52:55]
    v_mfma_f32_16x16x32_bf16 v[72:75], v[188:191], v[204:207], v[72:75]
    ds_read_b128 v[204:207], v230 offset:33792
    s_waitcnt lgkmcnt(2)
    s_add_u32 s99, s99, 28672
    s_sub_u32 s77, s99, 458752
    s_cselect_b32 s99, s99, s77
    s_add_u32 s77, s99, 0
    s_add_u32 m0, s76, 2048
    s_nop 0
    buffer_load_dwordx4 v245, s[56:59], s77 offen lds
    buffer_load_dwordx4 v246, s[56:59], s77 offen offset:1024 lds
    v_mfma_f32_16x16x32_bf16 v[16:19], v[176:179], v[208:211], v[16:19]
    v_mfma_f32_16x16x32_bf16 v[36:39], v[180:183], v[208:211], v[36:39]
    v_mfma_f32_16x16x32_bf16 v[56:59], v[184:187], v[208:211], v[56:59]
    v_mfma_f32_16x16x32_bf16 v[76:79], v[188:191], v[208:211], v[76:79]
    ds_read_b128 v[208:211], v230 offset:34816
    s_setprio 1
    s_waitcnt vmcnt(8)
    v_mfma_f32_16x16x32_bf16 v[0:3], v[160:163], v[192:195], v[0:3]
    ds_read_b64_tr_b16 v[176:177], v233 offset:4096
    ds_read_b64_tr_b16 v[180:181], v234 offset:4096
    v_mfma_f32_16x16x32_bf16 v[20:23], v[164:167], v[192:195], v[20:23]
    ds_read_b64_tr_b16 v[184:185], v235 offset:4096
    ds_read_b64_tr_b16 v[188:189], v236 offset:4096
    v_mfma_f32_16x16x32_bf16 v[40:43], v[168:171], v[192:195], v[40:43]
    v_mfma_f32_16x16x32_bf16 v[60:63], v[172:175], v[192:195], v[60:63]
    ds_read_b128 v[192:195], v230 offset:35840
    v_mfma_f32_16x16x32_bf16 v[4:7], v[160:163], v[196:199], v[4:7]
    v_mfma_f32_16x16x32_bf16 v[24:27], v[164:167], v[196:199], v[24:27]
    s_waitcnt lgkmcnt(1)
    s_add_u32 s77, s99, 14336
    s_add_u32 m0, s76, 4096
    s_nop 0
    buffer_load_dwordx4 v245, s[56:59], s77 offen lds
    buffer_load_dwordx4 v246, s[56:59], s77 offen offset:1024 lds
    v_mfma_f32_16x16x32_bf16 v[44:47], v[168:171], v[196:199], v[44:47]
    v_mfma_f32_16x16x32_bf16 v[64:67], v[172:175], v[196:199], v[64:67]
    ds_read_b128 v[196:199], v230 offset:36864
    v_mfma_f32_16x16x32_bf16 v[8:11], v[160:163], v[200:203], v[8:11]
    v_mfma_f32_16x16x32_bf16 v[28:31], v[164:167], v[200:203], v[28:31]
    s_waitcnt vmcnt(8)
    v_mfma_f32_16x16x32_bf16 v[48:51], v[168:171], v[200:203], v[48:51]
    ds_read_b64_tr_b16 v[178:179], v233 offset:6144
    ds_read_b64_tr_b16 v[182:183], v234 offset:6144
    v_mfma_f32_16x16x32_bf16 v[68:71], v[172:175], v[200:203], v[68:71]
    ds_read_b64_tr_b16 v[186:187], v235 offset:6144
    ds_read_b64_tr_b16 v[190:191], v236 offset:6144
    ds_read_b128 v[200:203], v230 offset:37888
    v_mfma_f32_16x16x32_bf16 v[12:15], v[160:163], v[204:207], v[12:15]
    v_mfma_f32_16x16x32_bf16 v[32:35], v[164:167], v[204:207], v[32:35]
    v_mfma_f32_16x16x32_bf16 v[52:55], v[168:171], v[204:207], v[52:55]
    v_mfma_f32_16x16x32_bf16 v[72:75], v[172:175], v[204:207], v[72:75]
    ds_read_b128 v[204:207], v230 offset:38912
    s_waitcnt lgkmcnt(2)
    s_add_u32 s99, s99, 28672
    s_sub_u32 s77, s99, 458752
    s_cselect_b32 s99, s99, s77
    s_add_u32 s77, s99, 0
    s_add_u32 m0, s76, 6144
    s_nop 0
    buffer_load_dwordx4 v245, s[56:59], s77 offen lds
    buffer_load_dwordx4 v246, s[56:59], s77 offen offset:1024 lds
    v_mfma_f32_16x16x32_bf16 v[16:19], v[160:163], v[208:211], v[16:19]
    v_mfma_f32_16x16x32_bf16 v[36:39], v[164:167], v[208:211], v[36:39]
    v_mfma_f32_16x16x32_bf16 v[56:59], v[168:171], v[208:211], v[56:59]
    v_mfma_f32_16x16x32_bf16 v[76:79], v[172:175], v[208:211], v[76:79]
    ds_read_b128 v[208:211], v230 offset:39936
    s_setprio 0
    s_waitcnt vmcnt(8)
    v_mfma_f32_16x16x32_bf16 v[0:3], v[176:179], v[192:195], v[0:3]
    ds_read_b64_tr_b16 v[160:161], v233 offset:8192
    ds_read_b64_tr_b16 v[164:165], v234 offset:8192
    v_mfma_f32_16x16x32_bf16 v[20:23], v[180:183], v[192:195], v[20:23]
    ds_read_b64_tr_b16 v[168:169], v235 offset:8192
    ds_read_b64_tr_b16 v[172:173], v236 offset:8192
    v_mfma_f32_16x16x32_bf16 v[40:43], v[184:187], v[192:195], v[40:43]
    v_mfma_f32_16x16x32_bf16 v[60:63], v[188:191], v[192:195], v[60:63]
    ds_read_b128 v[192:195], v247
    v_mfma_f32_16x16x32_bf16 v[4:7], v[176:179], v[196:199], v[4:7]
    v_mfma_f32_16x16x32_bf16 v[24:27], v[180:183], v[196:199], v[24:27]
    s_waitcnt lgkmcnt(1)
    s_add_u32 s77, s99, 14336
    s_add_u32 m0, s76, 8192
    s_nop 0
    buffer_load_dwordx4 v245, s[56:59], s77 offen lds
    buffer_load_dwordx4 v246, s[56:59], s77 offen offset:1024 lds
    v_mfma_f32_16x16x32_bf16 v[44:47], v[184:187], v[196:199], v[44:47]
    v_mfma_f32_16x16x32_bf16 v[64:67], v[188:191], v[196:199], v[64:67]
    ds_read_b128 v[196:199], v247 offset:1024
    v_mfma_f32_16x16x32_bf16 v[8:11], v[176:179], v[200:203], v[8:11]
    v_mfma_f32_16x16x32_bf16 v[28:31], v[180:183], v[200:203], v[28:31]
    s_waitcnt vmcnt(8)
    v_mfma_f32_16x16x32_bf16 v[48:51], v[184:187], v[200:203], v[48:51]
    ds_read_b64_tr_b16 v[162:163], v233
    ds_read_b64_tr_b16 v[166:167], v234
    v_mfma_f32_16x16x32_bf16 v[68:71], v[188:191], v[200:203], v[68:71]
    ds_read_b64_tr_b16 v[170:171], v235
    ds_read_b64_tr_b16 v[174:175], v236
    ds_read_b128 v[200:203], v247 offset:2048
    v_mfma_f32_16x16x32_bf16 v[12:15], v[176:179], v[204:207], v[12:15]
    v_mfma_f32_16x16x32_bf16 v[32:35], v[180:183], v[204:207], v[32:35]
    v_mfma_f32_16x16x32_bf16 v[52:55], v[184:187], v[204:207], v[52:55]
    v_mfma_f32_16x16x32_bf16 v[72:75], v[188:191], v[204:207], v[72:75]
    ds_read_b128 v[204:207], v247 offset:3072
    s_waitcnt lgkmcnt(2)
    s_add_u32 s99, s99, 28672
    s_sub_u32 s77, s99, 458752
    s_cselect_b32 s99, s99, s77
    s_add_u32 s77, s99, 0
    s_add_u32 m0, s76, 0
    s_nop 0
    buffer_load_dwordx4 v245, s[56:59], s77 offen lds
    buffer_load_dwordx4 v246, s[56:59], s77 offen offset:1024 lds
    v_mfma_f32_16x16x32_bf16 v[16:19], v[176:179], v[208:211], v[16:19]
    v_mfma_f32_16x16x32_bf16 v[36:39], v[180:183], v[208:211], v[36:39]
    v_mfma_f32_16x16x32_bf16 v[56:59], v[184:187], v[208:211], v[56:59]
    v_mfma_f32_16x16x32_bf16 v[76:79], v[188:191], v[208:211], v[76:79]
    ds_read_b128 v[208:211], v247 offset:4096
    s_setprio 3
    s_waitcnt vmcnt(8)
    s_barrier
    v_mfma_f32_16x16x32_bf16 v[0:3], v[160:163], v[192:195], v[0:3]
    ds_read_b64_tr_b16 v[176:177], v233 offset:2048
    ds_read_b64_tr_b16 v[180:181], v234 offset:2048
    v_mfma_f32_16x16x32_bf16 v[20:23], v[164:167], v[192:195], v[20:23]
    ds_read_b64_tr_b16 v[184:185], v235 offset:2048
    ds_read_b64_tr_b16 v[188:189], v236 offset:2048
    v_mfma_f32_16x16x32_bf16 v[40:43], v[168:171], v[192:195], v[40:43]
    v_mfma_f32_16x16x32_bf16 v[60:63], v[172:175], v[192:195], v[60:63]
    ds_read_b128 v[192:195], v247 offset:5120
    v_mfma_f32_16x16x32_bf16 v[4:7], v[160:163], v[196:199], v[4:7]
    v_mfma_f32_16x16x32_bf16 v[24:27], v[164:167], v[196:199], v[24:27]
    s_waitcnt lgkmcnt(1)
    s_add_u32 s77, s99, 14336
    s_add_u32 m0, s76, 2048
    s_nop 0
    buffer_load_dwordx4 v245, s[56:59], s77 offen lds
    buffer_load_dwordx4 v246, s[56:59], s77 offen offset:1024 lds
    v_mfma_f32_16x16x32_bf16 v[44:47], v[168:171], v[196:199], v[44:47]
    v_mfma_f32_16x16x32_bf16 v[64:67], v[172:175], v[196:199], v[64:67]
    ds_read_b128 v[196:199], v247 offset:6144
    v_mfma_f32_16x16x32_bf16 v[8:11], v[160:163], v[200:203], v[8:11]
    s_cmp_eq_u32 s92, 1
    s_cbranch_scc1 L_sk32
    ds_write_b128 v229, v[80:83] offset:0
L_sk32:
    v_mfma_f32_16x16x32_bf16 v[28:31], v[164:167], v[200:203], v[28:31]
    s_waitcnt vmcnt(8)
    v_mfma_f32_16x16x32_bf16 v[48:51], v[168:171], v[200:203], v[48:51]
    ds_read_b64_tr_b16 v[178:179], v233 offset:4096
    ds_read_b64_tr_b16 v[182:183], v234 offset:4096
    v_mfma_f32_16x16x32_bf16 v[68:71], v[172:175], v[200:203], v[68:71]
    ds_read_b64_tr_b16 v[186:187], v235 offset:4096
    ds_read_b64_tr_b16 v[190:191], v236 offset:4096
    ds_read_b128 v[200:203], v247 offset:7168
    v_mfma_f32_16x16x32_bf16 v[12:15], v[160:163], v[204:207], v[12:15]
    v_mfma_f32_16x16x32_bf16 v[32:35], v[164:167], v[204:207], v[32:35]
    v_mfma_f32_16x16x32_bf16 v[52:55], v[168:171], v[204:207], v[52:55]
    v_mfma_f32_16x16x32_bf16 v[72:75], v[172:175], v[204:207], v[72:75]
    ds_read_b128 v[204:207], v247 offset:8192
    s_waitcnt lgkmcnt(2)
    s_add_u32 s99, s99, 28672
    s_sub_u32 s77, s99, 458752
    s_cselect_b32 s99, s99, s77
    s_add_u32 s77, s99, 0
    s_add_u32 m0, s76, 4096
    s_nop 0
    buffer_load_dwordx4 v245, s[56:59], s77 offen lds
    buffer_load_dwordx4 v246, s[56:59], s77 offen offset:1024 lds
    v_mfma_f32_16x16x32_bf16 v[16:19], v[160:163], v[208:211], v[16:19]
    v_mfma_f32_16x16x32_bf16 v[36:39], v[164:167], v[208:211], v[36:39]
    v_mfma_f32_16x16x32_bf16 v[56:59], v[168:171], v[208:211], v[56:59]
    s_cmp_eq_u32 s92, 1
    s_cbranch_scc1 L_sk33
    ds_write_b128 v229, v[84:87] offset:4096
L_sk33:
    v_mfma_f32_16x16x32_bf16 v[76:79], v[172:175], v[208:211], v[76:79]
    ds_read_b128 v[208:211], v247 offset:9216
    s_setprio 2
    s_waitcnt vmcnt(8)
    v_mfma_f32_16x16x32_bf16 v[0:3], v[176:179], v[192:195], v[0:3]
    ds_read_b64_tr_b16 v[160:161], v233 offset:6144
    ds_read_b64_tr_b16 v[164:165], v234 offset:6144
    v_mfma_f32_16x16x32_bf16 v[20:23], v[180:183], v[192:195], v[20:23]
    ds_read_b64_tr_b16 v[168:169], v235 offset:6144
    ds_read_b64_tr_b16 v[172:173], v236 offset:6144
    v_mfma_f32_16x16x32_bf16 v[40:43], v[184:187], v[192:195], v[40:43]
    v_mfma_f32_16x16x32_bf16 v[60:63], v[188:191], v[192:195], v[60:63]
    ds_read_b128 v[192:195], v247 offset:10240
    v_mfma_f32_16x16x32_bf16 v[4:7], v[176:179], v[196:199], v[4:7]
    v_mfma_f32_16x16x32_bf16 v[24:27], v[180:183], v[196:199], v[24:27]
    s_waitcnt lgkmcnt(1)
    s_add_u32 s77, s99, 14336
    s_add_u32 m0, s76, 6144
    s_nop 0
    buffer_load_dwordx4 v245, s[56:59], s77 offen lds
    buffer_load_dwordx4 v246, s[56:59], s77 offen offset:1024 lds
    v_mfma_f32_16x16x32_bf16 v[44:47], v[184:187], v[196:199], v[44:47]
    v_mfma_f32_16x16x32_bf16 v[64:67], v[188:191], v[196:199], v[64:67]
    ds_read_b128 v[196:199], v247 offset:11264
    v_mfma_f32_16x16x32_bf16 v[8:11], v[176:179], v[200:203], v[8:11]
    s_cmp_eq_u32 s92, 1
    s_cbranch_scc1 L_sk34
    ds_write_b128 v229, v[88:91] offset:8192
L_sk34:
    v_mfma_f32_16x16x32_bf16 v[28:31], v[180:183], v[200:203], v[28:31]
    s_waitcnt vmcnt(8)
    v_mfma_f32_16x16x32_bf16 v[48:51], v[184:187], v[200:203], v[48:51]
    ds_read_b64_tr_b16 v[162:163], v233 offset:8192
    ds_read_b64_tr_b16 v[166:167], v234 offset:8192
    v_mfma_f32_16x16x32_bf16 v[68:71], v[188:191], v[200:203], v[68:71]
    ds_read_b64_tr_b16 v[170:171], v235 offset:8192
    ds_read_b64_tr_b16 v[174:175], v236 offset:8192
    ds_read_b128 v[200:203], v247 offset:12288
    v_mfma_f32_16x16x32_bf16 v[12:15], v[176:179], v[204:207], v[12:15]
    v_mfma_f32_16x16x32_bf16 v[32:35], v[180:183], v[204:207], v[32:35]
    v_mfma_f32_16x16x32_bf16 v[52:55], v[184:187], v[204:207], v[52:55]
    v_mfma_f32_16x16x32_bf16 v[72:75], v[188:191], v[204:207], v[72:75]
    ds_read_b128 v[204:207], v247 offset:13312
    s_waitcnt lgkmcnt(2)
    s_add_u32 s99, s99, 28672
    s_sub_u32 s77, s99, 458752
    s_cselect_b32 s99, s99, s77
    s_add_u32 s77, s99, 0
    s_add_u32 m0, s76, 8192
    s_nop 0
    buffer_load_dwordx4 v245, s[56:59], s77 offen lds
    buffer_load_dwordx4 v246, s[56:59], s77 offen offset:1024 lds
    v_mfma_f32_16x16x32_bf16 v[16:19], v[176:179], v[208:211], v[16:19]
    v_mfma_f32_16x16x32_bf16 v[36:39], v[180:183], v[208:211], v[36:39]
    v_mfma_f32_16x16x32_bf16 v[56:59], v[184:187], v[208:211], v[56:59]
    s_cmp_eq_u32 s92, 1
    s_cbranch_scc1 L_sk35
    ds_write_b128 v229, v[92:95] offset:12288
L_sk35:
    v_mfma_f32_16x16x32_bf16 v[76:79], v[188:191], v[208:211], v[76:79]
    ds_read_b128 v[208:211], v247 offset:14336
    s_setprio 1
    s_waitcnt vmcnt(8)
    v_mfma_f32_16x16x32_bf16 v[0:3], v[160:163], v[192:195], v[0:3]
    ds_read_b64_tr_b16 v[176:177], v233
    ds_read_b64_tr_b16 v[180:181], v234
    v_mfma_f32_16x16x32_bf16 v[20:23], v[164:167], v[192:195], v[20:23]
    ds_read_b64_tr_b16 v[184:185], v235
    ds_read_b64_tr_b16 v[188:189], v236
    v_mfma_f32_16x16x32_bf16 v[40:43], v[168:171], v[192:195], v[40:43]
    v_mfma_f32_16x16x32_bf16 v[60:63], v[172:175], v[192:195], v[60:63]
    ds_read_b128 v[192:195], v247 offset:15360
    v_mfma_f32_16x16x32_bf16 v[4:7], v[160:163], v[196:199], v[4:7]
    v_mfma_f32_16x16x32_bf16 v[24:27], v[164:167], v[196:199], v[24:27]
    s_waitcnt lgkmcnt(1)
    s_add_u32 s77, s99, 14336
    s_add_u32 m0, s76, 0
    s_nop 0
    buffer_load_dwordx4 v245, s[56:59], s77 offen lds
    buffer_load_dwordx4 v246, s[56:59], s77 offen offset:1024 lds
    v_mfma_f32_16x16x32_bf16 v[44:47], v[168:171], v[196:199], v[44:47]
    v_mfma_f32_16x16x32_bf16 v[64:67], v[172:175], v[196:199], v[64:67]
    ds_read_b128 v[196:199], v247 offset:16384
    v_mfma_f32_16x16x32_bf16 v[8:11], v[160:163], v[200:203], v[8:11]
    s_cmp_eq_u32 s92, 1
    s_cbranch_scc1 L_sk36
    ds_write_b128 v229, v[96:99] offset:16384
L_sk36:
    v_mfma_f32_16x16x32_bf16 v[28:31], v[164:167], v[200:203], v[28:31]
    s_waitcnt vmcnt(8)
    v_mfma_f32_16x16x32_bf16 v[48:51], v[168:171], v[200:203], v[48:51]
    ds_read_b64_tr_b16 v[178:179], v233 offset:2048
    ds_read_b64_tr_b16 v[182:183], v234 offset:2048
    v_mfma_f32_16x16x32_bf16 v[68:71], v[172:175], v[200:203], v[68:71]
    ds_read_b64_tr_b16 v[186:187], v235 offset:2048
    ds_read_b64_tr_b16 v[190:191], v236 offset:2048
    ds_read_b128 v[200:203], v247 offset:17408
    v_mfma_f32_16x16x32_bf16 v[12:15], v[160:163], v[204:207], v[12:15]
    v_mfma_f32_16x16x32_bf16 v[32:35], v[164:167], v[204:207], v[32:35]
    v_mfma_f32_16x16x32_bf16 v[52:55], v[168:171], v[204:207], v[52:55]
    v_mfma_f32_16x16x32_bf16 v[72:75], v[172:175], v[204:207], v[72:75]
    ds_read_b128 v[204:207], v247 offset:18432
    s_waitcnt lgkmcnt(2)
    s_add_u32 s99, s99, 28672
    s_sub_u32 s77, s99, 458752
    s_cselect_b32 s99, s99, s77
    s_add_u32 s77, s99, 0
    s_add_u32 m0, s76, 2048
    s_nop 0
    buffer_load_dwordx4 v245, s[56:59], s77 offen lds
    buffer_load_dwordx4 v246, s[56:59], s77 offen offset:1024 lds
    v_mfma_f32_16x16x32_bf16 v[16:19], v[160:163], v[208:211], v[16:19]
    v_mfma_f32_16x16x32_bf16 v[36:39], v[164:167], v[208:211], v[36:39]
    v_mfma_f32_16x16x32_bf16 v[56:59], v[168:171], v[208:211], v[56:59]
    v_mfma_f32_16x16x32_bf16 v[76:79], v[172:175], v[208:211], v[76:79]
    ds_read_b128 v[208:211], v247 offset:19456
    s_setprio 0
    s_waitcnt vmcnt(8)
    v_mfma_f32_16x16x32_bf16 v[0:3], v[176:179], v[192:195], v[0:3]
    ds_read_b64_tr_b16 v[160:161], v233 offset:4096
    ds_read_b64_tr_b16 v[164:165], v234 offset:4096
    v_mfma_f32_16x16x32_bf16 v[20:23], v[180:183], v[192:195], v[20:23]
    ds_read_b64_tr_b16 v[168:169], v235 offset:4096
    ds_read_b64_tr_b16 v[172:173], v236 offset:4096
    v_mfma_f32_16x16x32_bf16 v[40:43], v[184:187], v[192:195], v[40:43]
    v_mfma_f32_16x16x32_bf16 v[60:63], v[188:191], v[192:195], v[60:63]
    ds_read_b128 v[192:195], v247 offset:20480
    v_mfma_f32_16x16x32_bf16 v[4:7], v[176:179], v[196:199], v[4:7]
    v_mfma_f32_16x16x32_bf16 v[24:27], v[180:183], v[196:199], v[24:27]
    s_waitcnt lgkmcnt(1)
    s_add_u32 s77, s99, 14336
    s_add_u32 m0, s76, 4096
    s_nop 0
    buffer_load_dwordx4 v245, s[56:59], s77 offen lds
    buffer_load_dwordx4 v246, s[56:59], s77 offen offset:1024 lds
    v_mfma_f32_16x16x32_bf16 v[44:47], v[184:187], v[196:199], v[44:47]
    v_mfma_f32_16x16x32_bf16 v[64:67], v[188:191], v[196:199], v[64:67]
    ds_read_b128 v[196:199], v247 offset:21504
    v_mfma_f32_16x16x32_bf16 v[8:11], v[176:179], v[200:203], v[8:11]
    v_mfma_f32_16x16x32_bf16 v[28:31], v[180:183], v[200:203], v[28:31]
    s_waitcnt vmcnt(8)
    v_mfma_f32_16x16x32_bf16 v[48:51], v[184:187], v[200:203], v[48:51]
    ds_read_b64_tr_b16 v[162:163], v233 offset:6144
    ds_read_b64_tr_b16 v[166:167], v234 offset:6144
    v_mfma_f32_16x16x32_bf16 v[68:71], v[188:191], v[200:203], v[68:71]
    ds_read_b64_tr_b16 v[170:171], v235 offset:6144
    ds_read_b64_tr_b16 v[174:175], v236 offset:6144
    ds_read_b128 v[200:203], v247 offset:22528
    v_mfma_f32_16x16x32_bf16 v[12:15], v[176:179], v[204:207], v[12:15]
    v_mfma_f32_16x16x32_bf16 v[32:35], v[180:183], v[204:207], v[32:35]
    v_mfma_f32_16x16x32_bf16 v[52:55], v[184:187], v[204:207], v[52:55]
    v_mfma_f32_16x16x32_bf16 v[72:75], v[188:191], v[204:207], v[72:75]
    ds_read_b128 v[204:207], v247 offset:23552
    s_waitcnt lgkmcnt(2)
    s_add_u32 s99, s99, 28672
    s_sub_u32 s77, s99, 458752
    s_cselect_b32 s99, s99, s77
    s_add_u32 s77, s99, 0
    s_add_u32 m0, s76, 6144
    s_nop 0
    buffer_load_dwordx4 v245, s[56:59], s77 offen lds
    buffer_load_dwordx4 v246, s[56:59], s77 offen offset:1024 lds
    v_mfma_f32_16x16x32_bf16 v[16:19], v[176:179], v[208:211], v[16:19]
    v_mfma_f32_16x16x32_bf16 v[36:39], v[180:183], v[208:211], v[36:39]
    v_mfma_f32_16x16x32_bf16 v[56:59], v[184:187], v[208:211], v[56:59]
    v_mfma_f32_16x16x32_bf16 v[76:79], v[188:191], v[208:211], v[76:79]
    ds_read_b128 v[208:211], v247 offset:24576
    s_setprio 3
    s_waitcnt vmcnt(8)
    v_mfma_f32_16x16x32_bf16 v[0:3], v[160:163], v[192:195], v[0:3]
    ds_read_b64_tr_b16 v[176:177], v233 offset:8192
    ds_read_b64_tr_b16 v[180:181], v234 offset:8192
    v_mfma_f32_16x16x32_bf16 v[20:23], v[164:167], v[192:195], v[20:23]
    ds_read_b64_tr_b16 v[184:185], v235 offset:8192
    ds_read_b64_tr_b16 v[188:189], v236 offset:8192
    v_mfma_f32_16x16x32_bf16 v[40:43], v[168:171], v[192:195], v[40:43]
    v_mfma_f32_16x16x32_bf16 v[60:63], v[172:175], v[192:195], v[60:63]
    ds_read_b128 v[192:195], v247 offset:25600
    v_mfma_f32_16x16x32_bf16 v[4:7], v[160:163], v[196:199], v[4:7]
    v_mfma_f32_16x16x32_bf16 v[24:27], v[164:167], v[196:199], v[24:27]
    s_waitcnt lgkmcnt(1)
    s_add_u32 s77, s99, 14336
    s_add_u32 m0, s76, 8192
    s_nop 0
    buffer_load_dwordx4 v245, s[56:59], s77 offen lds
    buffer_load_dwordx4 v246, s[56:59], s77 offen offset:1024 lds
    v_mfma_f32_16x16x32_bf16 v[44:47], v[168:171], v[196:199], v[44:47]
    v_mfma_f32_16x16x32_bf16 v[64:67], v[172:175], v[196:199], v[64:67]
    ds_read_b128 v[196:199], v247 offset:26624
    v_mfma_f32_16x16x32_bf16 v[8:11], v[160:163], v[200:203], v[8:11]
    v_mfma_f32_16x16x32_bf16 v[28:31], v[164:167], v[200:203], v[28:31]
    s_waitcnt vmcnt(8)
    v_mfma_f32_16x16x32_bf16 v[48:51], v[168:171], v[200:203], v[48:51]
    ds_read_b64_tr_b16 v[178:179], v233
    ds_read_b64_tr_b16 v[182:183], v234
    v_mfma_f32_16x16x32_bf16 v[68:71], v[172:175], v[200:203], v[68:71]
    ds_read_b64_tr_b16 v[186:187], v235
    ds_read_b64_tr_b16 v[190:191], v236
    ds_read_b128 v[200:203], v247 offset:27648
    v_mfma_f32_16x16x32_bf16 v[12:15], v[160:163], v[204:207], v[12:15]
    v_mfma_f32_16x16x32_bf16 v[32:35], v[164:167], v[204:207], v[32:35]
    v_mfma_f32_16x16x32_bf16 v[52:55], v[168:171], v[204:207], v[52:55]
    v_mfma_f32_16x16x32_bf16 v[72:75], v[172:175], v[204:207], v[72:75]
    ds_read_b128 v[204:207], v247 offset:28672
    s_waitcnt lgkmcnt(2)
    s_add_u32 s98, s98, 262144
    s_sub_u32 s77, s98, 3670016
    s_cselect_b32 s98, s98, s77
    s_add_u32 s77, s98, 0
    s_add_u32 m0, s76, 0
    s_nop 0
    buffer_load_dwordx4 v243, s[32:35], s77 offen lds
    buffer_load_dwordx4 v244, s[32:35], s77 offen offset:1024 lds
    v_mfma_f32_16x16x32_bf16 v[16:19], v[160:163], v[208:211], v[16:19]
    v_mfma_f32_16x16x32_bf16 v[36:39], v[164:167], v[208:211], v[36:39]
    v_mfma_f32_16x16x32_bf16 v[56:59], v[168:171], v[208:211], v[56:59]
    v_mfma_f32_16x16x32_bf16 v[76:79], v[172:175], v[208:211], v[76:79]
    ds_read_b128 v[208:211], v247 offset:29696
    s_setprio 2
    s_waitcnt vmcnt(8)
    s_barrier
    v_mfma_f32_16x16x32_bf16 v[0:3], v[176:179], v[192:195], v[0:3]
    ds_read_b64_tr_b16 v[160:161], v233 offset:2048
    ds_read_b64_tr_b16 v[164:165], v234 offset:2048
    v_mfma_f32_16x16x32_bf16 v[20:23], v[180:183], v[192:195], v[20:23]
    ds_read_b64_tr_b16 v[168:169], v235 offset:2048
    ds_read_b64_tr_b16 v[172:173], v236 offset:2048
    v_mfma_f32_16x16x32_bf16 v[40:43], v[184:187], v[192:195], v[40:43]
    v_mfma_f32_16x16x32_bf16 v[60:63], v[188:191], v[192:195], v[60:63]
    ds_read_b128 v[192:195], v247 offset:30720
    v_mfma_f32_16x16x32_bf16 v[4:7], v[176:179], v[196:199], v[4:7]
    v_mfma_f32_16x16x32_bf16 v[24:27], v[180:183], v[196:199], v[24:27]
    s_waitcnt lgkmcnt(1)
    s_add_u32 s77, s98, 32768
    s_add_u32 m0, s76, 2048
    s_nop 0
    buffer_load_dwordx4 v243, s[32:35], s77 offen lds
    buffer_load_dwordx4 v244, s[32:35], s77 offen offset:1024 lds
    v_mfma_f32_16x16x32_bf16 v[44:47], v[184:187], v[196:199], v[44:47]
    v_mfma_f32_16x16x32_bf16 v[64:67], v[188:191], v[196:199], v[64:67]
    ds_read_b128 v[196:199], v247 offset:31744
    v_mfma_f32_16x16x32_bf16 v[8:11], v[176:179], v[200:203], v[8:11]
    v_mfma_f32_16x16x32_bf16 v[28:31], v[180:183], v[200:203], v[28:31]
    s_waitcnt vmcnt(8)
    v_mfma_f32_16x16x32_bf16 v[48:51], v[184:187], v[200:203], v[48:51]
    ds_read_b64_tr_b16 v[162:163], v233 offset:4096
    ds_read_b64_tr_b16 v[166:167], v234 offset:4096
    v_mfma_f32_16x16x32_bf16 v[68:71], v[188:191], v[200:203], v[68:71]
    ds_read_b64_tr_b16 v[170:171], v235 offset:4096
    ds_read_b64_tr_b16 v[174:175], v236 offset:4096
    ds_read_b128 v[200:203], v247 offset:32768
    v_mfma_f32_16x16x32_bf16 v[12:15], v[176:179], v[204:207], v[12:15]
    v_mfma_f32_16x16x32_bf16 v[32:35], v[180:183], v[204:207], v[32:35]
    v_mfma_f32_16x16x32_bf16 v[52:55], v[184:187], v[204:207], v[52:55]
    v_mfma_f32_16x16x32_bf16 v[72:75], v[188:191], v[204:207], v[72:75]
    ds_read_b128 v[204:207], v247 offset:33792
    s_waitcnt lgkmcnt(2)
    s_add_u32 s98, s98, 262144
    s_sub_u32 s77, s98, 3670016
    s_cselect_b32 s98, s98, s77
    s_add_u32 s77, s98, 0
    s_add_u32 m0, s76, 4096
    s_nop 0
    buffer_load_dwordx4 v243, s[32:35], s77 offen lds
    buffer_load_dwordx4 v244, s[32:35], s77 offen offset:1024 lds
    v_mfma_f32_16x16x32_bf16 v[16:19], v[176:179], v[208:211], v[16:19]
    v_mfma_f32_16x16x32_bf16 v[36:39], v[180:183], v[208:211], v[36:39]
    v_mfma_f32_16x16x32_bf16 v[56:59], v[184:187], v[208:211], v[56:59]
    v_mfma_f32_16x16x32_bf16 v[76:79], v[188:191], v[208:211], v[76:79]
    ds_read_b128 v[208:211], v247 offset:34816
    s_setprio 1
    s_waitcnt vmcnt(8)
    v_mfma_f32_16x16x32_bf16 v[0:3], v[160:163], v[192:195], v[0:3]
    ds_read_b64_tr_b16 v[176:177], v233 offset:6144
    ds_read_b64_tr_b16 v[180:181], v234 offset:6144
    v_mfma_f32_16x16x32_bf16 v[20:23], v[164:167], v[192:195], v[20:23]
    ds_read_b64_tr_b16 v[184:185], v235 offset:6144
    ds_read_b64_tr_b16 v[188:189], v236 offset:6144
    v_mfma_f32_16x16x32_bf16 v[40:43], v[168:171], v[192:195], v[40:43]
    v_mfma_f32_16x16x32_bf16 v[60:63], v[172:175], v[192:195], v[60:63]
    ds_read_b128 v[192:195], v247 offset:35840
    v_mfma_f32_16x16x32_bf16 v[4:7], v[160:163], v[196:199], v[4:7]
    v_mfma_f32_16x16x32_bf16 v[24:27], v[164:167], v[196:199], v[24:27]
    s_waitcnt lgkmcnt(1)
    s_add_u32 s77, s98, 32768
    s_add_u32 m0, s76, 6144
    s_nop 0
    buffer_load_dwordx4 v243, s[32:35], s77 offen lds
    buffer_load_dwordx4 v244, s[32:35], s77 offen offset:1024 lds
    v_mfma_f32_16x16x32_bf16 v[44:47], v[168:171], v[196:199], v[44:47]
    v_mfma_f32_16x16x32_bf16 v[64:67], v[172:175], v[196:199], v[64:67]
    ds_read_b128 v[196:199], v247 offset:36864
    v_mfma_f32_16x16x32_bf16 v[8:11], v[160:163], v[200:203], v[8:11]
    v_mfma_f32_16x16x32_bf16 v[28:31], v[164:167], v[200:203], v[28:31]
    s_waitcnt vmcnt(8)
    v_mfma_f32_16x16x32_bf16 v[48:51], v[168:171], v[200:203], v[48:51]
    ds_read_b64_tr_b16 v[178:179], v233 offset:8192
    ds_read_b64_tr_b16 v[182:183], v234 offset:8192
    v_mfma_f32_16x16x32_bf16 v[68:71], v[172:175], v[200:203], v[68:71]
    ds_read_b64_tr_b16 v[186:187], v235 offset:8192
    ds_read_b64_tr_b16 v[190:191], v236 offset:8192
    ds_read_b128 v[200:203], v247 offset:37888
    v_mfma_f32_16x16x32_bf16 v[12:15], v[160:163], v[204:207], v[12:15]
    v_mfma_f32_16x16x32_bf16 v[32:35], v[164:167], v[204:207], v[32:35]
    v_mfma_f32_16x16x32_bf16 v[52:55], v[168:171], v[204:207], v[52:55]
    v_mfma_f32_16x16x32_bf16 v[72:75], v[172:175], v[204:207], v[72:75]
    ds_read_b128 v[204:207], v247 offset:38912
    s_waitcnt lgkmcnt(2)
    s_add_u32 s98, s98, 262144
    s_sub_u32 s77, s98, 3670016
    s_cselect_b32 s98, s98, s77
    s_add_u32 s77, s98, 0
    s_add_u32 m0, s76, 8192
    s_nop 0
    buffer_load_dwordx4 v243, s[32:35], s77 offen lds
    buffer_load_dwordx4 v244, s[32:35], s77 offen offset:1024 lds
    v_mfma_f32_16x16x32_bf16 v[16:19], v[160:163], v[208:211], v[16:19]
    v_mfma_f32_16x16x32_bf16 v[36:39], v[164:167], v[208:211], v[36:39]
    v_mfma_f32_16x16x32_bf16 v[56:59], v[168:171], v[208:211], v[56:59]
    v_mfma_f32_16x16x32_bf16 v[76:79], v[172:175], v[208:211], v[76:79]
    ds_read_b128 v[208:211], v247 offset:39936
    s_setprio 0
    s_waitcnt vmcnt(8)
    v_mfma_f32_16x16x32_bf16 v[0:3], v[176:179], v[192:195], v[0:3]
    ds_read_b64_tr_b16 v[160:161], v233
    ds_read_b64_tr_b16 v[164:165], v234
    v_mfma_f32_16x16x32_bf16 v[20:23], v[180:183], v[192:195], v[20:23]
    ds_read_b64_tr_b16 v[168:169], v235
    ds_read_b64_tr_b16 v[172:173], v236
    v_mfma_f32_16x16x32_bf16 v[40:43], v[184:187], v[192:195], v[40:43]
    v_mfma_f32_16x16x32_bf16 v[60:63], v[188:191], v[192:195], v[60:63]
    ds_read_b128 v[192:195], v237
    v_mfma_f32_16x16x32_bf16 v[4:7], v[176:179], v[196:199], v[4:7]
    v_mfma_f32_16x16x32_bf16 v[24:27], v[180:183], v[196:199], v[24:27]
    s_waitcnt lgkmcnt(1)
    s_add_u32 s77, s98, 32768
    s_add_u32 m0, s76, 0
    s_nop 0
    buffer_load_dwordx4 v243, s[32:35], s77 offen lds
    buffer_load_dwordx4 v244, s[32:35], s77 offen offset:1024 lds
    v_mfma_f32_16x16x32_bf16 v[44:47], v[184:187], v[196:199], v[44:47]
    v_mfma_f32_16x16x32_bf16 v[64:67], v[188:191], v[196:199], v[64:67]
    ds_read_b128 v[196:199], v237 offset:4096
    v_cvt_pk_bf16_f32 v120, v0, v1
    v_cvt_pk_bf16_f32 v121, v2, v3
    v_cvt_pk_bf16_f32 v122, v20, v21
    v_mfma_f32_16x16x32_bf16 v[8:11], v[176:179], v[200:203], v[8:11]
    v_cvt_pk_bf16_f32 v123, v22, v23
    v_cvt_pk_bf16_f32 v140, v40, v41
    v_cvt_pk_bf16_f32 v141, v42, v43
    v_mfma_f32_16x16x32_bf16 v[28:31], v[180:183], v[200:203], v[28:31]
    v_cvt_pk_bf16_f32 v142, v60, v61
    v_cvt_pk_bf16_f32 v143, v62, v63
    s_waitcnt vmcnt(8)
    v_mfma_f32_16x16x32_bf16 v[48:51], v[184:187], v[200:203], v[48:51]
    ds_read_b64_tr_b16 v[162:163], v233 offset:2048
    ds_read_b64_tr_b16 v[166:167], v234 offset:2048
    v_mfma_f32_16x16x32_bf16 v[68:71], v[188:191], v[200:203], v[68:71]
    ds_read_b64_tr_b16 v[170:171], v235 offset:2048
    ds_read_b64_tr_b16 v[174:175], v236 offset:2048
    ds_read_b128 v[200:203], v237 offset:8192
    v_cvt_pk_bf16_f32 v124, v4, v5
    v_cvt_pk_bf16_f32 v125, v6, v7
    v_cvt_pk_bf16_f32 v126, v24, v25
    v_mfma_f32_16x16x32_bf16 v[12:15], v[176:179], v[204:207], v[12:15]
    v_cvt_pk_bf16_f32 v127, v26, v27
    v_cvt_pk_bf16_f32 v144, v44, v45
    v_cvt_pk_bf16_f32 v145, v46, v47
    v_mfma_f32_16x16x32_bf16 v[32:35], v[180:183], v[204:207], v[32:35]
    v_cvt_pk_bf16_f32 v146, v64, v65
    v_cvt_pk_bf16_f32 v147, v66, v67
    v_mfma_f32_16x16x32_bf16 v[52:55], v[184:187], v[204:207], v[52:55]
    v_mfma_f32_16x16x32_bf16 v[72:75], v[188:191], v[204:207], v[72:75]
    ds_read_b128 v[204:207], v237 offset:12288
    s_waitcnt lgkmcnt(2)
    s_add_u32 s98, s98, 262144
    s_sub_u32 s77, s98, 3670016
    s_cselect_b32 s98, s98, s77
    s_add_u32 s77, s98, 0
    s_add_u32 m0, s76, 2048
    s_nop 0
    buffer_load_dwordx4 v243, s[32:35], s77 offen lds
    buffer_load_dwordx4 v244, s[32:35], s77 offen offset:1024 lds
    v_cvt_pk_bf16_f32 v128, v8, v9
    v_cvt_pk_bf16_f32 v129, v10, v11
    v_cvt_pk_bf16_f32 v130, v28, v29
    v_mfma_f32_16x16x32_bf16 v[16:19], v[176:179], v[208:211], v[16:19]
    v_cvt_pk_bf16_f32 v131, v30, v31
    v_cvt_pk_bf16_f32 v148, v48, v49
    v_cvt_pk_bf16_f32 v149, v50, v51
    v_mfma_f32_16x16x32_bf16 v[36:39], v[180:183], v[208:211], v[36:39]
    v_cvt_pk_bf16_f32 v150, v68, v69
    v_cvt_pk_bf16_f32 v151, v70, v71
    v_mfma_f32_16x16x32_bf16 v[56:59], v[184:187], v[208:211], v[56:59]
    v_mfma_f32_16x16x32_bf16 v[76:79], v[188:191], v[208:211], v[76:79]
    ds_read_b128 v[208:211], v237 offset:16384
    v_cvt_pk_bf16_f32 v132, v12, v13
    v_cvt_pk_bf16_f32 v133, v14, v15
    v_cvt_pk_bf16_f32 v134, v32, v33
    v_cvt_pk_bf16_f32 v135, v34, v35
    v_cvt_pk_bf16_f32 v152, v52, v53
    v_cvt_pk_bf16_f32 v153, v54, v55
    v_cvt_pk_bf16_f32 v154, v72, v73
    v_cvt_pk_bf16_f32 v155, v74, v75
    v_cvt_pk_bf16_f32 v136, v16, v17
    v_cvt_pk_bf16_f32 v137, v18, v19
    v_cvt_pk_bf16_f32 v138, v36, v37
    v_cvt_pk_bf16_f32 v139, v38, v39
    v_cvt_pk_bf16_f32 v156, v56, v57
    v_cvt_pk_bf16_f32 v157, v58, v59
    v_cvt_pk_bf16_f32 v158, v76, v77
    v_cvt_pk_bf16_f32 v159, v78, v79
L_oend0:
    s_mov_b64 s[44:45], s[72:73]
    s_mov_b32 s46, 71680
    s_add_u32 s92, s92, 1
    s_cmp_eq_u32 s92, 2
    s_cbranch_scc1 L_final
L_body1:
    s_setprio 3
    s_waitcnt vmcnt(8)
    s_waitcnt lgkmcnt(4)
    v_mfma_f32_16x16x32_bf16 v[0:3], v[160:163], v[192:195], 0
    ds_read_b64_tr_b16 v[176:177], v233 offset:4096
    ds_read_b64_tr_b16 v[180:181], v234 offset:4096
    v_mfma_f32_16x16x32_bf16 v[20:23], v[164:167], v[192:195], 0
    ds_read_b64_tr_b16 v[184:185], v235 offset:4096
    ds_read_b64_tr_b16 v[188:189], v236 offset:4096
    v_mfma_f32_16x16x32_bf16 v[40:43], v[168:171], v[192:195], 0
    v_mfma_f32_16x16x32_bf16 v[60:63], v[172:175], v[192:195], 0
    ds_read_b128 v[192:195], v238
    s_waitcnt lgkmcnt(8)
    v_mfma_f32_16x16x32_bf16 v[4:7], v[160:163], v[196:199], 0
    v_mfma_f32_16x16x32_bf16 v[24:27], v[164:167], v[196:199], 0
    s_cmp_eq_u32 s92, 0
    s_cbranch_scc1 L_sk37
    s_add_u32 s88, s82, 0
    buffer_store_dwordx4 v[120:123], v230, s[44:47], s88 offen sc1
L_sk37:
    s_waitcnt lgkmcnt(1)
    s_add_u32 s77, s98, 32768
    s_add_u32 m0, s76, 4096
    s_nop 0
    buffer_load_dwordx4 v243, s[32:35], s77 offen lds
    buffer_load_dwordx4 v244, s[32:35], s77 offen offset:1024 lds
    v_mfma_f32_16x16x32_bf16 v[44:47], v[168:171], v[196:199], 0
    v_mfma_f32_16x16x32_bf16 v[64:67], v[172:175], v[196:199], 0
    ds_read_b128 v[196:199], v238 offset:4096
    v_mfma_f32_16x16x32_bf16 v[8:11], v[160:163], v[200:203], 0
    v_mfma_f32_16x16x32_bf16 v[28:31], v[164:167], v[200:203], 0
    s_waitcnt vmcnt(8)
    v_mfma_f32_16x16x32_bf16 v[48:51], v[168:171], v[200:203], 0
    ds_read_b64_tr_b16 v[178:179], v233 offset:6144
    ds_read_b64_tr_b16 v[182:183], v234 offset:6144
    v_mfma_f32_16x16x32_bf16 v[68:71], v[172:175], v[200:203], 0
    ds_read_b64_tr_b16 v[186:187], v235 offset:6144
    ds_read_b64_tr_b16 v[190:191], v236 offset:6144
    ds_read_b128 v[200:203], v238 offset:8192
    v_mfma_f32_16x16x32_bf16 v[12:15], v[160:163], v[204:207], 0
    v_mfma_f32_16x16x32_bf16 v[32:35], v[164:167], v[204:207], 0
    s_cmp_eq_u32 s92, 0
    s_cbranch_scc1 L_sk38
    s_add_u32 s88, s82, 1024
    buffer_store_dwordx4 v[124:127], v230, s[44:47], s88 offen sc1
L_sk38:
    v_mfma_f32_16x16x32_bf16 v[52:55], v[168:171], v[204:207], 0
    v_mfma_f32_16x16x32_bf16 v[72:75], v[172:175], v[204:207], 0
    ds_read_b128 v[204:207], v238 offset:12288
    s_waitcnt lgkmcnt(2)
    s_add_u32 s98, s98, 262144
    s_sub_u32 s77, s98, 3670016
    s_cselect_b32 s98, s98, s77
    s_add_u32 s77, s98, 0
    s_add_u32 m0, s76, 6144
    s_nop 0
    buffer_load_dwordx4 v243, s[32:35], s77 offen lds
    buffer_load_dwordx4 v244, s[32:35], s77 offen offset:1024 lds
    v_mfma_f32_16x16x32_bf16 v[16:19], v[160:163], v[208:211], 0
    v_mfma_f32_16x16x32_bf16 v[36:39], v[164:167], v[208:211], 0
    v_mfma_f32_16x16x32_bf16 v[56:59], v[168:171], v[208:211], 0
    v_mfma_f32_16x16x32_bf16 v[76:79], v[172:175], v[208:211], 0
    ds_read_b128 v[208:211], v238 offset:16384
    s_setprio 2
    s_waitcnt vmcnt(8)
    s_barrier
    v_mfma_f32_16x16x32_bf16 v[0:3], v[176:179], v[192:195], v[0:3]
    ds_read_b64_tr_b16 v[160:161], v233 offset:8192
    ds_read_b64_tr_b16 v[164:165], v234 offset:8192
    v_mfma_f32_16x16x32_bf16 v[20:23], v[180:183], v[192:195], v[20:23]
    ds_read_b64_tr_b16 v[168:169], v235 offset:8192
    ds_read_b64_tr_b16 v[172:173], v236 offset:8192
    v_mfma_f32_16x16x32_bf16 v[40:43], v[184:187], v[192:195], v[40:43]
    v_mfma_f32_16x16x32_bf16 v[60:63], v[188:191], v[192:195], v[60:63]
    ds_read_b128 v[192:195], v239
    v_mfma_f32_16x16x32_bf16 v[4:7], v[176:179], v[196:199], v[4:7]
    v_mfma_f32_16x16x32_bf16 v[24:27], v[180:183], v[196:199], v[24:27]
    s_cmp_eq_u32 s92, 0
    s_cbranch_scc1 L_sk39
    s_add_u32 s88, s82, 2048
    buffer_store_dwordx4 v[128:131], v230, s[44:47], s88 offen sc1
L_sk39:
    s_waitcnt lgkmcnt(1)
    s_add_u32 s77, s98, 32768
    s_add_u32 m0, s76, 8192
    s_nop 0
    buffer_load_dwordx4 v243, s[32:35], s77 offen lds
    buffer_load_dwordx4 v244, s[32:35], s77 offen offset:1024 lds
    v_mfma_f32_16x16x32_bf16 v[44:47], v[184:187], v[196:199], v[44:47]
    v_mfma_f32_16x16x32_bf16 v[64:67], v[188:191], v[196:199], v[64:67]
    ds_read_b128 v[196:199], v239 offset:4096
    v_mfma_f32_16x16x32_bf16 v[8:11], v[176:179], v[200:203], v[8:11]
    s_cmp_eq_u32 s92, 0
    s_cbranch_scc1 L_sk40
    ds_write_b128 v229, v[100:103] offset:40960
L_sk40:
    v_mfma_f32_16x16x32_bf16 v[28:31], v[180:183], v[200:203], v[28:31]
    s_waitcnt vmcnt(8)
    v_mfma_f32_16x16x32_bf16 v[48:51], v[184:187], v[200:203], v[48:51]
    ds_read_b64_tr_b16 v[162:163], v233
    ds_read_b64_tr_b16 v[166:167], v234
    v_mfma_f32_16x16x32_bf16 v[68:71], v[188:191], v[200:203], v[68:71]
    ds_read_b64_tr_b16 v[170:171], v235
    ds_read_b64_tr_b16 v[174:175], v236
    ds_read_b128 v[200:203], v239 offset:8192
    v_mfma_f32_16x16x32_bf16 v[12:15], v[176:179], v[204:207], v[12:15]
    v_mfma_f32_16x16x32_bf16 v[32:35], v[180:183], v[204:207], v[32:35]
    s_cmp_eq_u32 s92, 0
    s_cbranch_scc1 L_sk41
    s_add_u32 s88, s82, 3072
    buffer_store_dwordx4 v[132:135], v230, s[44:47], s88 offen sc1
L_sk41:
    v_mfma_f32_16x16x32_bf16 v[52:55], v[184:187], v[204:207], v[52:55]
    v_mfma_f32_16x16x32_bf16 v[72:75], v[188:191], v[204:207], v[72:75]
    ds_read_b128 v[204:207], v239 offset:12288
    s_waitcnt lgkmcnt(2)
    s_add_u32 s98, s98, 262144
    s_sub_u32 s77, s98, 3670016
    s_cselect_b32 s98, s98, s77
    s_add_u32 s77, s98, 0
    s_add_u32 m0, s76, 0
    s_nop 0
    buffer_load_dwordx4 v243, s[32:35], s77 offen lds
    buffer_load_dwordx4 v244, s[32:35], s77 offen offset:1024 lds
    v_mfma_f32_16x16x32_bf16 v[16:19], v[176:179], v[208:211], v[16:19]
    v_mfma_f32_16x16x32_bf16 v[36:39], v[180:183], v[208:211], v[36:39]
    v_mfma_f32_16x16x32_bf16 v[56:59], v[184:187], v[208:211], v[56:59]
    s_cmp_eq_u32 s92, 0
    s_cbranch_scc1 L_sk42
    ds_write_b128 v229, v[104:107] offset:45056
L_sk42:
    v_mfma_f32_16x16x32_bf16 v[76:79], v[188:191], v[208:211], v[76:79]
    ds_read_b128 v[208:211], v239 offset:16384
    s_setprio 1
    s_waitcnt vmcnt(8)
    v_mfma_f32_16x16x32_bf16 v[0:3], v[160:163], v[192:195], v[0:3]
    ds_read_b64_tr_b16 v[176:177], v233 offset:2048
    ds_read_b64_tr_b16 v[180:181], v234 offset:2048
    v_mfma_f32_16x16x32_bf16 v[20:23], v[164:167], v[192:195], v[20:23]
    ds_read_b64_tr_b16 v[184:185], v235 offset:2048
    ds_read_b64_tr_b16 v[188:189], v236 offset:2048
    v_mfma_f32_16x16x32_bf16 v[40:43], v[168:171], v[192:195], v[40:43]
    v_mfma_f32_16x16x32_bf16 v[60:63], v[172:175], v[192:195], v[60:63]
    ds_read_b128 v[192:195], v240
    v_mfma_f32_16x16x32_bf16 v[4:7], v[160:163], v[196:199], v[4:7]
    v_mfma_f32_16x16x32_bf16 v[24:27], v[164:167], v[196:199], v[24:27]
    s_cmp_eq_u32 s92, 0
    s_cbranch_scc1 L_sk43
    s_add_u32 s88, s82, 4096
    buffer_store_dwordx4 v[136:139], v230, s[44:47], s88 offen sc1
L_sk43:
    s_waitcnt lgkmcnt(1)
    s_add_u32 s77, s98, 32768
    s_add_u32 m0, s76, 2048
    s_nop 0
    buffer_load_dwordx4 v243, s[32:35], s77 offen lds
    buffer_load_dwordx4 v244, s[32:35], s77 offen offset:1024 lds
    v_mfma_f32_16x16x32_bf16 v[44:47], v[168:171], v[196:199], v[44:47]
    v_mfma_f32_16x16x32_bf16 v[64:67], v[172:175], v[196:199], v[64:67]
    ds_read_b128 v[196:199], v240 offset:4096
    v_mfma_f32_16x16x32_bf16 v[8:11], v[160:163], v[200:203], v[8:11]
    s_cmp_eq_u32 s92, 0
    s_cbranch_scc1 L_sk44
    ds_write_b128 v229, v[108:111] offset:49152
L_sk44:
    v_mfma_f32_16x16x32_bf16 v[28:31], v[164:167], v[200:203], v[28:31]
    s_waitcnt vmcnt(8)
    v_mfma_f32_16x16x32_bf16 v[48:51], v[168:171], v[200:203], v[48:51]
    ds_read_b64_tr_b16 v[178:179], v233 offset:4096
    ds_read_b64_tr_b16 v[182:183], v234 offset:4096
    v_mfma_f32_16x16x32_bf16 v[68:71], v[172:175], v[200:203], v[68:71]
    ds_read_b64_tr_b16 v[186:187], v235 offset:4096
    ds_read_b64_tr_b16 v[190:191], v236 offset:4096
    ds_read_b128 v[200:203], v240 offset:8192
    v_mfma_f32_16x16x32_bf16 v[12:15], v[160:163], v[204:207], v[12:15]
    v_mfma_f32_16x16x32_bf16 v[32:35], v[164:167], v[204:207], v[32:35]
    s_cmp_eq_u32 s92, 0
    s_cbranch_scc1 L_sk45
    s_add_u32 s88, s82, 5120
    buffer_store_dwordx4 v[140:143], v230, s[44:47], s88 offen sc1
L_sk45:
    v_mfma_f32_16x16x32_bf16 v[52:55], v[168:171], v[204:207], v[52:55]
    v_mfma_f32_16x16x32_bf16 v[72:75], v[172:175], v[204:207], v[72:75]
    ds_read_b128 v[204:207], v240 offset:12288
    s_waitcnt lgkmcnt(2)
    s_add_u32 s98, s98, 262144
    s_sub_u32 s77, s98, 3670016
    s_cselect_b32 s98, s98, s77
    s_add_u32 s77, s98, 0
    s_add_u32 m0, s76, 4096
    s_nop 0
    buffer_load_dwordx4 v243, s[32:35], s77 offen lds
    buffer_load_dwordx4 v244, s[32:35], s77 offen offset:1024 lds
    v_mfma_f32_16x16x32_bf16 v[16:19], v[160:163], v[208:211], v[16:19]
    v_mfma_f32_16x16x32_bf16 v[36:39], v[164:167], v[208:211], v[36:39]
    v_mfma_f32_16x16x32_bf16 v[56:59], v[168:171], v[208:211], v[56:59]
    s_cmp_eq_u32 s92, 0
    s_cbranch_scc1 L_sk46
    ds_write_b128 v229, v[112:115] offset:53248
L_sk46:
    v_mfma_f32_16x16x32_bf16 v[76:79], v[172:175], v[208:211], v[76:79]
    ds_read_b128 v[208:211], v240 offset:16384
    s_setprio 0
    s_waitcnt vmcnt(8)
    v_mfma_f32_16x16x32_bf16 v[0:3], v[176:179], v[192:195], v[0:3]
    ds_read_b64_tr_b16 v[160:161], v233 offset:6144
    ds_read_b64_tr_b16 v[164:165], v234 offset:6144
    v_mfma_f32_16x16x32_bf16 v[20:23], v[180:183], v[192:195], v[20:23]
    ds_read_b64_tr_b16 v[168:169], v235 offset:6144
    ds_read_b64_tr_b16 v[172:173], v236 offset:6144
    v_mfma_f32_16x16x32_bf16 v[40:43], v[184:187], v[192:195], v[40:43]
    v_mfma_f32_16x16x32_bf16 v[60:63], v[188:191], v[192:195], v[60:63]
    ds_read_b128 v[192:195], v237 offset:20480
    v_mfma_f32_16x16x32_bf16 v[4:7], v[176:179], v[196:199], v[4:7]
    v_mfma_f32_16x16x32_bf16 v[24:27], v[180:183], v[196:199], v[24:27]
    s_cmp_eq_u32 s92, 0
    s_cbranch_scc1 L_sk47
    s_add_u32 s88, s82, 6144
    buffer_store_dwordx4 v[144:147], v230, s[44:47], s88 offen sc1
L_sk47:
    s_waitcnt lgkmcnt(1)
    s_add_u32 s77, s98, 32768
    s_add_u32 m0, s76, 6144
    s_nop 0
    buffer_load_dwordx4 v243, s[32:35], s77 offen lds
    buffer_load_dwordx4 v244, s[32:35], s77 offen offset:1024 lds
    v_mfma_f32_16x16x32_bf16 v[44:47], v[184:187], v[196:199], v[44:47]
    v_mfma_f32_16x16x32_bf16 v[64:67], v[188:191], v[196:199], v[64:67]
    ds_read_b128 v[196:199], v237 offset:24576
    v_mfma_f32_16x16x32_bf16 v[8:11], v[176:179], v[200:203], v[8:11]
    s_cmp_eq_u32 s92, 0
    s_cbranch_scc1 L_sk48
    ds_write_b128 v229, v[116:119] offset:57344
L_sk48:
    v_mfma_f32_16x16x32_bf16 v[28:31], v[180:183], v[200:203], v[28:31]
    s_waitcnt vmcnt(8)
    v_mfma_f32_16x16x32_bf16 v[48:51], v[184:187], v[200:203], v[48:51]
    ds_read_b64_tr_b16 v[162:163], v233 offset:8192
    ds_read_b64_tr_b16 v[166:167], v234 offset:8192
    v_mfma_f32_16x16x32_bf16 v[68:71], v[188:191], v[200:203], v[68:71]
    ds_read_b64_tr_b16 v[170:171], v235 offset:8192
    ds_read_b64_tr_b16 v[174:175], v236 offset:8192
    ds_read_b128 v[200:203], v237 offset:28672
    v_mfma_f32_16x16x32_bf16 v[12:15], v[176:179], v[204:207], v[12:15]
    v_mfma_f32_16x16x32_bf16 v[32:35], v[180:183], v[204:207], v[32:35]
    s_cmp_eq_u32 s92, 0
    s_cbranch_scc1 L_sk49
    s_add_u32 s88, s82, 7168
    buffer_store_dwordx4 v[148:151], v230, s[44:47], s88 offen sc1
L_sk49:
    v_mfma_f32_16x16x32_bf16 v[52:55], v[184:187], v[204:207], v[52:55]
    v_mfma_f32_16x16x32_bf16 v[72:75], v[188:191], v[204:207], v[72:75]
    ds_read_b128 v[204:207], v237 offset:32768
    s_waitcnt lgkmcnt(2)
    s_add_u32 s98, s98, 262144
    s_sub_u32 s77, s98, 3670016
    s_cselect_b32 s98, s98, s77
    s_add_u32 s77, s98, 0
    s_add_u32 m0, s76, 8192
    s_nop 0
    buffer_load_dwordx4 v243, s[32:35], s77 offen lds
    buffer_load_dwordx4 v244, s[32:35], s77 offen offset:1024 lds
    v_mfma_f32_16x16x32_bf16 v[16:19], v[176:179], v[208:211], v[16:19]
    v_mfma_f32_16x16x32_bf16 v[36:39], v[180:183], v[208:211], v[36:39]
    v_mfma_f32_16x16x32_bf16 v[56:59], v[184:187], v[208:211], v[56:59]
    v_mfma_f32_16x16x32_bf16 v[76:79], v[188:191], v[208:211], v[76:79]
    ds_read_b128 v[208:211], v237 offset:36864
    s_setprio 3
    s_waitcnt vmcnt(8)
    v_mfma_f32_16x16x32_bf16 v[0:3], v[160:163], v[192:195], v[0:3]
    ds_read_b64_tr_b16 v[176:177], v233
    ds_read_b64_tr_b16 v[180:181], v234
    v_mfma_f32_16x16x32_bf16 v[20:23], v[164:167], v[192:195], v[20:23]
    ds_read_b64_tr_b16 v[184:185], v235
    ds_read_b64_tr_b16 v[188:189], v236
    v_mfma_f32_16x16x32_bf16 v[40:43], v[168:171], v[192:195], v[40:43]
    v_mfma_f32_16x16x32_bf16 v[60:63], v[172:175], v[192:195], v[60:63]
    ds_read_b128 v[192:195], v238 offset:20480
    v_mfma_f32_16x16x32_bf16 v[4:7], v[160:163], v[196:199], v[4:7]
    v_mfma_f32_16x16x32_bf16 v[24:27], v[164:167], v[196:199], v[24:27]
    s_cmp_eq_u32 s92, 0
    s_cbranch_scc1 L_sk50
    s_add_u32 s88, s82, 8192
    buffer_store_dwordx4 v[152:155], v230, s[44:47], s88 offen sc1
L_sk50:
    s_waitcnt lgkmcnt(1)
    s_add_u32 s77, s98, 32768
    s_add_u32 m0, s76, 0
    s_nop 0
    buffer_load_dwordx4 v243, s[32:35], s77 offen lds
    buffer_load_dwordx4 v244, s[32:35], s77 offen offset:1024 lds
    v_mfma_f32_16x16x32_bf16 v[44:47], v[168:171], v[196:199], v[44:47]
    v_mfma_f32_16x16x32_bf16 v[64:67], v[172:175], v[196:199], v[64:67]
    ds_read_b128 v[196:199], v238 offset:24576
    v_mfma_f32_16x16x32_bf16 v[8:11], v[160:163], v[200:203], v[8:11]
    v_mfma_f32_16x16x32_bf16 v[28:31], v[164:167], v[200:203], v[28:31]
    s_waitcnt vmcnt(8)
    v_mfma_f32_16x16x32_bf16 v[48:51], v[168:171], v[200:203], v[48:51]
    ds_read_b64_tr_b16 v[178:179], v233 offset:2048
    ds_read_b64_tr_b16 v[182:183], v234 offset:2048
    v_mfma_f32_16x16x32_bf16 v[68:71], v[172:175], v[200:203], v[68:71]
    ds_read_b64_tr_b16 v[186:187], v235 offset:2048
    ds_read_b64_tr_b16 v[190:191], v236 offset:2048
    ds_read_b128 v[200:203], v238 offset:28672
    v_mfma_f32_16x16x32_bf16 v[12:15], v[160:163], v[204:207], v[12:15]
    v_mfma_f32_16x16x32_bf16 v[32:35], v[164:167], v[204:207], v[32:35]
    s_cmp_eq_u32 s92, 0
    s_cbranch_scc1 L_sk51
    s_add_u32 s88, s82, 9216
    buffer_store_dwordx4 v[156:159], v230, s[44:47], s88 offen sc1
L_sk51:
    v_mfma_f32_16x16x32_bf16 v[52:55], v[168:171], v[204:207], v[52:55]
    v_mfma_f32_16x16x32_bf16 v[72:75], v[172:175], v[204:207], v[72:75]
    ds_read_b128 v[204:207], v238 offset:32768
    s_waitcnt lgkmcnt(2)
    s_add_u32 s98, s98, 262144
    s_sub_u32 s77, s98, 3670016
    s_cselect_b32 s98, s98, s77
    s_add_u32 s77, s98, 0
    s_add_u32 m0, s76, 2048
    s_nop 0
    buffer_load_dwordx4 v243, s[32:35], s77 offen lds
    buffer_load_dwordx4 v244, s[32:35], s77 offen offset:1024 lds
    v_mfma_f32_16x16x32_bf16 v[16:19], v[160:163], v[208:211], v[16:19]
    v_mfma_f32_16x16x32_bf16 v[36:39], v[164:167], v[208:211], v[36:39]
    v_mfma_f32_16x16x32_bf16 v[56:59], v[168:171], v[208:211], v[56:59]
    v_mfma_f32_16x16x32_bf16 v[76:79], v[172:175], v[208:211], v[76:79]
    ds_read_b128 v[208:211], v238 offset:36864
    s_setprio 2
    s_waitcnt vmcnt(8)
    v_mfma_f32_16x16x32_bf16 v[0:3], v[176:179], v[192:195], v[0:3]
    ds_read_b64_tr_b16 v[160:161], v233 offset:4096
    ds_read_b64_tr_b16 v[164:165], v234 offset:4096
    v_mfma_f32_16x16x32_bf16 v[20:23], v[180:183], v[192:195], v[20:23]
    ds_read_b64_tr_b16 v[168:169], v235 offset:4096
    ds_read_b64_tr_b16 v[172:173], v236 offset:4096
    v_mfma_f32_16x16x32_bf16 v[40:43], v[184:187], v[192:195], v[40:43]
    v_mfma_f32_16x16x32_bf16 v[60:63], v[188:191], v[192:195], v[60:63]
    ds_read_b128 v[192:195], v239 offset:20480
    v_mfma_f32_16x16x32_bf16 v[4:7], v[176:179], v[196:199], v[4:7]
    v_mfma_f32_16x16x32_bf16 v[24:27], v[180:183], v[196:199], v[24:27]
    s_waitcnt lgkmcnt(1)
    s_add_u32 s77, s98, 32768
    s_add_u32 m0, s76, 4096
    s_nop 0
    buffer_load_dwordx4 v243, s[32:35], s77 offen lds
    buffer_load_dwordx4 v244, s[32:35], s77 offen offset:1024 lds
    v_mfma_f32_16x16x32_bf16 v[44:47], v[184:187], v[196:199], v[44:47]
    v_mfma_f32_16x16x32_bf16 v[64:67], v[188:191], v[196:199], v[64:67]
    ds_read_b128 v[196:199], v239 offset:24576
    v_mfma_f32_16x16x32_bf16 v[8:11], v[176:179], v[200:203], v[8:11]
    v_mfma_f32_16x16x32_bf16 v[28:31], v[180:183], v[200:203], v[28:31]
    s_waitcnt vmcnt(8)
    v_mfma_f32_16x16x32_bf16 v[48:51], v[184:187], v[200:203], v[48:51]
    ds_read_b64_tr_b16 v[162:163], v233 offset:6144
    ds_read_b64_tr_b16 v[166:167], v234 offset:6144
    v_mfma_f32_16x16x32_bf16 v[68:71], v[188:191], v[200:203], v[68:71]
    ds_read_b64_tr_b16 v[170:171], v235 offset:6144
    ds_read_b64_tr_b16 v[174:175], v236 offset:6144
    ds_read_b128 v[200:203], v239 offset:28672
    v_mfma_f32_16x16x32_bf16 v[12:15], v[176:179], v[204:207], v[12:15]
    v_mfma_f32_16x16x32_bf16 v[32:35], v[180:183], v[204:207], v[32:35]
    v_mfma_f32_16x16x32_bf16 v[52:55], v[184:187], v[204:207], v[52:55]
    v_mfma_f32_16x16x32_bf16 v[72:75], v[188:191], v[204:207], v[72:75]
    ds_read_b128 v[204:207], v239 offset:32768
    s_waitcnt lgkmcnt(2)
    s_add_u32 s98, s98, 262144
    s_sub_u32 s77, s98, 3670016
    s_cselect_b32 s98, s98, s77
    s_add_u32 s77, s98, 0
    s_add_u32 m0, s76, 6144
    s_nop 0
    buffer_load_dwordx4 v243, s[32:35], s77 offen lds
    buffer_load_dwordx4 v244, s[32:35], s77 offen offset:1024 lds
    v_mfma_f32_16x16x32_bf16 v[16:19], v[176:179], v[208:211], v[16:19]
    v_mfma_f32_16x16x32_bf16 v[36:39], v[180:183], v[208:211], v[36:39]
    v_mfma_f32_16x16x32_bf16 v[56:59], v[184:187], v[208:211], v[56:59]
    v_mfma_f32_16x16x32_bf16 v[76:79], v[188:191], v[208:211], v[76:79]
    ds_read_b128 v[208:211], v239 offset:36864
    s_setprio 1
    s_waitcnt vmcnt(8)
    v_mfma_f32_16x16x32_bf16 v[0:3], v[160:163], v[192:195], v[0:3]
    ds_read_b64_tr_b16 v[176:177], v233 offset:8192
    ds_read_b64_tr_b16 v[180:181], v234 offset:8192
    v_mfma_f32_16x16x32_bf16 v[20:23], v[164:167], v[192:195], v[20:23]
    ds_read_b64_tr_b16 v[184:185], v235 offset:8192
    ds_read_b64_tr_b16 v[188:189], v236 offset:8192
    v_mfma_f32_16x16x32_bf16 v[40:43], v[168:171], v[192:195], v[40:43]
    v_mfma_f32_16x16x32_bf16 v[60:63], v[172:175], v[192:195], v[60:63]
    ds_read_b128 v[192:195], v240 offset:20480
    v_mfma_f32_16x16x32_bf16 v[4:7], v[160:163], v[196:199], v[4:7]
    v_mfma_f32_16x16x32_bf16 v[24:27], v[164:167], v[196:199], v[24:27]
    s_waitcnt lgkmcnt(1)
    s_add_u32 s77, s98, 32768
    s_add_u32 m0, s76, 8192
    s_nop 0
    buffer_load_dwordx4 v243, s[32:35], s77 offen lds
    buffer_load_dwordx4 v244, s[32:35], s77 offen offset:1024 lds
    v_mfma_f32_16x16x32_bf16 v[44:47], v[168:171], v[196:199], v[44:47]
    v_mfma_f32_16x16x32_bf16 v[64:67], v[172:175], v[196:199], v[64:67]
    ds_read_b128 v[196:199], v240 offset:24576
    v_mfma_f32_16x16x32_bf16 v[8:11], v[160:163], v[200:203], v[8:11]
    v_mfma_f32_16x16x32_bf16 v[28:31], v[164:167], v[200:203], v[28:31]
    s_waitcnt vmcnt(8)
    v_mfma_f32_16x16x32_bf16 v[48:51], v[168:171], v[200:203], v[48:51]
    ds_read_b64_tr_b16 v[178:179], v233
    ds_read_b64_tr_b16 v[182:183], v234
    v_mfma_f32_16x16x32_bf16 v[68:71], v[172:175], v[200:203], v[68:71]
    ds_read_b64_tr_b16 v[186:187], v235
    ds_read_b64_tr_b16 v[190:191], v236
    ds_read_b128 v[200:203], v240 offset:28672
    v_mfma_f32_16x16x32_bf16 v[12:15], v[160:163], v[204:207], v[12:15]
    v_mfma_f32_16x16x32_bf16 v[32:35], v[164:167], v[204:207], v[32:35]
    v_mfma_f32_16x16x32_bf16 v[52:55], v[168:171], v[204:207], v[52:55]
    v_mfma_f32_16x16x32_bf16 v[72:75], v[172:175], v[204:207], v[72:75]
    ds_read_b128 v[204:207], v240 offset:32768
    s_waitcnt lgkmcnt(2)
    s_add_u32 s98, s98, 262144
    s_sub_u32 s77, s98, 3670016
    s_cselect_b32 s98, s98, s77
    s_add_u32 s77, s98, 0
    s_add_u32 m0, s76, 0
    s_nop 0
    buffer_load_dwordx4 v243, s[32:35], s77 offen lds
    buffer_load_dwordx4 v244, s[32:35], s77 offen offset:1024 lds
    v_mfma_f32_16x16x32_bf16 v[16:19], v[160:163], v[208:211], v[16:19]
    v_mfma_f32_16x16x32_bf16 v[36:39], v[164:167], v[208:211], v[36:39]
    v_mfma_f32_16x16x32_bf16 v[56:59], v[168:171], v[208:211], v[56:59]
    v_mfma_f32_16x16x32_bf16 v[76:79], v[172:175], v[208:211], v[76:79]
    ds_read_b128 v[208:211], v240 offset:36864
    s_setprio 0
    s_waitcnt vmcnt(8)
    s_barrier
    v_mfma_f32_16x16x32_bf16 v[0:3], v[176:179], v[192:195], v[0:3]
    ds_read_b64_tr_b16 v[160:161], v233 offset:2048
    ds_read_b64_tr_b16 v[164:165], v234 offset:2048
    v_mfma_f32_16x16x32_bf16 v[20:23], v[180:183], v[192:195], v[20:23]
    ds_read_b64_tr_b16 v[168:169], v235 offset:2048
    ds_read_b64_tr_b16 v[172:173], v236 offset:2048
    v_mfma_f32_16x16x32_bf16 v[40:43], v[184:187], v[192:195], v[40:43]
    v_mfma_f32_16x16x32_bf16 v[60:63], v[188:191], v[192:195], v[60:63]
    ds_read_b128 v[192:195], v237 offset:40960
    v_mfma_f32_16x16x32_bf16 v[4:7], v[176:179], v[196:199], v[4:7]
    v_mfma_f32_16x16x32_bf16 v[24:27], v[180:183], v[196:199], v[24:27]
    s_waitcnt lgkmcnt(1)
    s_add_u32 s77, s98, 32768
    s_add_u32 m0, s76, 2048
    s_nop 0
    buffer_load_dwordx4 v243, s[32:35], s77 offen lds
    buffer_load_dwordx4 v244, s[32:35], s77 offen offset:1024 lds
    v_mfma_f32_16x16x32_bf16 v[44:47], v[184:187], v[196:199], v[44:47]
    v_mfma_f32_16x16x32_bf16 v[64:67], v[188:191], v[196:199], v[64:67]
    ds_read_b128 v[196:199], v237 offset:45056
    v_mfma_f32_16x16x32_bf16 v[8:11], v[176:179], v[200:203], v[8:11]
    v_mfma_f32_16x16x32_bf16 v[28:31], v[180:183], v[200:203], v[28:31]
    s_waitcnt vmcnt(8)
    v_mfma_f32_16x16x32_bf16 v[48:51], v[184:187], v[200:203], v[48:51]
    ds_read_b64_tr_b16 v[162:163], v233 offset:4096
    ds_read_b64_tr_b16 v[166:167], v234 offset:4096
    v_mfma_f32_16x16x32_bf16 v[68:71], v[188:191], v[200:203], v[68:71]
    ds_read_b64_tr_b16 v[170:171], v235 offset:4096
    ds_read_b64_tr_b16 v[174:175], v236 offset:4096
    ds_read_b128 v[200:203], v237 offset:49152
    v_mfma_f32_16x16x32_bf16 v[12:15], v[176:179], v[204:207], v[12:15]
    v_mfma_f32_16x16x32_bf16 v[32:35], v[180:183], v[204:207], v[32:35]
    v_mfma_f32_16x16x32_bf16 v[52:55], v[184:187], v[204:207], v[52:55]
    v_mfma_f32_16x16x32_bf16 v[72:75], v[188:191], v[204:207], v[72:75]
    ds_read_b128 v[204:207], v237 offset:53248
    s_waitcnt lgkmcnt(2)
    s_add_u32 s98, s98, 262144
    s_sub_u32 s77, s98, 3670016
    s_cselect_b32 s98, s98, s77
    s_add_u32 s77, s98, 0
    s_add_u32 m0, s76, 4096
    s_nop 0
    buffer_load_dwordx4 v243, s[32:35], s77 offen lds
    buffer_load_dwordx4 v244, s[32:35], s77 offen offset:1024 lds
    v_mfma_f32_16x16x32_bf16 v[16:19], v[176:179], v[208:211], v[16:19]
    v_mfma_f32_16x16x32_bf16 v[36:39], v[180:183], v[208:211], v[36:39]
    v_mfma_f32_16x16x32_bf16 v[56:59], v[184:187], v[208:211], v[56:59]
    v_mfma_f32_16x16x32_bf16 v[76:79], v[188:191], v[208:211], v[76:79]
    ds_read_b128 v[208:211], v237 offset:57344
    s_setprio 3
    s_waitcnt vmcnt(8)
    v_mfma_f32_16x16x32_bf16 v[0:3], v[160:163], v[192:195], v[0:3]
    ds_read_b64_tr_b16 v[176:177], v233 offset:6144
    ds_read_b64_tr_b16 v[180:181], v234 offset:6144
    v_mfma_f32_16x16x32_bf16 v[20:23], v[164:167], v[192:195], v[20:23]
    ds_read_b64_tr_b16 v[184:185], v235 offset:6144
    ds_read_b64_tr_b16 v[188:189], v236 offset:6144
    v_mfma_f32_16x16x32_bf16 v[40:43], v[168:171], v[192:195], v[40:43]
    v_mfma_f32_16x16x32_bf16 v[60:63], v[172:175], v[192:195], v[60:63]
    ds_read_b128 v[192:195], v238 offset:40960
    v_mfma_f32_16x16x32_bf16 v[4:7], v[160:163], v[196:199], v[4:7]
    v_mfma_f32_16x16x32_bf16 v[24:27], v[164:167], v[196:199], v[24:27]
    s_waitcnt lgkmcnt(1)
    s_add_u32 s77, s98, 32768
    s_add_u32 m0, s76, 6144
    s_nop 0
    buffer_load_dwordx4 v243, s[32:35], s77 offen lds
    buffer_load_dwordx4 v244, s[32:35], s77 offen offset:1024 lds
    v_mfma_f32_16x16x32_bf16 v[44:47], v[168:171], v[196:199], v[44:47]
    v_mfma_f32_16x16x32_bf16 v[64:67], v[172:175], v[196:199], v[64:67]
    ds_read_b128 v[196:199], v238 offset:45056
    v_mfma_f32_16x16x32_bf16 v[8:11], v[160:163], v[200:203], v[8:11]
    v_mfma_f32_16x16x32_bf16 v[28:31], v[164:167], v[200:203], v[28:31]
    s_waitcnt vmcnt(8)
    v_mfma_f32_16x16x32_bf16 v[48:51], v[168:171], v[200:203], v[48:51]
    ds_read_b64_tr_b16 v[178:179], v233 offset:8192
    ds_read_b64_tr_b16 v[182:183], v234 offset:8192
    v_mfma_f32_16x16x32_bf16 v[68:71], v[172:175], v[200:203], v[68:71]
    ds_read_b64_tr_b16 v[186:187], v235 offset:8192
    ds_read_b64_tr_b16 v[190:191], v236 offset:8192
    ds_read_b128 v[200:203], v238 offset:49152
    v_mfma_f32_16x16x32_bf16 v[12:15], v[160:163], v[204:207], v[12:15]
    v_mfma_f32_16x16x32_bf16 v[32:35], v[164:167], v[204:207], v[32:35]
    v_mfma_f32_16x16x32_bf16 v[52:55], v[168:171], v[204:207], v[52:55]
    v_mfma_f32_16x16x32_bf16 v[72:75], v[172:175], v[204:207], v[72:75]
    ds_read_b128 v[204:207], v238 offset:53248
    s_waitcnt lgkmcnt(2)
    s_add_u32 s98, s98, 262144
    s_sub_u32 s77, s98, 3670016
    s_cselect_b32 s98, s98, s77
    s_add_u32 s77, s98, 0
    s_add_u32 m0, s76, 8192
    s_nop 0
    buffer_load_dwordx4 v243, s[32:35], s77 offen lds
    buffer_load_dwordx4 v244, s[32:35], s77 offen offset:1024 lds
    v_mfma_f32_16x16x32_bf16 v[16:19], v[160:163], v[208:211], v[16:19]
    v_mfma_f32_16x16x32_bf16 v[36:39], v[164:167], v[208:211], v[36:39]
    v_mfma_f32_16x16x32_bf16 v[56:59], v[168:171], v[208:211], v[56:59]
    v_mfma_f32_16x16x32_bf16 v[76:79], v[172:175], v[208:211], v[76:79]
    ds_read_b128 v[208:211], v238 offset:57344
    s_setprio 2
    s_waitcnt vmcnt(8)
    v_mfma_f32_16x16x32_bf16 v[0:3], v[176:179], v[192:195], v[0:3]
    ds_read_b64_tr_b16 v[160:161], v233
    ds_read_b64_tr_b16 v[164:165], v234
    v_mfma_f32_16x16x32_bf16 v[20:23], v[180:183], v[192:195], v[20:23]
    ds_read_b64_tr_b16 v[168:169], v235
    ds_read_b64_tr_b16 v[172:173], v236
    v_mfma_f32_16x16x32_bf16 v[40:43], v[184:187], v[192:195], v[40:43]
    v_mfma_f32_16x16x32_bf16 v[60:63], v[188:191], v[192:195], v[60:63]
    ds_read_b128 v[192:195], v239 offset:40960
    v_mfma_f32_16x16x32_bf16 v[4:7], v[176:179], v[196:199], v[4:7]
    v_mfma_f32_16x16x32_bf16 v[24:27], v[180:183], v[196:199], v[24:27]
    s_waitcnt lgkmcnt(1)
    s_add_u32 s77, s98, 32768
    s_add_u32 m0, s76, 0
    s_nop 0
    buffer_load_dwordx4 v243, s[32:35], s77 offen lds
    buffer_load_dwordx4 v244, s[32:35], s77 offen offset:1024 lds
    v_mfma_f32_16x16x32_bf16 v[44:47], v[184:187], v[196:199], v[44:47]
    v_mfma_f32_16x16x32_bf16 v[64:67], v[188:191], v[196:199], v[64:67]
    ds_read_b128 v[196:199], v239 offset:45056
    v_mfma_f32_16x16x32_bf16 v[8:11], v[176:179], v[200:203], v[8:11]
    v_mfma_f32_16x16x32_bf16 v[28:31], v[180:183], v[200:203], v[28:31]
    s_waitcnt vmcnt(8)
    v_mfma_f32_16x16x32_bf16 v[48:51], v[184:187], v[200:203], v[48:51]
    ds_read_b64_tr_b16 v[162:163], v233 offset:2048
    ds_read_b64_tr_b16 v[166:167], v234 offset:2048
    v_mfma_f32_16x16x32_bf16 v[68:71], v[188:191], v[200:203], v[68:71]
    ds_read_b64_tr_b16 v[170:171], v235 offset:2048
    ds_read_b64_tr_b16 v[174:175], v236 offset:2048
    ds_read_b128 v[200:203], v239 offset:49152
    v_mfma_f32_16x16x32_bf16 v[12:15], v[176:179], v[204:207], v[12:15]
    v_mfma_f32_16x16x32_bf16 v[32:35], v[180:183], v[204:207], v[32:35]
    v_mfma_f32_16x16x32_bf16 v[52:55], v[184:187], v[204:207], v[52:55]
    v_mfma_f32_16x16x32_bf16 v[72:75], v[188:191], v[204:207], v[72:75]
    ds_read_b128 v[204:207], v239 offset:53248
    s_waitcnt lgkmcnt(2)
    s_add_u32 s98, s98, 262144
    s_sub_u32 s77, s98, 3670016
    s_cselect_b32 s98, s98, s77
    s_add_u32 s77, s98, 0
    s_add_u32 m0, s76, 2048
    s_nop 0
    buffer_load_dwordx4 v243, s[32:35], s77 offen lds
    buffer_load_dwordx4 v244, s[32:35], s77 offen offset:1024 lds
    v_mfma_f32_16x16x32_bf16 v[16:19], v[176:179], v[208:211], v[16:19]
    v_mfma_f32_16x16x32_bf16 v[36:39], v[180:183], v[208:211], v[36:39]
    v_mfma_f32_16x16x32_bf16 v[56:59], v[184:187], v[208:211], v[56:59]
    v_mfma_f32_16x16x32_bf16 v[76:79], v[188:191], v[208:211], v[76:79]
    ds_read_b128 v[208:211], v239 offset:57344
    s_setprio 1
    s_waitcnt vmcnt(8)
    v_mfma_f32_16x16x32_bf16 v[0:3], v[160:163], v[192:195], v[0:3]
    ds_read_b64_tr_b16 v[176:177], v233 offset:4096
    ds_read_b64_tr_b16 v[180:181], v234 offset:4096
    v_mfma_f32_16x16x32_bf16 v[20:23], v[164:167], v[192:195], v[20:23]
    ds_read_b64_tr_b16 v[184:185], v235 offset:4096
    ds_read_b64_tr_b16 v[188:189], v236 offset:4096
    ds_read_b128 v[80:83], v242
    v_mfma_f32_16x16x32_bf16 v[40:43], v[168:171], v[192:195], v[40:43]
    v_mfma_f32_16x16x32_bf16 v[60:63], v[172:175], v[192:195], v[60:63]
    ds_read_b128 v[192:195], v240 offset:40960
    v_mfma_f32_16x16x32_bf16 v[4:7], v[160:163], v[196:199], v[4:7]
    v_mfma_f32_16x16x32_bf16 v[24:27], v[164:167], v[196:199], v[24:27]
    ds_read_b128 v[84:87], v242 offset:4096
    s_waitcnt lgkmcnt(3)
    s_add_u32 s77, s98, 32768
    s_add_u32 m0, s76, 4096
    s_nop 0
    buffer_load_dwordx4 v243, s[32:35], s77 offen lds
    buffer_load_dwordx4 v244, s[32:35], s77 offen offset:1024 lds
    s_mov_b64 s[28:29], s[36:37]
    s_mov_b32 s30, s38
    s_mov_b64 s[32:33], s[40:41]
    s_mov_b32 s34, s42
    s_mov_b32 s38, 0
    s_mov_b32 s42, 0
    v_mfma_f32_16x16x32_bf16 v[44:47], v[168:171], v[196:199], v[44:47]
    v_mfma_f32_16x16x32_bf16 v[64:67], v[172:175], v[196:199], v[64:67]
    ds_read_b128 v[196:199], v240 offset:45056
    v_mfma_f32_16x16x32_bf16 v[8:11], v[160:163], v[200:203], v[8:11]
    v_mfma_f32_16x16x32_bf16 v[28:31], v[164:167], v[200:203], v[28:31]
    ds_read_b128 v[88:91], v242 offset:8192
    s_waitcnt vmcnt(8)
    v_mfma_f32_16x16x32_bf16 v[48:51], v[168:171], v[200:203], v[48:51]
    ds_read_b64_tr_b16 v[178:179], v233 offset:6144
    ds_read_b64_tr_b16 v[182:183], v234 offset:6144
    v_mfma_f32_16x16x32_bf16 v[68:71], v[172:175], v[200:203], v[68:71]
    ds_read_b64_tr_b16 v[186:187], v235 offset:6144
    ds_read_b64_tr_b16 v[190:191], v236 offset:6144
    ds_read_b128 v[200:203], v240 offset:49152
    v_mfma_f32_16x16x32_bf16 v[12:15], v[160:163], v[204:207], v[12:15]
    v_mfma_f32_16x16x32_bf16 v[32:35], v[164:167], v[204:207], v[32:35]
    ds_read_b128 v[92:95], v242 offset:12288
    v_mfma_f32_16x16x32_bf16 v[52:55], v[168:171], v[204:207], v[52:55]
    v_mfma_f32_16x16x32_bf16 v[72:75], v[172:175], v[204:207], v[72:75]
    ds_read_b128 v[204:207], v240 offset:53248
    s_waitcnt lgkmcnt(3)
    s_add_u32 s77, s94, 0
    s_add_u32 m0, s76, 6144
    s_nop 0
    buffer_load_dwordx4 v218, s[60:63], s77 offen nt lds
    buffer_load_dwordx4 v219, s[60:63], s77 offen offset:1024 nt lds
    v_mfma_f32_16x16x32_bf16 v[16:19], v[160:163], v[208:211], v[16:19]
    v_mfma_f32_16x16x32_bf16 v[36:39], v[164:167], v[208:211], v[36:39]
    ds_read_b128 v[96:99], v242 offset:16384
    v_mfma_f32_16x16x32_bf16 v[56:59], v[168:171], v[208:211], v[56:59]
    v_mfma_f32_16x16x32_bf16 v[76:79], v[172:175], v[208:211], v[76:79]
    ds_read_b128 v[208:211], v240 offset:57344
    s_setprio 0
    s_waitcnt vmcnt(8)
    v_mfma_f32_16x16x32_bf16 v[0:3], v[176:179], v[192:195], v[0:3]
    ds_read_b64_tr_b16 v[160:161], v233 offset:8192
    ds_read_b64_tr_b16 v[164:165], v234 offset:8192
    v_mfma_f32_16x16x32_bf16 v[20:23], v[180:183], v[192:195], v[20:23]
    ds_read_b64_tr_b16 v[168:169], v235 offset:8192
    ds_read_b64_tr_b16 v[172:173], v236 offset:8192
    v_mfma_f32_16x16x32_bf16 v[40:43], v[184:187], v[192:195], v[40:43]
    v_mfma_f32_16x16x32_bf16 v[60:63], v[188:191], v[192:195], v[60:63]
    ds_read_b128 v[192:195], v241
    v_mfma_f32_16x16x32_bf16 v[4:7], v[176:179], v[196:199], v[4:7]
    v_mfma_f32_16x16x32_bf16 v[24:27], v[180:183], v[196:199], v[24:27]
    s_waitcnt lgkmcnt(1)
    s_add_u32 s77, s94, 8192
    s_add_u32 m0, s76, 8192
    s_nop 0
    buffer_load_dwordx4 v218, s[60:63], s77 offen nt lds
    buffer_load_dwordx4 v219, s[60:63], s77 offen offset:1024 nt lds
    v_mfma_f32_16x16x32_bf16 v[44:47], v[184:187], v[196:199], v[44:47]
    v_mfma_f32_16x16x32_bf16 v[64:67], v[188:191], v[196:199], v[64:67]
    ds_read_b128 v[196:199], v241 offset:4096
    v_mfma_f32_16x16x32_bf16 v[8:11], v[176:179], v[200:203], v[8:11]
    v_mfma_f32_16x16x32_bf16 v[28:31], v[180:183], v[200:203], v[28:31]
    s_waitcnt vmcnt(8)
    v_mfma_f32_16x16x32_bf16 v[48:51], v[184:187], v[200:203], v[48:51]
    ds_read_b64_tr_b16 v[162:163], v233
    ds_read_b64_tr_b16 v[166:167], v234
    v_mfma_f32_16x16x32_bf16 v[68:71], v[188:191], v[200:203], v[68:71]
    ds_read_b64_tr_b16 v[170:171], v235
    ds_read_b64_tr_b16 v[174:175], v236
    ds_read_b128 v[200:203], v241 offset:8192
    v_mfma_f32_16x16x32_bf16 v[12:15], v[176:179], v[204:207], v[12:15]
    v_mfma_f32_16x16x32_bf16 v[32:35], v[180:183], v[204:207], v[32:35]
    v_mfma_f32_16x16x32_bf16 v[52:55], v[184:187], v[204:207], v[52:55]
    v_mfma_f32_16x16x32_bf16 v[72:75], v[188:191], v[204:207], v[72:75]
    ds_read_b128 v[204:207], v241 offset:12288
    s_waitcnt lgkmcnt(2)
    s_add_u32 s77, s94, 16384
    s_add_u32 m0, s76, 0
    s_nop 0
    buffer_load_dwordx4 v218, s[60:63], s77 offen nt lds
    buffer_load_dwordx4 v219, s[60:63], s77 offen offset:1024 nt lds
    v_mfma_f32_16x16x32_bf16 v[16:19], v[176:179], v[208:211], v[16:19]
    v_mfma_f32_16x16x32_bf16 v[36:39], v[180:183], v[208:211], v[36:39]
    v_mfma_f32_16x16x32_bf16 v[56:59], v[184:187], v[208:211], v[56:59]
    v_mfma_f32_16x16x32_bf16 v[76:79], v[188:191], v[208:211], v[76:79]
    ds_read_b128 v[208:211], v241 offset:16384
    s_setprio 3
    s_waitcnt vmcnt(8)
    v_mfma_f32_16x16x32_bf16 v[0:3], v[160:163], v[192:195], v[0:3]
    ds_read_b64_tr_b16 v[176:177], v233 offset:2048
    ds_read_b64_tr_b16 v[180:181], v234 offset:2048
    v_mfma_f32_16x16x32_bf16 v[20:23], v[164:167], v[192:195], v[20:23]
    ds_read_b64_tr_b16 v[184:185], v235 offset:2048
    ds_read_b64_tr_b16 v[188:189], v236 offset:2048
    s_waitcnt vmcnt(6)
    v_mfma_f32_16x16x32_bf16 v[40:43], v[168:171], v[192:195], v[40:43]
    ds_read_b64_tr_b16 v[178:179], v233 offset:4096
    ds_read_b64_tr_b16 v[182:183], v234 offset:4096
    v_mfma_f32_16x16x32_bf16 v[60:63], v[172:175], v[192:195], v[60:63]
    ds_read_b64_tr_b16 v[186:187], v235 offset:4096
    ds_read_b64_tr_b16 v[190:191], v236 offset:4096
    v_mfma_f32_16x16x32_bf16 v[4:7], v[160:163], v[196:199], v[4:7]
    v_mfma_f32_16x16x32_bf16 v[24:27], v[164:167], v[196:199], v[24:27]
    v_mfma_f32_16x16x32_bf16 v[44:47], v[168:171], v[196:199], v[44:47]
    v_mfma_f32_16x16x32_bf16 v[64:67], v[172:175], v[196:199], v[64:67]
    s_waitcnt lgkmcnt(0)
    s_barrier
    v_mfma_f32_16x16x32_bf16 v[0:3], v[176:179], v[80:83], v[0:3]
    s_add_u32 s77, s94, 24576
    s_add_u32 m0, s76, 2048
    s_nop 0
    buffer_load_dwordx4 v218, s[60:63], s77 offen nt lds
    buffer_load_dwordx4 v219, s[60:63], s77 offen offset:1024 nt lds
    v_mfma_f32_16x16x32_bf16 v[20:23], v[180:183], v[80:83], v[20:23]
    s_add_u32 s77, s95, 0
    s_add_u32 m0, s76, 4096
    s_nop 0
    buffer_load_dwordx4 v218, s[60:63], s77 offen nt lds
    buffer_load_dwordx4 v219, s[60:63], s77 offen offset:1024 nt lds
    v_mfma_f32_16x16x32_bf16 v[40:43], v[184:187], v[80:83], v[40:43]
    s_mul_i32 s88, s94, 80
    v_add_u32 v225, s88, v224
    v_mfma_f32_16x16x32_bf16 v[60:63], v[188:191], v[80:83], v[60:63]
    v_mfma_f32_16x16x32_bf16 v[8:11], v[160:163], v[200:203], v[8:11]
    v_mfma_f32_16x16x32_bf16 v[28:31], v[164:167], v[200:203], v[28:31]
    v_mfma_f32_16x16x32_bf16 v[48:51], v[168:171], v[200:203], v[48:51]
    v_cvt_pk_bf16_f32 v0, v0, v1
    v_cvt_pk_bf16_f32 v1, v2, v3
    v_cvt_pk_bf16_f32 v2, v20, v21
    v_mfma_f32_16x16x32_bf16 v[68:71], v[172:175], v[200:203], v[68:71]
    v_cvt_pk_bf16_f32 v3, v22, v23
    v_cvt_pk_bf16_f32 v40, v40, v41
    v_cvt_pk_bf16_f32 v41, v42, v43
    v_mfma_f32_16x16x32_bf16 v[4:7], v[176:179], v[84:87], v[4:7]
    v_cvt_pk_bf16_f32 v42, v60, v61
    v_cvt_pk_bf16_f32 v43, v62, v63
    v_permlane16_swap_b32 v0, v2
    v_mfma_f32_16x16x32_bf16 v[24:27], v[180:183], v[84:87], v[24:27]
    v_permlane16_swap_b32 v1, v3
    v_permlane16_swap_b32 v40, v42
    v_permlane16_swap_b32 v41, v43
    v_mfma_f32_16x16x32_bf16 v[44:47], v[184:187], v[84:87], v[44:47]
    ds_write_b128 v231, v[0:3]
    ds_write_b128 v231, v[40:43] offset:5120
    v_mfma_f32_16x16x32_bf16 v[64:67], v[188:191], v[84:87], v[64:67]
    s_setprio 2
    v_mfma_f32_16x16x32_bf16 v[12:15], v[160:163], v[204:207], v[12:15]
    v_mfma_f32_16x16x32_bf16 v[32:35], v[164:167], v[204:207], v[32:35]
    v_mfma_f32_16x16x32_bf16 v[52:55], v[168:171], v[204:207], v[52:55]
    v_cvt_pk_bf16_f32 v4, v4, v5
    v_cvt_pk_bf16_f32 v5, v6, v7
    v_cvt_pk_bf16_f32 v6, v24, v25
    v_mfma_f32_16x16x32_bf16 v[72:75], v[172:175], v[204:207], v[72:75]
    v_cvt_pk_bf16_f32 v7, v26, v27
    v_cvt_pk_bf16_f32 v44, v44, v45
    v_cvt_pk_bf16_f32 v45, v46, v47
    v_mfma_f32_16x16x32_bf16 v[8:11], v[176:179], v[88:91], v[8:11]
    v_cvt_pk_bf16_f32 v46, v64, v65
    v_cvt_pk_bf16_f32 v47, v66, v67
    v_permlane16_swap_b32 v4, v6
    v_mfma_f32_16x16x32_bf16 v[28:31], v[180:183], v[88:91], v[28:31]
    v_permlane16_swap_b32 v5, v7
    v_permlane16_swap_b32 v44, v46
    v_permlane16_swap_b32 v45, v47
    v_mfma_f32_16x16x32_bf16 v[48:51], v[184:187], v[88:91], v[48:51]
    ds_write_b128 v231, v[4:7] offset:1024
    ds_write_b128 v231, v[44:47] offset:6144
    v_mfma_f32_16x16x32_bf16 v[68:71], v[188:191], v[88:91], v[68:71]
    v_mfma_f32_16x16x32_bf16 v[16:19], v[160:163], v[208:211], v[16:19]
    v_mfma_f32_16x16x32_bf16 v[36:39], v[164:167], v[208:211], v[36:39]
    v_mfma_f32_16x16x32_bf16 v[56:59], v[168:171], v[208:211], v[56:59]
    v_cvt_pk_bf16_f32 v8, v8, v9
    v_cvt_pk_bf16_f32 v9, v10, v11
    v_cvt_pk_bf16_f32 v10, v28, v29
    v_mfma_f32_16x16x32_bf16 v[76:79], v[172:175], v[208:211], v[76:79]
    v_cvt_pk_bf16_f32 v11, v30, v31
    v_cvt_pk_bf16_f32 v48, v48, v49
    v_cvt_pk_bf16_f32 v49, v50, v51
    v_mfma_f32_16x16x32_bf16 v[12:15], v[176:179], v[92:95], v[12:15]
    v_cvt_pk_bf16_f32 v50, v68, v69
    v_cvt_pk_bf16_f32 v51, v70, v71
    v_permlane16_swap_b32 v8, v10
    v_mfma_f32_16x16x32_bf16 v[32:35], v[180:183], v[92:95], v[32:35]
    v_permlane16_swap_b32 v9, v11
    v_permlane16_swap_b32 v48, v50
    v_permlane16_swap_b32 v49, v51
    v_mfma_f32_16x16x32_bf16 v[52:55], v[184:187], v[92:95], v[52:55]
    ds_write_b128 v231, v[8:11] offset:2048
    ds_write_b128 v231, v[48:51] offset:7168
    v_mfma_f32_16x16x32_bf16 v[72:75], v[188:191], v[92:95], v[72:75]
    v_mfma_f32_16x16x32_bf16 v[16:19], v[176:179], v[96:99], v[16:19]
    v_mfma_f32_16x16x32_bf16 v[36:39], v[180:183], v[96:99], v[36:39]
    v_mfma_f32_16x16x32_bf16 v[56:59], v[184:187], v[96:99], v[56:59]
    v_cvt_pk_bf16_f32 v12, v12, v13
    v_cvt_pk_bf16_f32 v13, v14, v15
    v_cvt_pk_bf16_f32 v14, v32, v33
    v_mfma_f32_16x16x32_bf16 v[76:79], v[188:191], v[96:99], v[76:79]
    v_cvt_pk_bf16_f32 v15, v34, v35
    v_cvt_pk_bf16_f32 v52, v52, v53
    v_cvt_pk_bf16_f32 v53, v54, v55
    v_cvt_pk_bf16_f32 v54, v72, v73
    v_cvt_pk_bf16_f32 v55, v74, v75
    v_permlane16_swap_b32 v12, v14
    v_permlane16_swap_b32 v13, v15
    v_permlane16_swap_b32 v52, v54
    v_permlane16_swap_b32 v53, v55
    ds_write_b128 v231, v[12:15] offset:3072
    ds_write_b128 v231, v[52:55] offset:8192
    v_cvt_pk_bf16_f32 v16, v16, v17
    v_cvt_pk_bf16_f32 v17, v18, v19
    v_cvt_pk_bf16_f32 v18, v36, v37
    v_cvt_pk_bf16_f32 v19, v38, v39
    v_cvt_pk_bf16_f32 v56, v56, v57
    v_cvt_pk_bf16_f32 v57, v58, v59
    v_cvt_pk_bf16_f32 v58, v76, v77
    v_cvt_pk_bf16_f32 v59, v78, v79
    v_permlane16_swap_b32 v16, v18
    v_permlane16_swap_b32 v17, v19
    v_permlane16_swap_b32 v56, v58
    v_permlane16_swap_b32 v57, v59
    ds_write_b128 v231, v[16:19] offset:4096
    ds_write_b128 v231, v[56:59] offset:9216
    s_setprio 0
    s_waitcnt vmcnt(8)
    ds_read_b128 v[200:203], v216 offset:6144
    ds_read_b128 v[204:207], v217 offset:6144
    s_waitcnt lgkmcnt(0)
    s_barrier
    ds_read_b128 v[160:163], v225
    ds_read_b128 v[164:167], v225 offset:1024
    ds_read_b128 v[168:171], v225 offset:2048
    ds_read_b128 v[172:175], v225 offset:3072
    ds_read_b128 v[176:179], v225 offset:4096
    ds_read_b128 v[180:183], v225 offset:5120
    ds_read_b128 v[184:187], v225 offset:6144
    ds_read_b128 v[188:191], v225 offset:7168
    ds_read_b128 v[192:195], v225 offset:8192
    ds_read_b128 v[196:199], v225 offset:9216
    s_add_u32 s77, s95, 8192
    s_add_u32 m0, s76, 6144
    s_nop 0
    buffer_load_dwordx4 v218, s[60:63], s77 offen nt lds
    buffer_load_dwordx4 v219, s[60:63], s77 offen offset:1024 nt lds
    s_cmp_lg_u32 s92, 0
    s_cbranch_scc1 L_snorm
    s_waitcnt vmcnt(8)
    s_waitcnt lgkmcnt(9)
    v_mfma_f32_16x16x32_bf16 v[0:3], v[200:203], v[160:163], 0
    ds_read_b128 v[208:211], v216 offset:8192
    s_waitcnt lgkmcnt(9)
    v_mfma_f32_16x16x32_bf16 v[4:7], v[200:203], v[164:167], 0
    ds_read_b128 v[212:215], v217 offset:8192
    s_waitcnt lgkmcnt(9)
    v_mfma_f32_16x16x32_bf16 v[8:11], v[200:203], v[168:171], 0
    s_waitcnt lgkmcnt(8)
    v_mfma_f32_16x16x32_bf16 v[12:15], v[200:203], v[172:175], 0
    s_waitcnt lgkmcnt(7)
    v_mfma_f32_16x16x32_bf16 v[16:19], v[200:203], v[176:179], 0
    s_waitcnt lgkmcnt(6)
    v_mfma_f32_16x16x32_bf16 v[0:3], v[204:207], v[180:183], v[0:3]
    s_waitcnt lgkmcnt(0)
    ds_write_b128 v253, v[100:103] offset:8192
    ds_write_b128 v253, v[104:107] offset:9216
    v_mfma_f32_16x16x32_bf16 v[4:7], v[204:207], v[184:187], v[4:7]
    v_mfma_f32_16x16x32_bf16 v[8:11], v[204:207], v[188:191], v[8:11]
    v_mfma_f32_16x16x32_bf16 v[12:15], v[204:207], v[192:195], v[12:15]
    v_mfma_f32_16x16x32_bf16 v[16:19], v[204:207], v[196:199], v[16:19]
    s_waitcnt vmcnt(6)
    v_mfma_f32_16x16x32_bf16 v[20:23], v[208:211], v[160:163], 0
    ds_read_b128 v[200:203], v216
    v_mfma_f32_16x16x32_bf16 v[24:27], v[208:211], v[164:167], 0
    ds_read_b128 v[204:207], v217
    v_mfma_f32_16x16x32_bf16 v[28:31], v[208:211], v[168:171], 0
    v_mfma_f32_16x16x32_bf16 v[32:35], v[208:211], v[172:175], 0
    v_mfma_f32_16x16x32_bf16 v[36:39], v[208:211], v[176:179], 0
    v_mfma_f32_16x16x32_bf16 v[20:23], v[212:215], v[180:183], v[20:23]
    s_waitcnt lgkmcnt(0)
    ds_write_b128 v253, v[108:111]
    ds_write_b128 v253, v[112:115] offset:1024
    v_mfma_f32_16x16x32_bf16 v[24:27], v[212:215], v[184:187], v[24:27]
    v_mfma_f32_16x16x32_bf16 v[28:31], v[212:215], v[188:191], v[28:31]
    v_mfma_f32_16x16x32_bf16 v[32:35], v[212:215], v[192:195], v[32:35]
    v_mfma_f32_16x16x32_bf16 v[36:39], v[212:215], v[196:199], v[36:39]
    s_waitcnt vmcnt(4)
    v_mfma_f32_16x16x32_bf16 v[40:43], v[200:203], v[160:163], 0
    ds_read_b128 v[208:211], v216 offset:2048
    v_mfma_f32_16x16x32_bf16 v[44:47], v[200:203], v[164:167], 0
    ds_read_b128 v[212:215], v217 offset:2048
    v_mfma_f32_16x16x32_bf16 v[48:51], v[200:203], v[168:171], 0
    v_mfma_f32_16x16x32_bf16 v[52:55], v[200:203], v[172:175], 0
    v_mfma_f32_16x16x32_bf16 v[56:59], v[200:203], v[176:179], 0
    v_mfma_f32_16x16x32_bf16 v[40:43], v[204:207], v[180:183], v[40:43]
    s_waitcnt lgkmcnt(0)
    ds_write_b128 v253, v[116:119] offset:2048
    ds_write_b128 v253, v[120:123] offset:3072
    v_mfma_f32_16x16x32_bf16 v[44:47], v[204:207], v[184:187], v[44:47]
    v_mfma_f32_16x16x32_bf16 v[48:51], v[204:207], v[188:191], v[48:51]
    v_mfma_f32_16x16x32_bf16 v[52:55], v[204:207], v[192:195], v[52:55]
    v_mfma_f32_16x16x32_bf16 v[56:59], v[204:207], v[196:199], v[56:59]
    s_mul_i32 s88, s95, 80
    v_add_u32 v225, s88, v224
    s_waitcnt vmcnt(2)
    v_mfma_f32_16x16x32_bf16 v[60:63], v[208:211], v[160:163], 0
    ds_read_b128 v[200:203], v216 offset:4096
    ds_read_b128 v[160:163], v225
    v_mfma_f32_16x16x32_bf16 v[64:67], v[208:211], v[164:167], 0
    ds_read_b128 v[204:207], v217 offset:4096
    ds_read_b128 v[164:167], v225 offset:1024
    v_mfma_f32_16x16x32_bf16 v[68:71], v[208:211], v[168:171], 0
    ds_read_b128 v[168:171], v225 offset:2048
    v_mfma_f32_16x16x32_bf16 v[72:75], v[208:211], v[172:175], 0
    ds_read_b128 v[172:175], v225 offset:3072
    v_mfma_f32_16x16x32_bf16 v[76:79], v[208:211], v[176:179], 0
    ds_read_b128 v[176:179], v225 offset:4096
    v_mfma_f32_16x16x32_bf16 v[60:63], v[212:215], v[180:183], v[60:63]
    ds_read_b128 v[180:183], v225 offset:5120
    s_waitcnt lgkmcnt(5)
    ds_write_b128 v253, v[124:127] offset:4096
    ds_write_b128 v253, v[128:131] offset:5120
    v_mfma_f32_16x16x32_bf16 v[64:67], v[212:215], v[184:187], v[64:67]
    ds_read_b128 v[184:187], v225 offset:6144
    v_mfma_f32_16x16x32_bf16 v[68:71], v[212:215], v[188:191], v[68:71]
    ds_read_b128 v[188:191], v225 offset:7168
    v_mfma_f32_16x16x32_bf16 v[72:75], v[212:215], v[192:195], v[72:75]
    ds_read_b128 v[192:195], v225 offset:8192
    v_mfma_f32_16x16x32_bf16 v[76:79], v[212:215], v[196:199], v[76:79]
    ds_read_b128 v[196:199], v225 offset:9216
    s_waitcnt vmcnt(0)
    v_mfma_f32_16x16x32_bf16 v[0:3], v[200:203], v[160:163], v[0:3]
    ds_read_b128 v[208:211], v216 offset:6144
    s_waitcnt lgkmcnt(11)
    v_mfma_f32_16x16x32_bf16 v[4:7], v[200:203], v[164:167], v[4:7]
    ds_read_b128 v[212:215], v217 offset:6144
    s_waitcnt lgkmcnt(11)
    v_mfma_f32_16x16x32_bf16 v[8:11], v[200:203], v[168:171], v[8:11]
    s_waitcnt lgkmcnt(10)
    v_mfma_f32_16x16x32_bf16 v[12:15], v[200:203], v[172:175], v[12:15]
    s_waitcnt lgkmcnt(9)
    v_mfma_f32_16x16x32_bf16 v[16:19], v[200:203], v[176:179], v[16:19]
    s_waitcnt lgkmcnt(8)
    v_mfma_f32_16x16x32_bf16 v[0:3], v[204:207], v[180:183], v[0:3]
    s_waitcnt lgkmcnt(0)
    ds_write_b128 v253, v[132:135] offset:6144
    ds_write_b128 v253, v[136:139] offset:7168
    v_mfma_f32_16x16x32_bf16 v[4:7], v[204:207], v[184:187], v[4:7]
    v_mfma_f32_16x16x32_bf16 v[8:11], v[204:207], v[188:191], v[8:11]
    v_mfma_f32_16x16x32_bf16 v[12:15], v[204:207], v[192:195], v[12:15]
    v_mfma_f32_16x16x32_bf16 v[16:19], v[204:207], v[196:199], v[16:19]
    v_mfma_f32_16x16x32_bf16 v[20:23], v[208:211], v[160:163], v[20:23]
    ds_read_b128 v[200:203], v216 offset:8192
    v_mfma_f32_16x16x32_bf16 v[24:27], v[208:211], v[164:167], v[24:27]
    ds_read_b128 v[204:207], v217 offset:8192
    v_mfma_f32_16x16x32_bf16 v[28:31], v[208:211], v[168:171], v[28:31]
    v_mfma_f32_16x16x32_bf16 v[32:35], v[208:211], v[172:175], v[32:35]
    v_mfma_f32_16x16x32_bf16 v[36:39], v[208:211], v[176:179], v[36:39]
    v_mfma_f32_16x16x32_bf16 v[20:23], v[212:215], v[180:183], v[20:23]
    s_waitcnt lgkmcnt(0)
    ds_write_b128 v253, v[140:143] offset:8192
    ds_write_b128 v253, v[144:147] offset:9216
    v_mfma_f32_16x16x32_bf16 v[24:27], v[212:215], v[184:187], v[24:27]
    v_mfma_f32_16x16x32_bf16 v[28:31], v[212:215], v[188:191], v[28:31]
    v_mfma_f32_16x16x32_bf16 v[32:35], v[212:215], v[192:195], v[32:35]
    v_mfma_f32_16x16x32_bf16 v[36:39], v[212:215], v[196:199], v[36:39]
    v_mfma_f32_16x16x32_bf16 v[40:43], v[200:203], v[160:163], v[40:43]
    ds_read_b128 v[208:211], v216
    v_mfma_f32_16x16x32_bf16 v[44:47], v[200:203], v[164:167], v[44:47]
    ds_read_b128 v[212:215], v217
    v_mfma_f32_16x16x32_bf16 v[48:51], v[200:203], v[168:171], v[48:51]
    v_mfma_f32_16x16x32_bf16 v[52:55], v[200:203], v[172:175], v[52:55]
    v_mfma_f32_16x16x32_bf16 v[56:59], v[200:203], v[176:179], v[56:59]
    v_mfma_f32_16x16x32_bf16 v[40:43], v[204:207], v[180:183], v[40:43]
    s_waitcnt lgkmcnt(0)
    ds_write_b128 v253, v[148:151]
    ds_write_b128 v253, v[152:155] offset:1024
    v_mfma_f32_16x16x32_bf16 v[44:47], v[204:207], v[184:187], v[44:47]
    v_mfma_f32_16x16x32_bf16 v[48:51], v[204:207], v[188:191], v[48:51]
    v_mfma_f32_16x16x32_bf16 v[52:55], v[204:207], v[192:195], v[52:55]
    v_mfma_f32_16x16x32_bf16 v[56:59], v[204:207], v[196:199], v[56:59]
    s_mul_i32 s88, s96, 80
    v_add_u32 v225, s88, v224
    v_mfma_f32_16x16x32_bf16 v[60:63], v[208:211], v[160:163], v[60:63]
    ds_read_b128 v[200:203], v216 offset:2048
    ds_read_b128 v[160:163], v225
    v_mfma_f32_16x16x32_bf16 v[64:67], v[208:211], v[164:167], v[64:67]
    ds_read_b128 v[204:207], v217 offset:2048
    ds_read_b128 v[164:167], v225 offset:1024
    v_mfma_f32_16x16x32_bf16 v[68:71], v[208:211], v[168:171], v[68:71]
    ds_read_b128 v[168:171], v225 offset:2048
    v_mfma_f32_16x16x32_bf16 v[72:75], v[208:211], v[172:175], v[72:75]
    ds_read_b128 v[172:175], v225 offset:3072
    v_mfma_f32_16x16x32_bf16 v[76:79], v[208:211], v[176:179], v[76:79]
    ds_read_b128 v[176:179], v225 offset:4096
    v_mfma_f32_16x16x32_bf16 v[60:63], v[212:215], v[180:183], v[60:63]
    ds_read_b128 v[180:183], v225 offset:5120
    s_waitcnt lgkmcnt(5)
    s_add_u32 s77, s97, 8192
    s_add_u32 m0, s76, 2048
    s_nop 0
    buffer_load_dwordx4 v218, s[60:63], s77 offen nt lds
    buffer_load_dwordx4 v219, s[60:63], s77 offen offset:1024 nt lds
    v_mfma_f32_16x16x32_bf16 v[64:67], v[212:215], v[184:187], v[64:67]
    ds_read_b128 v[184:187], v225 offset:6144
    v_mfma_f32_16x16x32_bf16 v[68:71], v[212:215], v[188:191], v[68:71]
    ds_read_b128 v[188:191], v225 offset:7168
    v_mfma_f32_16x16x32_bf16 v[72:75], v[212:215], v[192:195], v[72:75]
    ds_read_b128 v[192:195], v225 offset:8192
    v_mfma_f32_16x16x32_bf16 v[76:79], v[212:215], v[196:199], v[76:79]
    ds_read_b128 v[196:199], v225 offset:9216
    v_mfma_f32_16x16x32_bf16 v[0:3], v[200:203], v[160:163], v[0:3]
    ds_read_b128 v[208:211], v216 offset:4096
    s_waitcnt lgkmcnt(9)
    v_mfma_f32_16x16x32_bf16 v[4:7], v[200:203], v[164:167], v[4:7]
    ds_read_b128 v[212:215], v217 offset:4096
    s_waitcnt lgkmcnt(9)
    v_mfma_f32_16x16x32_bf16 v[8:11], v[200:203], v[168:171], v[8:11]
    s_waitcnt lgkmcnt(8)
    v_mfma_f32_16x16x32_bf16 v[12:15], v[200:203], v[172:175], v[12:15]
    s_waitcnt lgkmcnt(7)
    v_mfma_f32_16x16x32_bf16 v[16:19], v[200:203], v[176:179], v[16:19]
    s_waitcnt lgkmcnt(6)
    v_mfma_f32_16x16x32_bf16 v[0:3], v[204:207], v[180:183], v[0:3]
    s_waitcnt lgkmcnt(0)
    s_add_u32 s77, s97, 16384
    s_add_u32 m0, s76, 4096
    s_nop 0
    buffer_load_dwordx4 v218, s[60:63], s77 offen nt lds
    buffer_load_dwordx4 v219, s[60:63], s77 offen offset:1024 nt lds
    v_mfma_f32_16x16x32_bf16 v[4:7], v[204:207], v[184:187], v[4:7]
    v_mfma_f32_16x16x32_bf16 v[8:11], v[204:207], v[188:191], v[8:11]
    v_mfma_f32_16x16x32_bf16 v[12:15], v[204:207], v[192:195], v[12:15]
    v_mfma_f32_16x16x32_bf16 v[16:19], v[204:207], v[196:199], v[16:19]
    v_mfma_f32_16x16x32_bf16 v[20:23], v[208:211], v[160:163], v[20:23]
    ds_read_b128 v[200:203], v216 offset:6144
    v_mfma_f32_16x16x32_bf16 v[24:27], v[208:211], v[164:167], v[24:27]
    ds_read_b128 v[204:207], v217 offset:6144
    v_mfma_f32_16x16x32_bf16 v[28:31], v[208:211], v[168:171], v[28:31]
    v_mfma_f32_16x16x32_bf16 v[32:35], v[208:211], v[172:175], v[32:35]
    v_mfma_f32_16x16x32_bf16 v[36:39], v[208:211], v[176:179], v[36:39]
    v_mfma_f32_16x16x32_bf16 v[20:23], v[212:215], v[180:183], v[20:23]
    s_waitcnt lgkmcnt(0)
    s_add_u32 s77, s97, 24576
    s_add_u32 m0, s76, 6144
    s_nop 0
    buffer_load_dwordx4 v218, s[60:63], s77 offen nt lds
    buffer_load_dwordx4 v219, s[60:63], s77 offen offset:1024 nt lds
    v_mfma_f32_16x16x32_bf16 v[24:27], v[212:215], v[184:187], v[24:27]
    v_mfma_f32_16x16x32_bf16 v[28:31], v[212:215], v[188:191], v[28:31]
    v_mfma_f32_16x16x32_bf16 v[32:35], v[212:215], v[192:195], v[32:35]
    v_mfma_f32_16x16x32_bf16 v[36:39], v[212:215], v[196:199], v[36:39]
    v_mfma_f32_16x16x32_bf16 v[40:43], v[200:203], v[160:163], v[40:43]
    ds_read_b128 v[208:211], v216 offset:8192
    v_mfma_f32_16x16x32_bf16 v[44:47], v[200:203], v[164:167], v[44:47]
    ds_read_b128 v[212:215], v217 offset:8192
    v_mfma_f32_16x16x32_bf16 v[48:51], v[200:203], v[168:171], v[48:51]
    v_mfma_f32_16x16x32_bf16 v[52:55], v[200:203], v[172:175], v[52:55]
    v_mfma_f32_16x16x32_bf16 v[56:59], v[200:203], v[176:179], v[56:59]
    v_mfma_f32_16x16x32_bf16 v[40:43], v[204:207], v[180:183], v[40:43]
    s_waitcnt lgkmcnt(0)
    s_add_u32 s77, s94, 32768
    s_add_u32 m0, s76, 8192
    s_nop 0
    buffer_load_dwordx4 v218, s[60:63], s77 offen nt lds
    buffer_load_dwordx4 v219, s[60:63], s77 offen offset:1024 nt lds
    v_mfma_f32_16x16x32_bf16 v[44:47], v[204:207], v[184:187], v[44:47]
    v_mfma_f32_16x16x32_bf16 v[48:51], v[204:207], v[188:191], v[48:51]
    v_mfma_f32_16x16x32_bf16 v[52:55], v[204:207], v[192:195], v[52:55]
    v_mfma_f32_16x16x32_bf16 v[56:59], v[204:207], v[196:199], v[56:59]
    s_mul_i32 s88, s97, 80
    v_add_u32 v225, s88, v224
    v_mfma_f32_16x16x32_bf16 v[60:63], v[208:211], v[160:163], v[60:63]
    ds_read_b128 v[200:203], v216
    ds_read_b128 v[160:163], v225
    v_mfma_f32_16x16x32_bf16 v[64:67], v[208:211], v[164:167], v[64:67]
    ds_read_b128 v[204:207], v217
    ds_read_b128 v[164:167], v225 offset:1024
    v_mfma_f32_16x16x32_bf16 v[68:71], v[208:211], v[168:171], v[68:71]
    ds_read_b128 v[168:171], v225 offset:2048
    v_mfma_f32_16x16x32_bf16 v[72:75], v[208:211], v[172:175], v[72:75]
    ds_read_b128 v[172:175], v225 offset:3072
    v_mfma_f32_16x16x32_bf16 v[76:79], v[208:211], v[176:179], v[76:79]
    ds_read_b128 v[176:179], v225 offset:4096
    v_mfma_f32_16x16x32_bf16 v[60:63], v[212:215], v[180:183], v[60:63]
    ds_read_b128 v[180:183], v225 offset:5120
    s_waitcnt lgkmcnt(5)
    s_add_u32 s77, s94, 40960
    s_add_u32 m0, s76, 0
    s_nop 0
    buffer_load_dwordx4 v218, s[60:63], s77 offen nt lds
    buffer_load_dwordx4 v219, s[60:63], s77 offen offset:1024 nt lds
    v_mfma_f32_16x16x32_bf16 v[64:67], v[212:215], v[184:187], v[64:67]
    ds_read_b128 v[184:187], v225 offset:6144
    v_mfma_f32_16x16x32_bf16 v[68:71], v[212:215], v[188:191], v[68:71]
    ds_read_b128 v[188:191], v225 offset:7168
    v_mfma_f32_16x16x32_bf16 v[72:75], v[212:215], v[192:195], v[72:75]
    ds_read_b128 v[192:195], v225 offset:8192
    v_mfma_f32_16x16x32_bf16 v[76:79], v[212:215], v[196:199], v[76:79]
    ds_read_b128 v[196:199], v225 offset:9216
    s_branch L_sjoin
L_snorm:
    s_waitcnt vmcnt(8)
    s_waitcnt lgkmcnt(9)
    v_mfma_f32_16x16x32_bf16 v[0:3], v[200:203], v[160:163], 0
    ds_read_b128 v[208:211], v216 offset:8192
    s_waitcnt lgkmcnt(9)
    v_mfma_f32_16x16x32_bf16 v[4:7], v[200:203], v[164:167], 0
    ds_read_b128 v[212:215], v217 offset:8192
    s_waitcnt lgkmcnt(9)
    v_mfma_f32_16x16x32_bf16 v[8:11], v[200:203], v[168:171], 0
    s_waitcnt lgkmcnt(8)
    v_mfma_f32_16x16x32_bf16 v[12:15], v[200:203], v[172:175], 0
    s_waitcnt lgkmcnt(7)
    v_mfma_f32_16x16x32_bf16 v[16:19], v[200:203], v[176:179], 0
    s_waitcnt lgkmcnt(6)
    v_mfma_f32_16x16x32_bf16 v[0:3], v[204:207], v[180:183], v[0:3]
    s_waitcnt lgkmcnt(0)
    s_add_u32 s77, s95, 16384
    s_add_u32 m0, s76, 8192
    s_nop 0
    buffer_load_dwordx4 v218, s[60:63], s77 offen nt lds
    buffer_load_dwordx4 v219, s[60:63], s77 offen offset:1024 nt lds
    v_mfma_f32_16x16x32_bf16 v[4:7], v[204:207], v[184:187], v[4:7]
    v_mfma_f32_16x16x32_bf16 v[8:11], v[204:207], v[188:191], v[8:11]
    v_mfma_f32_16x16x32_bf16 v[12:15], v[204:207], v[192:195], v[12:15]
    v_mfma_f32_16x16x32_bf16 v[16:19], v[204:207], v[196:199], v[16:19]
    s_waitcnt vmcnt(8)
    v_mfma_f32_16x16x32_bf16 v[20:23], v[208:211], v[160:163], 0
    ds_read_b128 v[200:203], v216
    v_mfma_f32_16x16x32_bf16 v[24:27], v[208:211], v[164:167], 0
    ds_read_b128 v[204:207], v217
    v_mfma_f32_16x16x32_bf16 v[28:31], v[208:211], v[168:171], 0
    v_mfma_f32_16x16x32_bf16 v[32:35], v[208:211], v[172:175], 0
    v_mfma_f32_16x16x32_bf16 v[36:39], v[208:211], v[176:179], 0
    v_mfma_f32_16x16x32_bf16 v[20:23], v[212:215], v[180:183], v[20:23]
    s_waitcnt lgkmcnt(0)
    s_add_u32 s77, s95, 24576
    s_add_u32 m0, s76, 0
    s_nop 0
    buffer_load_dwordx4 v218, s[60:63], s77 offen nt lds
    buffer_load_dwordx4 v219, s[60:63], s77 offen offset:1024 nt lds
    v_mfma_f32_16x16x32_bf16 v[24:27], v[212:215], v[184:187], v[24:27]
    v_mfma_f32_16x16x32_bf16 v[28:31], v[212:215], v[188:191], v[28:31]
    v_mfma_f32_16x16x32_bf16 v[32:35], v[212:215], v[192:195], v[32:35]
    v_mfma_f32_16x16x32_bf16 v[36:39], v[212:215], v[196:199], v[36:39]
    s_waitcnt vmcnt(8)
    v_mfma_f32_16x16x32_bf16 v[40:43], v[200:203], v[160:163], 0
    ds_read_b128 v[208:211], v216 offset:2048
    v_mfma_f32_16x16x32_bf16 v[44:47], v[200:203], v[164:167], 0
    ds_read_b128 v[212:215], v217 offset:2048
    v_mfma_f32_16x16x32_bf16 v[48:51], v[200:203], v[168:171], 0
    v_mfma_f32_16x16x32_bf16 v[52:55], v[200:203], v[172:175], 0
    v_mfma_f32_16x16x32_bf16 v[56:59], v[200:203], v[176:179], 0
    v_mfma_f32_16x16x32_bf16 v[40:43], v[204:207], v[180:183], v[40:43]
    s_waitcnt lgkmcnt(0)
    s_add_u32 s77, s96, 0
    s_add_u32 m0, s76, 2048
    s_nop 0
    buffer_load_dwordx4 v218, s[60:63], s77 offen nt lds
    buffer_load_dwordx4 v219, s[60:63], s77 offen offset:1024 nt lds
    v_mfma_f32_16x16x32_bf16 v[44:47], v[204:207], v[184:187], v[44:47]
    v_mfma_f32_16x16x32_bf16 v[48:51], v[204:207], v[188:191], v[48:51]
    v_mfma_f32_16x16x32_bf16 v[52:55], v[204:207], v[192:195], v[52:55]
    v_mfma_f32_16x16x32_bf16 v[56:59], v[204:207], v[196:199], v[56:59]
    s_mul_i32 s88, s95, 80
    v_add_u32 v225, s88, v224
    s_waitcnt vmcnt(8)
    v_mfma_f32_16x16x32_bf16 v[60:63], v[208:211], v[160:163], 0
    ds_read_b128 v[200:203], v216 offset:4096
    ds_read_b128 v[160:163], v225
    v_mfma_f32_16x16x32_bf16 v[64:67], v[208:211], v[164:167], 0
    ds_read_b128 v[204:207], v217 offset:4096
    ds_read_b128 v[164:167], v225 offset:1024
    v_mfma_f32_16x16x32_bf16 v[68:71], v[208:211], v[168:171], 0
    ds_read_b128 v[168:171], v225 offset:2048
    v_mfma_f32_16x16x32_bf16 v[72:75], v[208:211], v[172:175], 0
    ds_read_b128 v[172:175], v225 offset:3072
    v_mfma_f32_16x16x32_bf16 v[76:79], v[208:211], v[176:179], 0
    ds_read_b128 v[176:179], v225 offset:4096
    v_mfma_f32_16x16x32_bf16 v[60:63], v[212:215], v[180:183], v[60:63]
    ds_read_b128 v[180:183], v225 offset:5120
    s_waitcnt lgkmcnt(5)
    s_add_u32 s77, s96, 8192
    s_add_u32 m0, s76, 4096
    s_nop 0
    buffer_load_dwordx4 v218, s[60:63], s77 offen nt lds
    buffer_load_dwordx4 v219, s[60:63], s77 offen offset:1024 nt lds
    v_mfma_f32_16x16x32_bf16 v[64:67], v[212:215], v[184:187], v[64:67]
    ds_read_b128 v[184:187], v225 offset:6144
    v_mfma_f32_16x16x32_bf16 v[68:71], v[212:215], v[188:191], v[68:71]
    ds_read_b128 v[188:191], v225 offset:7168
    v_mfma_f32_16x16x32_bf16 v[72:75], v[212:215], v[192:195], v[72:75]
    ds_read_b128 v[192:195], v225 offset:8192
    v_mfma_f32_16x16x32_bf16 v[76:79], v[212:215], v[196:199], v[76:79]
    ds_read_b128 v[196:199], v225 offset:9216
    s_waitcnt vmcnt(8)
    v_mfma_f32_16x16x32_bf16 v[0:3], v[200:203], v[160:163], v[0:3]
    ds_read_b128 v[208:211], v216 offset:6144
    s_waitcnt lgkmcnt(9)
    v_mfma_f32_16x16x32_bf16 v[4:7], v[200:203], v[164:167], v[4:7]
    ds_read_b128 v[212:215], v217 offset:6144
    s_waitcnt lgkmcnt(9)
    v_mfma_f32_16x16x32_bf16 v[8:11], v[200:203], v[168:171], v[8:11]
    s_waitcnt lgkmcnt(8)
    v_mfma_f32_16x16x32_bf16 v[12:15], v[200:203], v[172:175], v[12:15]
    s_waitcnt lgkmcnt(7)
    v_mfma_f32_16x16x32_bf16 v[16:19], v[200:203], v[176:179], v[16:19]
    s_waitcnt lgkmcnt(6)
    v_mfma_f32_16x16x32_bf16 v[0:3], v[204:207], v[180:183], v[0:3]
    s_waitcnt lgkmcnt(0)
    s_add_u32 s77, s96, 16384
    s_add_u32 m0, s76, 6144
    s_nop 0
    buffer_load_dwordx4 v218, s[60:63], s77 offen nt lds
    buffer_load_dwordx4 v219, s[60:63], s77 offen offset:1024 nt lds
    v_mfma_f32_16x16x32_bf16 v[4:7], v[204:207], v[184:187], v[4:7]
    v_mfma_f32_16x16x32_bf16 v[8:11], v[204:207], v[188:191], v[8:11]
    v_mfma_f32_16x16x32_bf16 v[12:15], v[204:207], v[192:195], v[12:15]
    v_mfma_f32_16x16x32_bf16 v[16:19], v[204:207], v[196:199], v[16:19]
    s_waitcnt vmcnt(8)
    v_mfma_f32_16x16x32_bf16 v[20:23], v[208:211], v[160:163], v[20:23]
    ds_read_b128 v[200:203], v216 offset:8192
    v_mfma_f32_16x16x32_bf16 v[24:27], v[208:211], v[164:167], v[24:27]
    ds_read_b128 v[204:207], v217 offset:8192
    v_mfma_f32_16x16x32_bf16 v[28:31], v[208:211], v[168:171], v[28:31]
    v_mfma_f32_16x16x32_bf16 v[32:35], v[208:211], v[172:175], v[32:35]
    v_mfma_f32_16x16x32_bf16 v[36:39], v[208:211], v[176:179], v[36:39]
    v_mfma_f32_16x16x32_bf16 v[20:23], v[212:215], v[180:183], v[20:23]
    s_waitcnt lgkmcnt(0)
    s_add_u32 s77, s96, 24576
    s_add_u32 m0, s76, 8192
    s_nop 0
    buffer_load_dwordx4 v218, s[60:63], s77 offen nt lds
    buffer_load_dwordx4 v219, s[60:63], s77 offen offset:1024 nt lds
    v_mfma_f32_16x16x32_bf16 v[24:27], v[212:215], v[184:187], v[24:27]
    v_mfma_f32_16x16x32_bf16 v[28:31], v[212:215], v[188:191], v[28:31]
    v_mfma_f32_16x16x32_bf16 v[32:35], v[212:215], v[192:195], v[32:35]
    v_mfma_f32_16x16x32_bf16 v[36:39], v[212:215], v[196:199], v[36:39]
    s_waitcnt vmcnt(8)
    v_mfma_f32_16x16x32_bf16 v[40:43], v[200:203], v[160:163], v[40:43]
    ds_read_b128 v[208:211], v216
    v_mfma_f32_16x16x32_bf16 v[44:47], v[200:203], v[164:167], v[44:47]
    ds_read_b128 v[212:215], v217
    v_mfma_f32_16x16x32_bf16 v[48:51], v[200:203], v[168:171], v[48:51]
    v_mfma_f32_16x16x32_bf16 v[52:55], v[200:203], v[172:175], v[52:55]
    v_mfma_f32_16x16x32_bf16 v[56:59], v[200:203], v[176:179], v[56:59]
    v_mfma_f32_16x16x32_bf16 v[40:43], v[204:207], v[180:183], v[40:43]
    s_waitcnt lgkmcnt(0)
    s_add_u32 s77, s97, 0
    s_add_u32 m0, s76, 0
    s_nop 0
    buffer_load_dwordx4 v218, s[60:63], s77 offen nt lds
    buffer_load_dwordx4 v219, s[60:63], s77 offen offset:1024 nt lds
    v_mfma_f32_16x16x32_bf16 v[44:47], v[204:207], v[184:187], v[44:47]
    v_mfma_f32_16x16x32_bf16 v[48:51], v[204:207], v[188:191], v[48:51]
    v_mfma_f32_16x16x32_bf16 v[52:55], v[204:207], v[192:195], v[52:55]
    v_mfma_f32_16x16x32_bf16 v[56:59], v[204:207], v[196:199], v[56:59]
    s_mul_i32 s88, s96, 80
    v_add_u32 v225, s88, v224
    s_waitcnt vmcnt(8)
    v_mfma_f32_16x16x32_bf16 v[60:63], v[208:211], v[160:163], v[60:63]
    ds_read_b128 v[200:203], v216 offset:2048
    ds_read_b128 v[160:163], v225
    v_mfma_f32_16x16x32_bf16 v[64:67], v[208:211], v[164:167], v[64:67]
    ds_read_b128 v[204:207], v217 offset:2048
    ds_read_b128 v[164:167], v225 offset:1024
    v_mfma_f32_16x16x32_bf16 v[68:71], v[208:211], v[168:171], v[68:71]
    ds_read_b128 v[168:171], v225 offset:2048
    v_mfma_f32_16x16x32_bf16 v[72:75], v[208:211], v[172:175], v[72:75]
    ds_read_b128 v[172:175], v225 offset:3072
    v_mfma_f32_16x16x32_bf16 v[76:79], v[208:211], v[176:179], v[76:79]
    ds_read_b128 v[176:179], v225 offset:4096
    v_mfma_f32_16x16x32_bf16 v[60:63], v[212:215], v[180:183], v[60:63]
    ds_read_b128 v[180:183], v225 offset:5120
    s_waitcnt lgkmcnt(5)
    s_add_u32 s77, s97, 8192
    s_add_u32 m0, s76, 2048
    s_nop 0
    buffer_load_dwordx4 v218, s[60:63], s77 offen nt lds
    buffer_load_dwordx4 v219, s[60:63], s77 offen offset:1024 nt lds
    v_mfma_f32_16x16x32_bf16 v[64:67], v[212:215], v[184:187], v[64:67]
    ds_read_b128 v[184:187], v225 offset:6144
    v_mfma_f32_16x16x32_bf16 v[68:71], v[212:215], v[188:191], v[68:71]
    ds_read_b128 v[188:191], v225 offset:7168
    v_mfma_f32_16x16x32_bf16 v[72:75], v[212:215], v[192:195], v[72:75]
    ds_read_b128 v[192:195], v225 offset:8192
    v_mfma_f32_16x16x32_bf16 v[76:79], v[212:215], v[196:199], v[76:79]
    ds_read_b128 v[196:199], v225 offset:9216
    s_waitcnt vmcnt(8)
    v_mfma_f32_16x16x32_bf16 v[0:3], v[200:203], v[160:163], v[0:3]
    ds_read_b128 v[208:211], v216 offset:4096
    s_waitcnt lgkmcnt(9)
    v_mfma_f32_16x16x32_bf16 v[4:7], v[200:203], v[164:167], v[4:7]
    ds_read_b128 v[212:215], v217 offset:4096
    s_waitcnt lgkmcnt(9)
    v_mfma_f32_16x16x32_bf16 v[8:11], v[200:203], v[168:171], v[8:11]
    s_waitcnt lgkmcnt(8)
    v_mfma_f32_16x16x32_bf16 v[12:15], v[200:203], v[172:175], v[12:15]
    s_waitcnt lgkmcnt(7)
    v_mfma_f32_16x16x32_bf16 v[16:19], v[200:203], v[176:179], v[16:19]
    s_waitcnt lgkmcnt(6)
    v_mfma_f32_16x16x32_bf16 v[0:3], v[204:207], v[180:183], v[0:3]
    s_waitcnt lgkmcnt(0)
    s_add_u32 s77, s97, 16384
    s_add_u32 m0, s76, 4096
    s_nop 0
    buffer_load_dwordx4 v218, s[60:63], s77 offen nt lds
    buffer_load_dwordx4 v219, s[60:63], s77 offen offset:1024 nt lds
    v_mfma_f32_16x16x32_bf16 v[4:7], v[204:207], v[184:187], v[4:7]
    v_mfma_f32_16x16x32_bf16 v[8:11], v[204:207], v[188:191], v[8:11]
    v_mfma_f32_16x16x32_bf16 v[12:15], v[204:207], v[192:195], v[12:15]
    v_mfma_f32_16x16x32_bf16 v[16:19], v[204:207], v[196:199], v[16:19]
    s_waitcnt vmcnt(8)
    v_mfma_f32_16x16x32_bf16 v[20:23], v[208:211], v[160:163], v[20:23]
    ds_read_b128 v[200:203], v216 offset:6144
    v_mfma_f32_16x16x32_bf16 v[24:27], v[208:211], v[164:167], v[24:27]
    ds_read_b128 v[204:207], v217 offset:6144
    v_mfma_f32_16x16x32_bf16 v[28:31], v[208:211], v[168:171], v[28:31]
    v_mfma_f32_16x16x32_bf16 v[32:35], v[208:211], v[172:175], v[32:35]
    v_mfma_f32_16x16x32_bf16 v[36:39], v[208:211], v[176:179], v[36:39]
    v_mfma_f32_16x16x32_bf16 v[20:23], v[212:215], v[180:183], v[20:23]
    s_waitcnt lgkmcnt(0)
    s_add_u32 s77, s97, 24576
    s_add_u32 m0, s76, 6144
    s_nop 0
    buffer_load_dwordx4 v218, s[60:63], s77 offen nt lds
    buffer_load_dwordx4 v219, s[60:63], s77 offen offset:1024 nt lds
    v_mfma_f32_16x16x32_bf16 v[24:27], v[212:215], v[184:187], v[24:27]
    v_mfma_f32_16x16x32_bf16 v[28:31], v[212:215], v[188:191], v[28:31]
    v_mfma_f32_16x16x32_bf16 v[32:35], v[212:215], v[192:195], v[32:35]
    v_mfma_f32_16x16x32_bf16 v[36:39], v[212:215], v[196:199], v[36:39]
    s_waitcnt vmcnt(8)
    v_mfma_f32_16x16x32_bf16 v[40:43], v[200:203], v[160:163], v[40:43]
    ds_read_b128 v[208:211], v216 offset:8192
    v_mfma_f32_16x16x32_bf16 v[44:47], v[200:203], v[164:167], v[44:47]
    ds_read_b128 v[212:215], v217 offset:8192
    v_mfma_f32_16x16x32_bf16 v[48:51], v[200:203], v[168:171], v[48:51]
    v_mfma_f32_16x16x32_bf16 v[52:55], v[200:203], v[172:175], v[52:55]
    v_mfma_f32_16x16x32_bf16 v[56:59], v[200:203], v[176:179], v[56:59]
    v_mfma_f32_16x16x32_bf16 v[40:43], v[204:207], v[180:183], v[40:43]
    s_waitcnt lgkmcnt(0)
    s_add_u32 s77, s94, 32768
    s_add_u32 m0, s76, 8192
    s_nop 0
    buffer_load_dwordx4 v218, s[60:63], s77 offen nt lds
    buffer_load_dwordx4 v219, s[60:63], s77 offen offset:1024 nt lds
    v_mfma_f32_16x16x32_bf16 v[44:47], v[204:207], v[184:187], v[44:47]
    v_mfma_f32_16x16x32_bf16 v[48:51], v[204:207], v[188:191], v[48:51]
    v_mfma_f32_16x16x32_bf16 v[52:55], v[204:207], v[192:195], v[52:55]
    v_mfma_f32_16x16x32_bf16 v[56:59], v[204:207], v[196:199], v[56:59]
    s_mul_i32 s88, s97, 80
    v_add_u32 v225, s88, v224
    s_waitcnt vmcnt(8)
    v_mfma_f32_16x16x32_bf16 v[60:63], v[208:211], v[160:163], v[60:63]
    ds_read_b128 v[200:203], v216
    ds_read_b128 v[160:163], v225
    v_mfma_f32_16x16x32_bf16 v[64:67], v[208:211], v[164:167], v[64:67]
    ds_read_b128 v[204:207], v217
    ds_read_b128 v[164:167], v225 offset:1024
    v_mfma_f32_16x16x32_bf16 v[68:71], v[208:211], v[168:171], v[68:71]
    ds_read_b128 v[168:171], v225 offset:2048
    v_mfma_f32_16x16x32_bf16 v[72:75], v[208:211], v[172:175], v[72:75]
    ds_read_b128 v[172:175], v225 offset:3072
    v_mfma_f32_16x16x32_bf16 v[76:79], v[208:211], v[176:179], v[76:79]
    ds_read_b128 v[176:179], v225 offset:4096
    v_mfma_f32_16x16x32_bf16 v[60:63], v[212:215], v[180:183], v[60:63]
    ds_read_b128 v[180:183], v225 offset:5120
    s_waitcnt lgkmcnt(5)
    s_add_u32 s77, s94, 40960
    s_add_u32 m0, s76, 0
    s_nop 0
    buffer_load_dwordx4 v218, s[60:63], s77 offen nt lds
    buffer_load_dwordx4 v219, s[60:63], s77 offen offset:1024 nt lds
    v_mfma_f32_16x16x32_bf16 v[64:67], v[212:215], v[184:187], v[64:67]
    ds_read_b128 v[184:187], v225 offset:6144
    v_mfma_f32_16x16x32_bf16 v[68:71], v[212:215], v[188:191], v[68:71]
    ds_read_b128 v[188:191], v225 offset:7168
    v_mfma_f32_16x16x32_bf16 v[72:75], v[212:215], v[192:195], v[72:75]
    ds_read_b128 v[192:195], v225 offset:8192
    v_mfma_f32_16x16x32_bf16 v[76:79], v[212:215], v[196:199], v[76:79]
    ds_read_b128 v[196:199], v225 offset:9216
L_sjoin:
    s_waitcnt vmcnt(8)
    v_mfma_f32_16x16x32_bf16 v[0:3], v[200:203], v[160:163], v[0:3]
    ds_read_b128 v[208:211], v216 offset:2048
    s_waitcnt lgkmcnt(9)
    v_mfma_f32_16x16x32_bf16 v[4:7], v[200:203], v[164:167], v[4:7]
    ds_read_b128 v[212:215], v217 offset:2048
    s_waitcnt lgkmcnt(9)
    v_mfma_f32_16x16x32_bf16 v[8:11], v[200:203], v[168:171], v[8:11]
    s_waitcnt lgkmcnt(8)
    v_mfma_f32_16x16x32_bf16 v[12:15], v[200:203], v[172:175], v[12:15]
    s_waitcnt lgkmcnt(7)
    v_mfma_f32_16x16x32_bf16 v[16:19], v[200:203], v[176:179], v[16:19]
    s_waitcnt lgkmcnt(6)
    v_mfma_f32_16x16x32_bf16 v[0:3], v[204:207], v[180:183], v[0:3]
    s_waitcnt lgkmcnt(0)
    s_add_u32 s77, s94, 49152
    s_add_u32 m0, s76, 2048
    s_nop 0
    buffer_load_dwordx4 v218, s[60:63], s77 offen nt lds
    buffer_load_dwordx4 v219, s[60:63], s77 offen offset:1024 nt lds
    v_mfma_f32_16x16x32_bf16 v[4:7], v[204:207], v[184:187], v[4:7]
    v_mfma_f32_16x16x32_bf16 v[8:11], v[204:207], v[188:191], v[8:11]
    v_mfma_f32_16x16x32_bf16 v[12:15], v[204:207], v[192:195], v[12:15]
    v_mfma_f32_16x16x32_bf16 v[16:19], v[204:207], v[196:199], v[16:19]
    s_waitcnt vmcnt(8)
    v_mfma_f32_16x16x32_bf16 v[20:23], v[208:211], v[160:163], v[20:23]
    ds_read_b128 v[200:203], v216 offset:4096
    v_mfma_f32_16x16x32_bf16 v[24:27], v[208:211], v[164:167], v[24:27]
    ds_read_b128 v[204:207], v217 offset:4096
    v_mfma_f32_16x16x32_bf16 v[28:31], v[208:211], v[168:171], v[28:31]
    v_mfma_f32_16x16x32_bf16 v[32:35], v[208:211], v[172:175], v[32:35]
    v_mfma_f32_16x16x32_bf16 v[36:39], v[208:211], v[176:179], v[36:39]
    v_max3_f32 v248, v0, v1, v2
    v_max_f32 v248, v248, v3
    v_mfma_f32_16x16x32_bf16 v[20:23], v[212:215], v[180:183], v[20:23]
    s_waitcnt lgkmcnt(0)
    s_add_u32 s77, s94, 57344
    s_add_u32 m0, s76, 4096
    s_nop 0
    buffer_load_dwordx4 v218, s[60:63], s77 offen nt lds
    buffer_load_dwordx4 v219, s[60:63], s77 offen offset:1024 nt lds
    v_max3_f32 v249, v4, v5, v6
    v_max_f32 v249, v249, v7
    v_mfma_f32_16x16x32_bf16 v[24:27], v[212:215], v[184:187], v[24:27]
    v_max3_f32 v250, v8, v9, v10
    v_max_f32 v250, v250, v11
    v_mfma_f32_16x16x32_bf16 v[28:31], v[212:215], v[188:191], v[28:31]
    v_max3_f32 v251, v12, v13, v14
    v_max_f32 v251, v251, v15
    v_mfma_f32_16x16x32_bf16 v[32:35], v[212:215], v[192:195], v[32:35]
    v_max3_f32 v252, v16, v17, v18
    v_max_f32 v252, v252, v19
    v_mfma_f32_16x16x32_bf16 v[36:39], v[212:215], v[196:199], v[36:39]
    s_waitcnt vmcnt(8)
    v_mfma_f32_16x16x32_bf16 v[40:43], v[200:203], v[160:163], v[40:43]
    ds_read_b128 v[208:211], v216 offset:6144
    v_mfma_f32_16x16x32_bf16 v[44:47], v[200:203], v[164:167], v[44:47]
    ds_read_b128 v[212:215], v217 offset:6144
    v_mfma_f32_16x16x32_bf16 v[48:51], v[200:203], v[168:171], v[48:51]
    v_mfma_f32_16x16x32_bf16 v[52:55], v[200:203], v[172:175], v[52:55]
    v_mfma_f32_16x16x32_bf16 v[56:59], v[200:203], v[176:179], v[56:59]
    v_max3_f32 v248, v248, v20, v21
    v_max3_f32 v248, v248, v22, v23
    v_mfma_f32_16x16x32_bf16 v[40:43], v[204:207], v[180:183], v[40:43]
    s_waitcnt lgkmcnt(0)
    s_add_u32 s77, s95, 32768
    s_add_u32 m0, s76, 6144
    s_nop 0
    buffer_load_dwordx4 v218, s[60:63], s77 offen nt lds
    buffer_load_dwordx4 v219, s[60:63], s77 offen offset:1024 nt lds
    v_max3_f32 v249, v249, v24, v25
    v_max3_f32 v249, v249, v26, v27
    v_mfma_f32_16x16x32_bf16 v[44:47], v[204:207], v[184:187], v[44:47]
    v_max3_f32 v250, v250, v28, v29
    v_max3_f32 v250, v250, v30, v31
    v_mfma_f32_16x16x32_bf16 v[48:51], v[204:207], v[188:191], v[48:51]
    v_max3_f32 v251, v251, v32, v33
    v_max3_f32 v251, v251, v34, v35
    v_mfma_f32_16x16x32_bf16 v[52:55], v[204:207], v[192:195], v[52:55]
    v_max3_f32 v252, v252, v36, v37
    v_max3_f32 v252, v252, v38, v39
    v_mfma_f32_16x16x32_bf16 v[56:59], v[204:207], v[196:199], v[56:59]
    s_mul_i32 s88, s94, 80
    v_add_u32 v225, s88, v224
    s_waitcnt vmcnt(8)
    v_mfma_f32_16x16x32_bf16 v[60:63], v[208:211], v[160:163], v[60:63]
    ds_read_b128 v[200:203], v216 offset:8192
    ds_read_b128 v[160:163], v225
    v_mfma_f32_16x16x32_bf16 v[64:67], v[208:211], v[164:167], v[64:67]
    ds_read_b128 v[204:207], v217 offset:8192
    ds_read_b128 v[164:167], v225 offset:1024
    v_mfma_f32_16x16x32_bf16 v[68:71], v[208:211], v[168:171], v[68:71]
    ds_read_b128 v[168:171], v225 offset:2048
    v_mfma_f32_16x16x32_bf16 v[72:75], v[208:211], v[172:175], v[72:75]
    ds_read_b128 v[172:175], v225 offset:3072
    v_mfma_f32_16x16x32_bf16 v[76:79], v[208:211], v[176:179], v[76:79]
    ds_read_b128 v[176:179], v225 offset:4096
    v_max3_f32 v248, v248, v40, v41
    v_max3_f32 v248, v248, v42, v43
    v_mfma_f32_16x16x32_bf16 v[60:63], v[212:215], v[180:183], v[60:63]
    ds_read_b128 v[180:183], v225 offset:5120
    s_waitcnt lgkmcnt(5)
    s_add_u32 s77, s95, 40960
    s_add_u32 m0, s76, 8192
    s_nop 0
    buffer_load_dwordx4 v218, s[60:63], s77 offen nt lds
    buffer_load_dwordx4 v219, s[60:63], s77 offen offset:1024 nt lds
    v_max3_f32 v249, v249, v44, v45
    v_max3_f32 v249, v249, v46, v47
    v_mfma_f32_16x16x32_bf16 v[64:67], v[212:215], v[184:187], v[64:67]
    ds_read_b128 v[184:187], v225 offset:6144
    v_max3_f32 v250, v250, v48, v49
    v_max3_f32 v250, v250, v50, v51
    v_mfma_f32_16x16x32_bf16 v[68:71], v[212:215], v[188:191], v[68:71]
    ds_read_b128 v[188:191], v225 offset:7168
    v_max3_f32 v251, v251, v52, v53
    v_max3_f32 v251, v251, v54, v55
    v_mfma_f32_16x16x32_bf16 v[72:75], v[212:215], v[192:195], v[72:75]
    ds_read_b128 v[192:195], v225 offset:8192
    v_max3_f32 v252, v252, v56, v57
    v_max3_f32 v252, v252, v58, v59
    v_mfma_f32_16x16x32_bf16 v[76:79], v[212:215], v[196:199], v[76:79]
    ds_read_b128 v[196:199], v225 offset:9216
    s_waitcnt vmcnt(8)
    v_mfma_f32_16x16x32_bf16 v[80:83], v[200:203], v[160:163], 0
    ds_read_b128 v[208:211], v216
    s_waitcnt lgkmcnt(9)
    v_mfma_f32_16x16x32_bf16 v[84:87], v[200:203], v[164:167], 0
    ds_read_b128 v[212:215], v217
    s_waitcnt lgkmcnt(9)
    v_mfma_f32_16x16x32_bf16 v[88:91], v[200:203], v[168:171], 0
    s_waitcnt lgkmcnt(8)
    v_mfma_f32_16x16x32_bf16 v[92:95], v[200:203], v[172:175], 0
    s_waitcnt lgkmcnt(7)
    v_mfma_f32_16x16x32_bf16 v[96:99], v[200:203], v[176:179], 0
    v_max3_f32 v248, v248, v60, v61
    v_max3_f32 v248, v248, v62, v63
    s_waitcnt lgkmcnt(6)
    v_mfma_f32_16x16x32_bf16 v[80:83], v[204:207], v[180:183], v[80:83]
    s_waitcnt lgkmcnt(0)
    s_add_u32 s77, s95, 49152
    s_add_u32 m0, s76, 0
    s_nop 0
    buffer_load_dwordx4 v218, s[60:63], s77 offen nt lds
    buffer_load_dwordx4 v219, s[60:63], s77 offen offset:1024 nt lds
    v_max3_f32 v249, v249, v64, v65
    v_max3_f32 v249, v249, v66, v67
    v_mfma_f32_16x16x32_bf16 v[84:87], v[204:207], v[184:187], v[84:87]
    v_max3_f32 v250, v250, v68, v69
    v_max3_f32 v250, v250, v70, v71
    v_mfma_f32_16x16x32_bf16 v[88:91], v[204:207], v[188:191], v[88:91]
    v_max3_f32 v251, v251, v72, v73
    v_max3_f32 v251, v251, v74, v75
    v_mfma_f32_16x16x32_bf16 v[92:95], v[204:207], v[192:195], v[92:95]
    v_max3_f32 v252, v252, v76, v77
    v_max3_f32 v252, v252, v78, v79
    v_mfma_f32_16x16x32_bf16 v[96:99], v[204:207], v[196:199], v[96:99]
    v_mov_b32 v240, v248
    v_mov_b32 v241, v249
    s_waitcnt vmcnt(8)
    v_mfma_f32_16x16x32_bf16 v[100:103], v[208:211], v[160:163], 0
    ds_read_b128 v[200:203], v216 offset:2048
    v_mov_b32 v242, v250
    v_mov_b32 v244, v251
    v_mfma_f32_16x16x32_bf16 v[104:107], v[208:211], v[164:167], 0
    ds_read_b128 v[204:207], v217 offset:2048
    v_mov_b32 v246, v252
    v_permlane32_swap_b32 v248, v240
    v_mfma_f32_16x16x32_bf16 v[108:111], v[208:211], v[168:171], 0
    v_permlane32_swap_b32 v249, v241
    v_permlane32_swap_b32 v250, v242
    v_mfma_f32_16x16x32_bf16 v[112:115], v[208:211], v[172:175], 0
    v_permlane32_swap_b32 v251, v244
    v_permlane32_swap_b32 v252, v246
    v_mfma_f32_16x16x32_bf16 v[116:119], v[208:211], v[176:179], 0
    v_max_f32 v248, v248, v240
    v_max_f32 v249, v249, v241
    v_mfma_f32_16x16x32_bf16 v[100:103], v[212:215], v[180:183], v[100:103]
    s_waitcnt lgkmcnt(0)
    s_add_u32 s77, s95, 57344
    s_add_u32 m0, s76, 2048
    s_nop 0
    buffer_load_dwordx4 v218, s[60:63], s77 offen nt lds
    buffer_load_dwordx4 v219, s[60:63], s77 offen offset:1024 nt lds
    v_max_f32 v250, v250, v242
    v_max_f32 v251, v251, v244
    v_mfma_f32_16x16x32_bf16 v[104:107], v[212:215], v[184:187], v[104:107]
    v_max_f32 v252, v252, v246
    v_mov_b32 v240, v248
    v_mfma_f32_16x16x32_bf16 v[108:111], v[212:215], v[188:191], v[108:111]
    v_mov_b32 v241, v249
    v_mov_b32 v242, v250
    v_mfma_f32_16x16x32_bf16 v[112:115], v[212:215], v[192:195], v[112:115]
    v_mov_b32 v244, v251
    v_mov_b32 v246, v252
    v_mfma_f32_16x16x32_bf16 v[116:119], v[212:215], v[196:199], v[116:119]
    v_permlane16_swap_b32 v248, v240
    v_permlane16_swap_b32 v249, v241
    s_waitcnt vmcnt(8)
    v_mfma_f32_16x16x32_bf16 v[120:123], v[200:203], v[160:163], 0
    ds_read_b128 v[208:211], v216 offset:4096
    v_permlane16_swap_b32 v250, v242
    v_permlane16_swap_b32 v251, v244
    v_mfma_f32_16x16x32_bf16 v[124:127], v[200:203], v[164:167], 0
    ds_read_b128 v[212:215], v217 offset:4096
    v_permlane16_swap_b32 v252, v246
    v_max_f32 v248, v248, v240
    v_mfma_f32_16x16x32_bf16 v[128:131], v[200:203], v[168:171], 0
    v_max_f32 v249, v249, v241
    v_max_f32 v250, v250, v242
    v_mfma_f32_16x16x32_bf16 v[132:135], v[200:203], v[172:175], 0
    v_max_f32 v251, v251, v244
    v_max_f32 v252, v252, v246
    v_mfma_f32_16x16x32_bf16 v[136:139], v[200:203], v[176:179], 0
    v_mul_f32 v234, s80, v248
    v_mul_f32 v235, s80, v249
    v_mfma_f32_16x16x32_bf16 v[120:123], v[204:207], v[180:183], v[120:123]
    s_waitcnt lgkmcnt(0)
    s_add_u32 s77, s96, 32768
    s_add_u32 m0, s76, 4096
    s_nop 0
    buffer_load_dwordx4 v218, s[60:63], s77 offen nt lds
    buffer_load_dwordx4 v219, s[60:63], s77 offen offset:1024 nt lds
    v_mul_f32 v236, s80, v250
    v_mul_f32 v238, s80, v251
    v_mfma_f32_16x16x32_bf16 v[124:127], v[204:207], v[184:187], v[124:127]
    v_mul_f32 v239, s80, v252
    v_fma_f32 v0, v0, s78, v234
    v_mfma_f32_16x16x32_bf16 v[128:131], v[204:207], v[188:191], v[128:131]
    v_fma_f32 v1, v1, s78, v234
    v_fma_f32 v2, v2, s78, v234
    v_mfma_f32_16x16x32_bf16 v[132:135], v[204:207], v[192:195], v[132:135]
    v_fma_f32 v3, v3, s78, v234
    v_exp_f32 v0, v0
    v_mfma_f32_16x16x32_bf16 v[136:139], v[204:207], v[196:199], v[136:139]
    s_mul_i32 s88, s95, 80
    v_add_u32 v225, s88, v224
    v_exp_f32 v1, v1
    v_exp_f32 v2, v2
    s_waitcnt vmcnt(8)
    v_mfma_f32_16x16x32_bf16 v[140:143], v[208:211], v[160:163], 0
    ds_read_b128 v[200:203], v216 offset:6144
    ds_read_b128 v[160:163], v225
    v_exp_f32 v3, v3
    v_add_f32 v240, v0, v1
    v_mfma_f32_16x16x32_bf16 v[144:147], v[208:211], v[164:167], 0
    ds_read_b128 v[204:207], v217 offset:6144
    ds_read_b128 v[164:167], v225 offset:1024
    v_add_f32 v240, v240, v2
    v_add_f32 v240, v240, v3
    v_mfma_f32_16x16x32_bf16 v[148:151], v[208:211], v[168:171], 0
    ds_read_b128 v[168:171], v225 offset:2048
    v_fma_f32 v4, v4, s78, v235
    v_fma_f32 v5, v5, s78, v235
    v_mfma_f32_16x16x32_bf16 v[152:155], v[208:211], v[172:175], 0
    ds_read_b128 v[172:175], v225 offset:3072
    v_fma_f32 v6, v6, s78, v235
    v_fma_f32 v7, v7, s78, v235
    v_mfma_f32_16x16x32_bf16 v[156:159], v[208:211], v[176:179], 0
    ds_read_b128 v[176:179], v225 offset:4096
    v_exp_f32 v4, v4
    v_exp_f32 v5, v5
    v_mfma_f32_16x16x32_bf16 v[140:143], v[212:215], v[180:183], v[140:143]
    ds_read_b128 v[180:183], v225 offset:5120
    s_waitcnt lgkmcnt(5)
    s_add_u32 s77, s96, 40960
    s_add_u32 m0, s76, 6144
    s_nop 0
    buffer_load_dwordx4 v218, s[60:63], s77 offen nt lds
    buffer_load_dwordx4 v219, s[60:63], s77 offen offset:1024 nt lds
    v_exp_f32 v6, v6
    v_exp_f32 v7, v7
    v_mfma_f32_16x16x32_bf16 v[144:147], v[212:215], v[184:187], v[144:147]
    ds_read_b128 v[184:187], v225 offset:6144
    v_add_f32 v241, v4, v5
    v_add_f32 v241, v241, v6
    v_mfma_f32_16x16x32_bf16 v[148:151], v[212:215], v[188:191], v[148:151]
    ds_read_b128 v[188:191], v225 offset:7168
    v_add_f32 v241, v241, v7
    v_fma_f32 v8, v8, s78, v236
    v_mfma_f32_16x16x32_bf16 v[152:155], v[212:215], v[192:195], v[152:155]
    ds_read_b128 v[192:195], v225 offset:8192
    v_fma_f32 v9, v9, s78, v236
    v_fma_f32 v10, v10, s78, v236
    v_mfma_f32_16x16x32_bf16 v[156:159], v[212:215], v[196:199], v[156:159]
    ds_read_b128 v[196:199], v225 offset:9216
    v_fma_f32 v11, v11, s78, v236
    v_exp_f32 v8, v8
    s_waitcnt vmcnt(8)
    v_mfma_f32_16x16x32_bf16 v[80:83], v[200:203], v[160:163], v[80:83]
    ds_read_b128 v[208:211], v216 offset:8192
    v_exp_f32 v9, v9
    v_exp_f32 v10, v10
    s_waitcnt lgkmcnt(9)
    v_mfma_f32_16x16x32_bf16 v[84:87], v[200:203], v[164:167], v[84:87]
    ds_read_b128 v[212:215], v217 offset:8192
    v_exp_f32 v11, v11
    v_add_f32 v242, v8, v9
    s_waitcnt lgkmcnt(9)
    v_mfma_f32_16x16x32_bf16 v[88:91], v[200:203], v[168:171], v[88:91]
    v_add_f32 v242, v242, v10
    v_add_f32 v242, v242, v11
    s_waitcnt lgkmcnt(8)
    v_mfma_f32_16x16x32_bf16 v[92:95], v[200:203], v[172:175], v[92:95]
    v_fma_f32 v12, v12, s78, v238
    v_fma_f32 v13, v13, s78, v238
    s_waitcnt lgkmcnt(7)
    v_mfma_f32_16x16x32_bf16 v[96:99], v[200:203], v[176:179], v[96:99]
    v_fma_f32 v14, v14, s78, v238
    v_fma_f32 v15, v15, s78, v238
    s_waitcnt lgkmcnt(6)
    v_mfma_f32_16x16x32_bf16 v[80:83], v[204:207], v[180:183], v[80:83]
    s_waitcnt lgkmcnt(0)
    s_add_u32 s77, s96, 49152
    s_add_u32 m0, s76, 8192
    s_nop 0
    buffer_load_dwordx4 v218, s[60:63], s77 offen nt lds
    buffer_load_dwordx4 v219, s[60:63], s77 offen offset:1024 nt lds
    v_exp_f32 v12, v12
    v_exp_f32 v13, v13
    v_mfma_f32_16x16x32_bf16 v[84:87], v[204:207], v[184:187], v[84:87]
    v_exp_f32 v14, v14
    v_exp_f32 v15, v15
    v_mfma_f32_16x16x32_bf16 v[88:91], v[204:207], v[188:191], v[88:91]
    v_add_f32 v244, v12, v13
    v_add_f32 v244, v244, v14
    v_mfma_f32_16x16x32_bf16 v[92:95], v[204:207], v[192:195], v[92:95]
    v_add_f32 v244, v244, v15
    v_fma_f32 v16, v16, s78, v239
    v_mfma_f32_16x16x32_bf16 v[96:99], v[204:207], v[196:199], v[96:99]
    v_fma_f32 v17, v17, s78, v239
    v_fma_f32 v18, v18, s78, v239
    s_waitcnt vmcnt(8)
    v_mfma_f32_16x16x32_bf16 v[100:103], v[208:211], v[160:163], v[100:103]
    ds_read_b128 v[200:203], v216
    v_fma_f32 v19, v19, s78, v239
    v_exp_f32 v16, v16
    v_mfma_f32_16x16x32_bf16 v[104:107], v[208:211], v[164:167], v[104:107]
    ds_read_b128 v[204:207], v217
    v_exp_f32 v17, v17
    v_exp_f32 v18, v18
    v_mfma_f32_16x16x32_bf16 v[108:111], v[208:211], v[168:171], v[108:111]
    v_exp_f32 v19, v19
    v_add_f32 v246, v16, v17
    v_mfma_f32_16x16x32_bf16 v[112:115], v[208:211], v[172:175], v[112:115]
    v_add_f32 v246, v246, v18
    v_add_f32 v246, v246, v19
    v_mfma_f32_16x16x32_bf16 v[116:119], v[208:211], v[176:179], v[116:119]
    v_fma_f32 v20, v20, s78, v234
    v_fma_f32 v21, v21, s78, v234
    v_mfma_f32_16x16x32_bf16 v[100:103], v[212:215], v[180:183], v[100:103]
    s_waitcnt lgkmcnt(0)
    s_add_u32 s77, s96, 57344
    s_add_u32 m0, s76, 0
    s_nop 0
    buffer_load_dwordx4 v218, s[60:63], s77 offen nt lds
    buffer_load_dwordx4 v219, s[60:63], s77 offen offset:1024 nt lds
    v_fma_f32 v22, v22, s78, v234
    v_fma_f32 v23, v23, s78, v234
    v_mfma_f32_16x16x32_bf16 v[104:107], v[212:215], v[184:187], v[104:107]
    v_exp_f32 v20, v20
    v_exp_f32 v21, v21
    v_mfma_f32_16x16x32_bf16 v[108:111], v[212:215], v[188:191], v[108:111]
    v_exp_f32 v22, v22
    v_exp_f32 v23, v23
    v_mfma_f32_16x16x32_bf16 v[112:115], v[212:215], v[192:195], v[112:115]
    v_add_f32 v240, v240, v20
    v_add_f32 v240, v240, v21
    v_mfma_f32_16x16x32_bf16 v[116:119], v[212:215], v[196:199], v[116:119]
    v_add_f32 v240, v240, v22
    v_add_f32 v240, v240, v23
    s_waitcnt vmcnt(8)
    v_mfma_f32_16x16x32_bf16 v[120:123], v[200:203], v[160:163], v[120:123]
    ds_read_b128 v[208:211], v216 offset:2048
    v_fma_f32 v24, v24, s78, v235
    v_fma_f32 v25, v25, s78, v235
    v_mfma_f32_16x16x32_bf16 v[124:127], v[200:203], v[164:167], v[124:127]
    ds_read_b128 v[212:215], v217 offset:2048
    v_fma_f32 v26, v26, s78, v235
    v_fma_f32 v27, v27, s78, v235
    v_mfma_f32_16x16x32_bf16 v[128:131], v[200:203], v[168:171], v[128:131]
    v_exp_f32 v24, v24
    v_exp_f32 v25, v25
    v_mfma_f32_16x16x32_bf16 v[132:135], v[200:203], v[172:175], v[132:135]
    v_exp_f32 v26, v26
    v_exp_f32 v27, v27
    v_mfma_f32_16x16x32_bf16 v[136:139], v[200:203], v[176:179], v[136:139]
    v_add_f32 v241, v241, v24
    v_add_f32 v241, v241, v25
    v_mfma_f32_16x16x32_bf16 v[120:123], v[204:207], v[180:183], v[120:123]
    s_waitcnt lgkmcnt(0)
    s_add_u32 s77, s97, 32768
    s_add_u32 m0, s76, 2048
    s_nop 0
    buffer_load_dwordx4 v218, s[60:63], s77 offen nt lds
    buffer_load_dwordx4 v219, s[60:63], s77 offen offset:1024 nt lds
    v_add_f32 v241, v241, v26
    v_add_f32 v241, v241, v27
    v_mfma_f32_16x16x32_bf16 v[124:127], v[204:207], v[184:187], v[124:127]
    v_fma_f32 v28, v28, s78, v236
    v_fma_f32 v29, v29, s78, v236
    v_mfma_f32_16x16x32_bf16 v[128:131], v[204:207], v[188:191], v[128:131]
    v_fma_f32 v30, v30, s78, v236
    v_fma_f32 v31, v31, s78, v236
    v_mfma_f32_16x16x32_bf16 v[132:135], v[204:207], v[192:195], v[132:135]
    v_exp_f32 v28, v28
    v_exp_f32 v29, v29
    v_mfma_f32_16x16x32_bf16 v[136:139], v[204:207], v[196:199], v[136:139]
    s_mul_i32 s88, s96, 80
    v_add_u32 v225, s88, v224
    v_exp_f32 v30, v30
    v_exp_f32 v31, v31
    s_waitcnt vmcnt(8)
    v_mfma_f32_16x16x32_bf16 v[140:143], v[208:211], v[160:163], v[140:143]
    ds_read_b128 v[200:203], v216 offset:4096
    ds_read_b128 v[160:163], v225
    v_add_f32 v242, v242, v28
    v_add_f32 v242, v242, v29
    v_mfma_f32_16x16x32_bf16 v[144:147], v[208:211], v[164:167], v[144:147]
    ds_read_b128 v[204:207], v217 offset:4096
    ds_read_b128 v[164:167], v225 offset:1024
    v_add_f32 v242, v242, v30
    v_add_f32 v242, v242, v31
    v_mfma_f32_16x16x32_bf16 v[148:151], v[208:211], v[168:171], v[148:151]
    ds_read_b128 v[168:171], v225 offset:2048
    v_fma_f32 v32, v32, s78, v238
    v_fma_f32 v33, v33, s78, v238
    v_mfma_f32_16x16x32_bf16 v[152:155], v[208:211], v[172:175], v[152:155]
    ds_read_b128 v[172:175], v225 offset:3072
    v_fma_f32 v34, v34, s78, v238
    v_fma_f32 v35, v35, s78, v238
    v_mfma_f32_16x16x32_bf16 v[156:159], v[208:211], v[176:179], v[156:159]
    ds_read_b128 v[176:179], v225 offset:4096
    v_exp_f32 v32, v32
    v_exp_f32 v33, v33
    v_mfma_f32_16x16x32_bf16 v[140:143], v[212:215], v[180:183], v[140:143]
    ds_read_b128 v[180:183], v225 offset:5120
    s_waitcnt lgkmcnt(5)
    s_add_u32 s77, s97, 40960
    s_add_u32 m0, s76, 4096
    s_nop 0
    buffer_load_dwordx4 v218, s[60:63], s77 offen nt lds
    buffer_load_dwordx4 v219, s[60:63], s77 offen offset:1024 nt lds
    v_exp_f32 v34, v34
    v_exp_f32 v35, v35
    v_mfma_f32_16x16x32_bf16 v[144:147], v[212:215], v[184:187], v[144:147]
    ds_read_b128 v[184:187], v225 offset:6144
    v_add_f32 v244, v244, v32
    v_add_f32 v244, v244, v33
    v_mfma_f32_16x16x32_bf16 v[148:151], v[212:215], v[188:191], v[148:151]
    ds_read_b128 v[188:191], v225 offset:7168
    v_add_f32 v244, v244, v34
    v_add_f32 v244, v244, v35
    v_mfma_f32_16x16x32_bf16 v[152:155], v[212:215], v[192:195], v[152:155]
    ds_read_b128 v[192:195], v225 offset:8192
    v_fma_f32 v36, v36, s78, v239
    v_fma_f32 v37, v37, s78, v239
    v_mfma_f32_16x16x32_bf16 v[156:159], v[212:215], v[196:199], v[156:159]
    ds_read_b128 v[196:199], v225 offset:9216
    v_fma_f32 v38, v38, s78, v239
    v_fma_f32 v39, v39, s78, v239
    s_waitcnt vmcnt(8)
    v_mfma_f32_16x16x32_bf16 v[80:83], v[200:203], v[160:163], v[80:83]
    ds_read_b128 v[208:211], v216 offset:6144
    v_exp_f32 v36, v36
    v_exp_f32 v37, v37
    s_waitcnt lgkmcnt(9)
    v_mfma_f32_16x16x32_bf16 v[84:87], v[200:203], v[164:167], v[84:87]
    ds_read_b128 v[212:215], v217 offset:6144
    v_exp_f32 v38, v38
    v_exp_f32 v39, v39
    s_waitcnt lgkmcnt(9)
    v_mfma_f32_16x16x32_bf16 v[88:91], v[200:203], v[168:171], v[88:91]
    v_add_f32 v246, v246, v36
    v_add_f32 v246, v246, v37
    s_waitcnt lgkmcnt(8)
    v_mfma_f32_16x16x32_bf16 v[92:95], v[200:203], v[172:175], v[92:95]
    v_add_f32 v246, v246, v38
    v_add_f32 v246, v246, v39
    s_waitcnt lgkmcnt(7)
    v_mfma_f32_16x16x32_bf16 v[96:99], v[200:203], v[176:179], v[96:99]
    v_fma_f32 v40, v40, s78, v234
    v_fma_f32 v41, v41, s78, v234
    s_waitcnt lgkmcnt(6)
    v_mfma_f32_16x16x32_bf16 v[80:83], v[204:207], v[180:183], v[80:83]
    s_waitcnt lgkmcnt(0)
    s_add_u32 s77, s97, 49152
    s_add_u32 m0, s76, 6144
    s_nop 0
    buffer_load_dwordx4 v218, s[60:63], s77 offen nt lds
    buffer_load_dwordx4 v219, s[60:63], s77 offen offset:1024 nt lds
    v_fma_f32 v42, v42, s78, v234
    v_fma_f32 v43, v43, s78, v234
    v_mfma_f32_16x16x32_bf16 v[84:87], v[204:207], v[184:187], v[84:87]
    v_exp_f32 v40, v40
    v_exp_f32 v41, v41
    v_mfma_f32_16x16x32_bf16 v[88:91], v[204:207], v[188:191], v[88:91]
    v_exp_f32 v42, v42
    v_exp_f32 v43, v43
    v_mfma_f32_16x16x32_bf16 v[92:95], v[204:207], v[192:195], v[92:95]
    v_add_f32 v240, v240, v40
    v_add_f32 v240, v240, v41
    v_mfma_f32_16x16x32_bf16 v[96:99], v[204:207], v[196:199], v[96:99]
    v_add_f32 v240, v240, v42
    v_add_f32 v240, v240, v43
    s_waitcnt vmcnt(8)
    v_mfma_f32_16x16x32_bf16 v[100:103], v[208:211], v[160:163], v[100:103]
    ds_read_b128 v[200:203], v216 offset:8192
    v_fma_f32 v44, v44, s78, v235
    v_fma_f32 v45, v45, s78, v235
    v_mfma_f32_16x16x32_bf16 v[104:107], v[208:211], v[164:167], v[104:107]
    ds_read_b128 v[204:207], v217 offset:8192
    v_fma_f32 v46, v46, s78, v235
    v_fma_f32 v47, v47, s78, v235
    v_mfma_f32_16x16x32_bf16 v[108:111], v[208:211], v[168:171], v[108:111]
    v_exp_f32 v44, v44
    v_exp_f32 v45, v45
    v_mfma_f32_16x16x32_bf16 v[112:115], v[208:211], v[172:175], v[112:115]
    v_exp_f32 v46, v46
    v_exp_f32 v47, v47
    v_mfma_f32_16x16x32_bf16 v[116:119], v[208:211], v[176:179], v[116:119]
    v_add_f32 v241, v241, v44
    v_add_f32 v241, v241, v45
    v_mfma_f32_16x16x32_bf16 v[100:103], v[212:215], v[180:183], v[100:103]
    s_waitcnt lgkmcnt(0)
    s_add_u32 s77, s97, 57344
    s_add_u32 m0, s76, 8192
    s_nop 0
    buffer_load_dwordx4 v218, s[60:63], s77 offen nt lds
    buffer_load_dwordx4 v219, s[60:63], s77 offen offset:1024 nt lds
    v_add_f32 v241, v241, v46
    v_add_f32 v241, v241, v47
    v_mfma_f32_16x16x32_bf16 v[104:107], v[212:215], v[184:187], v[104:107]
    v_fma_f32 v48, v48, s78, v236
    v_fma_f32 v49, v49, s78, v236
    v_mfma_f32_16x16x32_bf16 v[108:111], v[212:215], v[188:191], v[108:111]
    v_fma_f32 v50, v50, s78, v236
    v_fma_f32 v51, v51, s78, v236
    v_mfma_f32_16x16x32_bf16 v[112:115], v[212:215], v[192:195], v[112:115]
    v_exp_f32 v48, v48
    v_exp_f32 v49, v49
    v_mfma_f32_16x16x32_bf16 v[116:119], v[212:215], v[196:199], v[116:119]
    v_exp_f32 v50, v50
    v_exp_f32 v51, v51
    s_waitcnt vmcnt(8)
    v_mfma_f32_16x16x32_bf16 v[120:123], v[200:203], v[160:163], v[120:123]
    ds_read_b128 v[208:211], v216
    v_add_f32 v242, v242, v48
    v_add_f32 v242, v242, v49
    v_mfma_f32_16x16x32_bf16 v[124:127], v[200:203], v[164:167], v[124:127]
    ds_read_b128 v[212:215], v217
    v_add_f32 v242, v242, v50
    v_add_f32 v242, v242, v51
    v_mfma_f32_16x16x32_bf16 v[128:131], v[200:203], v[168:171], v[128:131]
    v_fma_f32 v52, v52, s78, v238
    v_fma_f32 v53, v53, s78, v238
    v_mfma_f32_16x16x32_bf16 v[132:135], v[200:203], v[172:175], v[132:135]
    v_fma_f32 v54, v54, s78, v238
    v_fma_f32 v55, v55, s78, v238
    v_mfma_f32_16x16x32_bf16 v[136:139], v[200:203], v[176:179], v[136:139]
    v_exp_f32 v52, v52
    v_exp_f32 v53, v53
    v_mfma_f32_16x16x32_bf16 v[120:123], v[204:207], v[180:183], v[120:123]
    s_waitcnt lgkmcnt(0)
    v_exp_f32 v54, v54
    v_exp_f32 v55, v55
    v_mfma_f32_16x16x32_bf16 v[124:127], v[204:207], v[184:187], v[124:127]
    v_add_f32 v244, v244, v52
    v_add_f32 v244, v244, v53
    v_mfma_f32_16x16x32_bf16 v[128:131], v[204:207], v[188:191], v[128:131]
    v_add_f32 v244, v244, v54
    v_add_f32 v244, v244, v55
    v_mfma_f32_16x16x32_bf16 v[132:135], v[204:207], v[192:195], v[132:135]
    v_fma_f32 v56, v56, s78, v239
    v_fma_f32 v57, v57, s78, v239
    v_mfma_f32_16x16x32_bf16 v[136:139], v[204:207], v[196:199], v[136:139]
    s_mul_i32 s88, s97, 80
    v_add_u32 v225, s88, v224
    v_fma_f32 v58, v58, s78, v239
    v_fma_f32 v59, v59, s78, v239
    s_waitcnt vmcnt(6)
    v_mfma_f32_16x16x32_bf16 v[140:143], v[208:211], v[160:163], v[140:143]
    ds_read_b128 v[200:203], v216 offset:2048
    ds_read_b128 v[160:163], v225
    v_exp_f32 v56, v56
    v_exp_f32 v57, v57
    v_mfma_f32_16x16x32_bf16 v[144:147], v[208:211], v[164:167], v[144:147]
    ds_read_b128 v[204:207], v217 offset:2048
    ds_read_b128 v[164:167], v225 offset:1024
    v_exp_f32 v58, v58
    v_exp_f32 v59, v59
    v_mfma_f32_16x16x32_bf16 v[148:151], v[208:211], v[168:171], v[148:151]
    ds_read_b128 v[168:171], v225 offset:2048
    v_add_f32 v246, v246, v56
    v_add_f32 v246, v246, v57
    v_mfma_f32_16x16x32_bf16 v[152:155], v[208:211], v[172:175], v[152:155]
    ds_read_b128 v[172:175], v225 offset:3072
    v_add_f32 v246, v246, v58
    v_add_f32 v246, v246, v59
    v_mfma_f32_16x16x32_bf16 v[156:159], v[208:211], v[176:179], v[156:159]
    ds_read_b128 v[176:179], v225 offset:4096
    v_fma_f32 v60, v60, s78, v234
    v_fma_f32 v61, v61, s78, v234
    v_mfma_f32_16x16x32_bf16 v[140:143], v[212:215], v[180:183], v[140:143]
    ds_read_b128 v[180:183], v225 offset:5120
    s_waitcnt lgkmcnt(5)
    s_mov_b32 s77, 0
    s_add_u32 m0, s76, 2048
    s_nop 0
    buffer_load_dwordx4 v220, s[64:67], s77 offen nt lds
    buffer_load_dwordx4 v221, s[64:67], s77 offen offset:1024 nt lds
    v_fma_f32 v62, v62, s78, v234
    v_fma_f32 v63, v63, s78, v234
    v_mfma_f32_16x16x32_bf16 v[144:147], v[212:215], v[184:187], v[144:147]
    ds_read_b128 v[184:187], v225 offset:6144
    v_exp_f32 v60, v60
    v_exp_f32 v61, v61
    v_mfma_f32_16x16x32_bf16 v[148:151], v[212:215], v[188:191], v[148:151]
    ds_read_b128 v[188:191], v225 offset:7168
    v_exp_f32 v62, v62
    v_exp_f32 v63, v63
    v_mfma_f32_16x16x32_bf16 v[152:155], v[212:215], v[192:195], v[152:155]
    ds_read_b128 v[192:195], v225 offset:8192
    v_add_f32 v240, v240, v60
    v_add_f32 v240, v240, v61
    v_mfma_f32_16x16x32_bf16 v[156:159], v[212:215], v[196:199], v[156:159]
    ds_read_b128 v[196:199], v225 offset:9216
    v_add_f32 v240, v240, v62
    v_add_f32 v240, v240, v63
    s_waitcnt vmcnt(6)
    v_mfma_f32_16x16x32_bf16 v[80:83], v[200:203], v[160:163], v[80:83]
    ds_read_b128 v[208:211], v216 offset:4096
    v_fma_f32 v64, v64, s78, v235
    v_fma_f32 v65, v65, s78, v235
    s_waitcnt lgkmcnt(9)
    v_mfma_f32_16x16x32_bf16 v[84:87], v[200:203], v[164:167], v[84:87]
    ds_read_b128 v[212:215], v217 offset:4096
    v_fma_f32 v66, v66, s78, v235
    v_fma_f32 v67, v67, s78, v235
    s_waitcnt lgkmcnt(9)
    v_mfma_f32_16x16x32_bf16 v[88:91], v[200:203], v[168:171], v[88:91]
    v_exp_f32 v64, v64
    v_exp_f32 v65, v65
    s_waitcnt lgkmcnt(8)
    v_mfma_f32_16x16x32_bf16 v[92:95], v[200:203], v[172:175], v[92:95]
    v_exp_f32 v66, v66
    v_exp_f32 v67, v67
    s_waitcnt lgkmcnt(7)
    v_mfma_f32_16x16x32_bf16 v[96:99], v[200:203], v[176:179], v[96:99]
    v_add_f32 v241, v241, v64
    v_add_f32 v241, v241, v65
    s_waitcnt lgkmcnt(6)
    v_mfma_f32_16x16x32_bf16 v[80:83], v[204:207], v[180:183], v[80:83]
    s_waitcnt lgkmcnt(0)
    s_mov_b32 s77, 8192
    s_add_u32 m0, s76, 4096
    s_nop 0
    buffer_load_dwordx4 v220, s[64:67], s77 offen nt lds
    buffer_load_dwordx4 v221, s[64:67], s77 offen offset:1024 nt lds
    v_add_f32 v241, v241, v66
    v_add_f32 v241, v241, v67
    v_mfma_f32_16x16x32_bf16 v[84:87], v[204:207], v[184:187], v[84:87]
    v_fma_f32 v68, v68, s78, v236
    v_fma_f32 v69, v69, s78, v236
    v_mfma_f32_16x16x32_bf16 v[88:91], v[204:207], v[188:191], v[88:91]
    v_fma_f32 v70, v70, s78, v236
    v_fma_f32 v71, v71, s78, v236
    v_mfma_f32_16x16x32_bf16 v[92:95], v[204:207], v[192:195], v[92:95]
    v_exp_f32 v68, v68
    v_exp_f32 v69, v69
    v_mfma_f32_16x16x32_bf16 v[96:99], v[204:207], v[196:199], v[96:99]
    v_exp_f32 v70, v70
    v_exp_f32 v71, v71
    s_waitcnt vmcnt(6)
    v_mfma_f32_16x16x32_bf16 v[100:103], v[208:211], v[160:163], v[100:103]
    ds_read_b128 v[200:203], v216 offset:6144
    v_add_f32 v242, v242, v68
    v_add_f32 v242, v242, v69
    v_mfma_f32_16x16x32_bf16 v[104:107], v[208:211], v[164:167], v[104:107]
    ds_read_b128 v[204:207], v217 offset:6144
    v_add_f32 v242, v242, v70
    v_add_f32 v242, v242, v71
    v_mfma_f32_16x16x32_bf16 v[108:111], v[208:211], v[168:171], v[108:111]
    v_fma_f32 v72, v72, s78, v238
    v_fma_f32 v73, v73, s78, v238
    v_mfma_f32_16x16x32_bf16 v[112:115], v[208:211], v[172:175], v[112:115]
    v_fma_f32 v74, v74, s78, v238
    v_fma_f32 v75, v75, s78, v238
    v_mfma_f32_16x16x32_bf16 v[116:119], v[208:211], v[176:179], v[116:119]
    v_exp_f32 v72, v72
    v_exp_f32 v73, v73
    v_mfma_f32_16x16x32_bf16 v[100:103], v[212:215], v[180:183], v[100:103]
    s_waitcnt lgkmcnt(0)
    s_mov_b32 s77, 65536
    s_add_u32 m0, s76, 6144
    s_nop 0
    buffer_load_dwordx4 v220, s[64:67], s77 offen nt lds
    buffer_load_dwordx4 v221, s[64:67], s77 offen offset:1024 nt lds
    v_exp_f32 v74, v74
    v_exp_f32 v75, v75
    v_mfma_f32_16x16x32_bf16 v[104:107], v[212:215], v[184:187], v[104:107]
    v_add_f32 v244, v244, v72
    v_add_f32 v244, v244, v73
    v_mfma_f32_16x16x32_bf16 v[108:111], v[212:215], v[188:191], v[108:111]
    v_add_f32 v244, v244, v74
    v_add_f32 v244, v244, v75
    v_mfma_f32_16x16x32_bf16 v[112:115], v[212:215], v[192:195], v[112:115]
    v_fma_f32 v76, v76, s78, v239
    v_fma_f32 v77, v77, s78, v239
    v_mfma_f32_16x16x32_bf16 v[116:119], v[212:215], v[196:199], v[116:119]
    v_fma_f32 v78, v78, s78, v239
    v_fma_f32 v79, v79, s78, v239
    s_waitcnt vmcnt(6)
    v_mfma_f32_16x16x32_bf16 v[120:123], v[200:203], v[160:163], v[120:123]
    ds_read_b128 v[208:211], v216 offset:8192
    v_exp_f32 v76, v76
    v_exp_f32 v77, v77
    v_mfma_f32_16x16x32_bf16 v[124:127], v[200:203], v[164:167], v[124:127]
    ds_read_b128 v[212:215], v217 offset:8192
    v_exp_f32 v78, v78
    v_exp_f32 v79, v79
    v_mfma_f32_16x16x32_bf16 v[128:131], v[200:203], v[168:171], v[128:131]
    v_add_f32 v246, v246, v76
    v_add_f32 v246, v246, v77
    v_mfma_f32_16x16x32_bf16 v[132:135], v[200:203], v[172:175], v[132:135]
    v_add_f32 v246, v246, v78
    v_add_f32 v246, v246, v79
    v_mfma_f32_16x16x32_bf16 v[136:139], v[200:203], v[176:179], v[136:139]
    v_max3_f32 v248, v248, v80, v81
    v_max3_f32 v248, v248, v82, v83
    v_mfma_f32_16x16x32_bf16 v[120:123], v[204:207], v[180:183], v[120:123]
    s_waitcnt lgkmcnt(0)
    s_mov_b32 s77, 73728
    s_add_u32 m0, s76, 8192
    s_nop 0
    buffer_load_dwordx4 v220, s[64:67], s77 offen nt lds
    buffer_load_dwordx4 v221, s[64:67], s77 offen offset:1024 nt lds
    v_max3_f32 v249, v249, v84, v85
    v_max3_f32 v249, v249, v86, v87
    v_mfma_f32_16x16x32_bf16 v[124:127], v[204:207], v[184:187], v[124:127]
    v_max3_f32 v250, v250, v88, v89
    v_max3_f32 v250, v250, v90, v91
    v_mfma_f32_16x16x32_bf16 v[128:131], v[204:207], v[188:191], v[128:131]
    v_max3_f32 v251, v251, v92, v93
    v_max3_f32 v251, v251, v94, v95
    v_mfma_f32_16x16x32_bf16 v[132:135], v[204:207], v[192:195], v[132:135]
    v_max3_f32 v252, v252, v96, v97
    v_max3_f32 v252, v252, v98, v99
    v_mfma_f32_16x16x32_bf16 v[136:139], v[204:207], v[196:199], v[136:139]
    v_max3_f32 v248, v248, v100, v101
    v_max3_f32 v248, v248, v102, v103
    v_mfma_f32_16x16x32_bf16 v[140:143], v[208:211], v[160:163], v[140:143]
    v_max3_f32 v249, v249, v104, v105
    v_max3_f32 v249, v249, v106, v107
    v_mfma_f32_16x16x32_bf16 v[144:147], v[208:211], v[164:167], v[144:147]
    v_max3_f32 v250, v250, v108, v109
    v_max3_f32 v250, v250, v110, v111
    v_mfma_f32_16x16x32_bf16 v[148:151], v[208:211], v[168:171], v[148:151]
    v_max3_f32 v251, v251, v112, v113
    v_max3_f32 v251, v251, v114, v115
    v_mfma_f32_16x16x32_bf16 v[152:155], v[208:211], v[172:175], v[152:155]
    v_max3_f32 v252, v252, v116, v117
    v_max3_f32 v252, v252, v118, v119
    v_mfma_f32_16x16x32_bf16 v[156:159], v[208:211], v[176:179], v[156:159]
    v_max3_f32 v248, v248, v120, v121
    v_max3_f32 v248, v248, v122, v123
    v_mfma_f32_16x16x32_bf16 v[140:143], v[212:215], v[180:183], v[140:143]
    v_max3_f32 v249, v249, v124, v125
    v_max3_f32 v249, v249, v126, v127
    v_mfma_f32_16x16x32_bf16 v[144:147], v[212:215], v[184:187], v[144:147]
    v_max3_f32 v250, v250, v128, v129
    v_max3_f32 v250, v250, v130, v131
    v_mfma_f32_16x16x32_bf16 v[148:151], v[212:215], v[188:191], v[148:151]
    v_max3_f32 v251, v251, v132, v133
    v_max3_f32 v251, v251, v134, v135
    v_mfma_f32_16x16x32_bf16 v[152:155], v[212:215], v[192:195], v[152:155]
    v_max3_f32 v252, v252, v136, v137
    v_max3_f32 v252, v252, v138, v139
    v_mfma_f32_16x16x32_bf16 v[156:159], v[212:215], v[196:199], v[156:159]
    v_max3_f32 v248, v248, v140, v141
    v_max3_f32 v248, v248, v142, v143
    v_max3_f32 v249, v249, v144, v145
    v_max3_f32 v249, v249, v146, v147
    v_max3_f32 v250, v250, v148, v149
    v_max3_f32 v250, v250, v150, v151
    v_max3_f32 v251, v251, v152, v153
    v_max3_f32 v251, v251, v154, v155
    v_max3_f32 v252, v252, v156, v157
    v_max3_f32 v252, v252, v158, v159
    v_mov_b32 v206, v248
    v_mov_b32 v207, v249
    v_mov_b32 v208, v250
    v_mov_b32 v209, v251
    v_mov_b32 v210, v252
    v_permlane32_swap_b32 v248, v206
    v_permlane32_swap_b32 v249, v207
    v_permlane32_swap_b32 v250, v208
    v_permlane32_swap_b32 v251, v209
    v_permlane32_swap_b32 v252, v210
    v_max_f32 v248, v248, v206
    v_max_f32 v249, v249, v207
    v_max_f32 v250, v250, v208
    v_max_f32 v251, v251, v209
    v_max_f32 v252, v252, v210
    v_mov_b32 v206, v248
    v_mov_b32 v207, v249
    v_mov_b32 v208, v250
    v_mov_b32 v209, v251
    v_mov_b32 v210, v252
    v_permlane16_swap_b32 v248, v206
    v_permlane16_swap_b32 v249, v207
    v_permlane16_swap_b32 v250, v208
    v_permlane16_swap_b32 v251, v209
    v_permlane16_swap_b32 v252, v210
    v_max_f32 v176, v248, v206
    v_max_f32 v178, v249, v207
    v_max_f32 v180, v250, v208
    v_max_f32 v182, v251, v209
    v_max_f32 v184, v252, v210
    v_mul_f32 v186, s80, v176
    v_mul_f32 v188, s80, v178
    v_mul_f32 v190, s80, v180
    v_mul_f32 v192, s80, v182
    v_mul_f32 v194, s80, v184
    v_sub_f32 v234, v186, v234
    v_sub_f32 v235, v188, v235
    v_sub_f32 v236, v190, v236
    v_sub_f32 v238, v192, v238
    v_sub_f32 v239, v194, v239
    v_exp_f32 v234, v234
    v_exp_f32 v235, v235
    v_exp_f32 v236, v236
    v_exp_f32 v238, v238
    v_exp_f32 v239, v239
    v_pk_fma_f32 v[80:81], v[80:81], s[78:79], v[186:187] op_sel_hi:[1,0,0]
    v_pk_fma_f32 v[82:83], v[82:83], s[78:79], v[186:187] op_sel_hi:[1,0,0]
    v_pk_fma_f32 v[84:85], v[84:85], s[78:79], v[188:189] op_sel_hi:[1,0,0]
    v_pk_fma_f32 v[86:87], v[86:87], s[78:79], v[188:189] op_sel_hi:[1,0,0]
    v_pk_fma_f32 v[88:89], v[88:89], s[78:79], v[190:191] op_sel_hi:[1,0,0]
    v_pk_fma_f32 v[90:91], v[90:91], s[78:79], v[190:191] op_sel_hi:[1,0,0]
    v_pk_fma_f32 v[92:93], v[92:93], s[78:79], v[192:193] op_sel_hi:[1,0,0]
    v_pk_fma_f32 v[94:95], v[94:95], s[78:79], v[192:193] op_sel_hi:[1,0,0]
    v_pk_fma_f32 v[96:97], v[96:97], s[78:79], v[194:195] op_sel_hi:[1,0,0]
    v_pk_fma_f32 v[98:99], v[98:99], s[78:79], v[194:195] op_sel_hi:[1,0,0]
    v_exp_f32 v80, v80
    v_exp_f32 v81, v81
    v_exp_f32 v82, v82
    v_exp_f32 v83, v83
    v_exp_f32 v84, v84
    v_exp_f32 v85, v85
    v_exp_f32 v86, v86
    v_exp_f32 v87, v87
    v_exp_f32 v88, v88
    v_exp_f32 v89, v89
    v_exp_f32 v90, v90
    v_exp_f32 v91, v91
    v_exp_f32 v92, v92
    v_exp_f32 v93, v93
    v_exp_f32 v94, v94
    v_exp_f32 v95, v95
    v_exp_f32 v96, v96
    v_exp_f32 v97, v97
    v_exp_f32 v98, v98
    v_exp_f32 v99, v99
    v_pk_add_f32 v[196:197], v[80:81], v[82:83]
    v_pk_add_f32 v[198:199], v[84:85], v[86:87]
    v_pk_add_f32 v[200:201], v[88:89], v[90:91]
    v_pk_add_f32 v[202:203], v[92:93], v[94:95]
    v_pk_add_f32 v[204:205], v[96:97], v[98:99]
    v_pk_fma_f32 v[100:101], v[100:101], s[78:79], v[186:187] op_sel_hi:[1,0,0]
    v_pk_fma_f32 v[102:103], v[102:103], s[78:79], v[186:187] op_sel_hi:[1,0,0]
    v_pk_fma_f32 v[104:105], v[104:105], s[78:79], v[188:189] op_sel_hi:[1,0,0]
    v_pk_fma_f32 v[106:107], v[106:107], s[78:79], v[188:189] op_sel_hi:[1,0,0]
    v_pk_fma_f32 v[108:109], v[108:109], s[78:79], v[190:191] op_sel_hi:[1,0,0]
    v_pk_fma_f32 v[110:111], v[110:111], s[78:79], v[190:191] op_sel_hi:[1,0,0]
    v_pk_fma_f32 v[112:113], v[112:113], s[78:79], v[192:193] op_sel_hi:[1,0,0]
    v_pk_fma_f32 v[114:115], v[114:115], s[78:79], v[192:193] op_sel_hi:[1,0,0]
    v_pk_fma_f32 v[116:117], v[116:117], s[78:79], v[194:195] op_sel_hi:[1,0,0]
    v_pk_fma_f32 v[118:119], v[118:119], s[78:79], v[194:195] op_sel_hi:[1,0,0]
    v_exp_f32 v100, v100
    v_exp_f32 v101, v101
    v_exp_f32 v102, v102
    v_exp_f32 v103, v103
    v_exp_f32 v104, v104
    v_exp_f32 v105, v105
    v_exp_f32 v106, v106
    v_exp_f32 v107, v107
    v_exp_f32 v108, v108
    v_exp_f32 v109, v109
    v_exp_f32 v110, v110
    v_exp_f32 v111, v111
    v_exp_f32 v112, v112
    v_exp_f32 v113, v113
    v_exp_f32 v114, v114
    v_exp_f32 v115, v115
    v_exp_f32 v116, v116
    v_exp_f32 v117, v117
    v_exp_f32 v118, v118
    v_exp_f32 v119, v119
    v_pk_add_f32 v[196:197], v[196:197], v[100:101]
    v_pk_add_f32 v[198:199], v[198:199], v[104:105]
    v_pk_add_f32 v[200:201], v[200:201], v[108:109]
    v_pk_add_f32 v[202:203], v[202:203], v[112:113]
    v_pk_add_f32 v[204:205], v[204:205], v[116:117]
    v_pk_add_f32 v[196:197], v[196:197], v[102:103]
    v_pk_add_f32 v[198:199], v[198:199], v[106:107]
    v_pk_add_f32 v[200:201], v[200:201], v[110:111]
    v_pk_add_f32 v[202:203], v[202:203], v[114:115]
    v_pk_add_f32 v[204:205], v[204:205], v[118:119]
    v_pk_fma_f32 v[120:121], v[120:121], s[78:79], v[186:187] op_sel_hi:[1,0,0]
    v_pk_fma_f32 v[122:123], v[122:123], s[78:79], v[186:187] op_sel_hi:[1,0,0]
    v_pk_fma_f32 v[124:125], v[124:125], s[78:79], v[188:189] op_sel_hi:[1,0,0]
    v_pk_fma_f32 v[126:127], v[126:127], s[78:79], v[188:189] op_sel_hi:[1,0,0]
    v_pk_fma_f32 v[128:129], v[128:129], s[78:79], v[190:191] op_sel_hi:[1,0,0]
    v_pk_fma_f32 v[130:131], v[130:131], s[78:79], v[190:191] op_sel_hi:[1,0,0]
    v_pk_fma_f32 v[132:133], v[132:133], s[78:79], v[192:193] op_sel_hi:[1,0,0]
    v_pk_fma_f32 v[134:135], v[134:135], s[78:79], v[192:193] op_sel_hi:[1,0,0]
    v_pk_fma_f32 v[136:137], v[136:137], s[78:79], v[194:195] op_sel_hi:[1,0,0]
    v_pk_fma_f32 v[138:139], v[138:139], s[78:79], v[194:195] op_sel_hi:[1,0,0]
    v_exp_f32 v120, v120
    v_exp_f32 v121, v121
    v_exp_f32 v122, v122
    v_exp_f32 v123, v123
    v_exp_f32 v124, v124
    v_exp_f32 v125, v125
    v_exp_f32 v126, v126
    v_exp_f32 v127, v127
    v_exp_f32 v128, v128
    v_exp_f32 v129, v129
    v_exp_f32 v130, v130
    v_exp_f32 v131, v131
    v_exp_f32 v132, v132
    v_exp_f32 v133, v133
    v_exp_f32 v134, v134
    v_exp_f32 v135, v135
    v_exp_f32 v136, v136
    v_exp_f32 v137, v137
    v_exp_f32 v138, v138
    v_exp_f32 v139, v139
    v_pk_add_f32 v[196:197], v[196:197], v[120:121]
    v_pk_add_f32 v[198:199], v[198:199], v[124:125]
    v_pk_add_f32 v[200:201], v[200:201], v[128:129]
    v_pk_add_f32 v[202:203], v[202:203], v[132:133]
    v_pk_add_f32 v[204:205], v[204:205], v[136:137]
    v_pk_add_f32 v[196:197], v[196:197], v[122:123]
    v_pk_add_f32 v[198:199], v[198:199], v[126:127]
    v_pk_add_f32 v[200:201], v[200:201], v[130:131]
    v_pk_add_f32 v[202:203], v[202:203], v[134:135]
    v_pk_add_f32 v[204:205], v[204:205], v[138:139]
    v_pk_fma_f32 v[140:141], v[140:141], s[78:79], v[186:187] op_sel_hi:[1,0,0]
    v_pk_fma_f32 v[142:143], v[142:143], s[78:79], v[186:187] op_sel_hi:[1,0,0]
    v_pk_fma_f32 v[144:145], v[144:145], s[78:79], v[188:189] op_sel_hi:[1,0,0]
    v_pk_fma_f32 v[146:147], v[146:147], s[78:79], v[188:189] op_sel_hi:[1,0,0]
    v_pk_fma_f32 v[148:149], v[148:149], s[78:79], v[190:191] op_sel_hi:[1,0,0]
    v_pk_fma_f32 v[150:151], v[150:151], s[78:79], v[190:191] op_sel_hi:[1,0,0]
    v_pk_fma_f32 v[152:153], v[152:153], s[78:79], v[192:193] op_sel_hi:[1,0,0]
    v_pk_fma_f32 v[154:155], v[154:155], s[78:79], v[192:193] op_sel_hi:[1,0,0]
    v_pk_fma_f32 v[156:157], v[156:157], s[78:79], v[194:195] op_sel_hi:[1,0,0]
    v_pk_fma_f32 v[158:159], v[158:159], s[78:79], v[194:195] op_sel_hi:[1,0,0]
    v_exp_f32 v140, v140
    v_exp_f32 v141, v141
    v_exp_f32 v142, v142
    v_exp_f32 v143, v143
    v_exp_f32 v144, v144
    v_exp_f32 v145, v145
    v_exp_f32 v146, v146
    v_exp_f32 v147, v147
    v_exp_f32 v148, v148
    v_exp_f32 v149, v149
    v_exp_f32 v150, v150
    v_exp_f32 v151, v151
    v_exp_f32 v152, v152
    v_exp_f32 v153, v153
    v_exp_f32 v154, v154
    v_exp_f32 v155, v155
    v_exp_f32 v156, v156
    v_exp_f32 v157, v157
    v_exp_f32 v158, v158
    v_exp_f32 v159, v159
    v_pk_add_f32 v[196:197], v[196:197], v[140:141]
    v_pk_add_f32 v[198:199], v[198:199], v[144:145]
    v_pk_add_f32 v[200:201], v[200:201], v[148:149]
    v_pk_add_f32 v[202:203], v[202:203], v[152:153]
    v_pk_add_f32 v[204:205], v[204:205], v[156:157]
    v_pk_add_f32 v[196:197], v[196:197], v[142:143]
    v_pk_add_f32 v[198:199], v[198:199], v[146:147]
    v_pk_add_f32 v[200:201], v[200:201], v[150:151]
    v_pk_add_f32 v[202:203], v[202:203], v[154:155]
    v_pk_add_f32 v[204:205], v[204:205], v[158:159]
    v_add_f32 v196, v196, v197
    v_add_f32 v198, v198, v199
    v_add_f32 v200, v200, v201
    v_add_f32 v202, v202, v203
    v_add_f32 v204, v204, v205
    v_fmac_f32 v196, v240, v234
    v_fmac_f32 v198, v241, v235
    v_fmac_f32 v200, v242, v236
    v_fmac_f32 v202, v244, v238
    v_fmac_f32 v204, v246, v239
    v_mov_b32 v206, v196
    v_mov_b32 v207, v198
    v_mov_b32 v208, v200
    v_mov_b32 v209, v202
    v_mov_b32 v210, v204
    v_permlane32_swap_b32 v196, v206
    v_permlane32_swap_b32 v198, v207
    v_permlane32_swap_b32 v200, v208
    v_permlane32_swap_b32 v202, v209
    v_permlane32_swap_b32 v204, v210
    v_add_f32 v196, v196, v206
    v_add_f32 v198, v198, v207
    v_add_f32 v200, v200, v208
    v_add_f32 v202, v202, v209
    v_add_f32 v204, v204, v210
    v_mov_b32 v206, v196
    v_mov_b32 v207, v198
    v_mov_b32 v208, v200
    v_mov_b32 v209, v202
    v_mov_b32 v210, v204
    v_permlane16_swap_b32 v196, v206
    v_permlane16_swap_b32 v198, v207
    v_permlane16_swap_b32 v200, v208
    v_permlane16_swap_b32 v202, v209
    v_permlane16_swap_b32 v204, v210
    v_add_f32 v177, v196, v206
    v_add_f32 v179, v198, v207
    v_add_f32 v181, v200, v208
    v_add_f32 v183, v202, v209
    v_add_f32 v185, v204, v210
    s_mov_b64 exec, 0xffff
    ds_write_b64 v226, v[176:177]
    ds_write_b64 v226, v[178:179] offset:128
    ds_write_b64 v226, v[180:181] offset:256
    ds_write_b64 v226, v[182:183] offset:384
    ds_write_b64 v226, v[184:185] offset:512
    s_mov_b64 exec, -1
    s_waitcnt lgkmcnt(0)
    s_barrier
    ds_read_b64 v[160:161], v227
    ds_read_b64 v[162:163], v227 offset:10240
    ds_read_b64 v[164:165], v227 offset:20480
    ds_read_b64 v[166:167], v227 offset:30720
    ds_read_b64 v[168:169], v227 offset:128
    ds_read_b64 v[170:171], v227 offset:10368
    ds_read_b64 v[172:173], v227 offset:20608
    ds_read_b64 v[174:175], v227 offset:30848
    ds_read_b64 v[176:177], v227 offset:256
    ds_read_b64 v[178:179], v227 offset:10496
    ds_read_b64 v[180:181], v227 offset:20736
    ds_read_b64 v[182:183], v227 offset:30976
    ds_read_b64 v[196:197], v227 offset:384
    ds_read_b64 v[198:199], v227 offset:10624
    ds_read_b64 v[200:201], v227 offset:20864
    s_waitcnt lgkmcnt(14)
    ds_read_b64 v[202:203], v227 offset:31104
    s_waitcnt lgkmcnt(14)
    ds_read_b64 v[204:205], v227 offset:512
    s_waitcnt lgkmcnt(14)
    ds_read_b64 v[206:207], v227 offset:10752
    s_waitcnt lgkmcnt(14)
    ds_read_b64 v[208:209], v227 offset:20992
    s_waitcnt lgkmcnt(14)
    ds_read_b64 v[210:211], v227 offset:31232
    v_max3_f32 v248, v160, v162, v164
    v_max_f32 v248, v248, v166
    v_mul_f32 v248, s80, v248
    v_fma_f32 v160, v160, s78, v248
    v_fma_f32 v162, v162, s78, v248
    v_fma_f32 v164, v164, s78, v248
    v_fma_f32 v166, v166, s78, v248
    v_sub_f32 v186, v248, v186
    s_waitcnt lgkmcnt(13)
    v_max3_f32 v249, v168, v170, v172
    s_waitcnt lgkmcnt(12)
    v_max_f32 v249, v249, v174
    v_mul_f32 v249, s80, v249
    v_fma_f32 v168, v168, s78, v249
    v_fma_f32 v170, v170, s78, v249
    v_fma_f32 v172, v172, s78, v249
    v_fma_f32 v174, v174, s78, v249
    v_sub_f32 v188, v249, v188
    s_waitcnt lgkmcnt(9)
    v_max3_f32 v250, v176, v178, v180
    s_waitcnt lgkmcnt(8)
    v_max_f32 v250, v250, v182
    v_mul_f32 v250, s80, v250
    v_fma_f32 v176, v176, s78, v250
    v_fma_f32 v178, v178, s78, v250
    v_fma_f32 v180, v180, s78, v250
    v_fma_f32 v182, v182, s78, v250
    v_sub_f32 v190, v250, v190
    s_waitcnt lgkmcnt(5)
    v_max3_f32 v251, v196, v198, v200
    s_waitcnt lgkmcnt(4)
    v_max_f32 v251, v251, v202
    v_mul_f32 v251, s80, v251
    v_fma_f32 v196, v196, s78, v251
    v_fma_f32 v198, v198, s78, v251
    v_fma_f32 v200, v200, s78, v251
    v_fma_f32 v202, v202, s78, v251
    v_sub_f32 v192, v251, v192
    s_waitcnt lgkmcnt(1)
    v_max3_f32 v252, v204, v206, v208
    s_waitcnt lgkmcnt(0)
    v_max_f32 v252, v252, v210
    v_mul_f32 v252, s80, v252
    v_fma_f32 v204, v204, s78, v252
    v_fma_f32 v206, v206, s78, v252
    v_fma_f32 v208, v208, s78, v252
    v_fma_f32 v210, v210, s78, v252
    v_sub_f32 v194, v252, v194
    v_exp_f32 v160, v160
    v_exp_f32 v162, v162
    v_exp_f32 v164, v164
    v_exp_f32 v166, v166
    v_exp_f32 v186, v186
    v_exp_f32 v168, v168
    v_exp_f32 v170, v170
    v_exp_f32 v172, v172
    v_exp_f32 v174, v174
    v_exp_f32 v188, v188
    v_exp_f32 v176, v176
    v_exp_f32 v178, v178
    v_exp_f32 v180, v180
    v_exp_f32 v182, v182
    v_exp_f32 v190, v190
    v_exp_f32 v196, v196
    v_exp_f32 v198, v198
    v_exp_f32 v200, v200
    v_exp_f32 v202, v202
    v_exp_f32 v192, v192
    v_exp_f32 v204, v204
    v_exp_f32 v206, v206
    v_exp_f32 v208, v208
    v_exp_f32 v210, v210
    v_exp_f32 v194, v194
    v_mul_f32 v248, v160, v161
    v_fmac_f32 v248, v162, v163
    v_fmac_f32 v248, v164, v165
    v_fmac_f32 v248, v166, v167
    v_mul_f32 v249, v168, v169
    v_fmac_f32 v249, v170, v171
    v_fmac_f32 v249, v172, v173
    v_fmac_f32 v249, v174, v175
    v_mul_f32 v250, v176, v177
    v_fmac_f32 v250, v178, v179
    v_fmac_f32 v250, v180, v181
    v_fmac_f32 v250, v182, v183
    v_mul_f32 v251, v196, v197
    v_fmac_f32 v251, v198, v199
    v_fmac_f32 v251, v200, v201
    v_fmac_f32 v251, v202, v203
    v_mul_f32 v252, v204, v205
    v_fmac_f32 v252, v206, v207
    v_fmac_f32 v252, v208, v209
    v_fmac_f32 v252, v210, v211
    v_rcp_f32 v248, v248
    v_rcp_f32 v249, v249
    v_rcp_f32 v250, v250
    v_rcp_f32 v251, v251
    v_rcp_f32 v252, v252
    v_mul_f32 v248, v248, v186
    v_mul_f32 v249, v249, v188
    v_mul_f32 v250, v250, v190
    v_mul_f32 v251, v251, v192
    v_mul_f32 v252, v252, v194
    v_mul_f32 v186, v248, v234
    v_mul_f32 v188, v249, v235
    v_mul_f32 v190, v250, v236
    v_mul_f32 v192, v251, v238
    v_mul_f32 v194, v252, v239
    v_xor_b32 v234, 32, v233
    v_xor_b32 v235, 64, v233
    v_xor_b32 v236, 96, v233
    s_waitcnt vmcnt(6)
    s_waitcnt vmcnt(4)
    ds_read_b64_tr_b16 v[160:161], v233 offset:2048
    ds_read_b64_tr_b16 v[164:165], v234 offset:2048
    ds_read_b64_tr_b16 v[168:169], v235 offset:2048
    ds_read_b64_tr_b16 v[172:173], v236 offset:2048
    ds_read_b64_tr_b16 v[162:163], v233 offset:4096
    ds_read_b64_tr_b16 v[166:167], v234 offset:4096
    ds_read_b64_tr_b16 v[170:171], v235 offset:4096
    ds_read_b64_tr_b16 v[174:175], v236 offset:4096
    v_pk_mul_f32 v[0:1], v[0:1], v[186:187] op_sel_hi:[1,0]
    v_pk_mul_f32 v[2:3], v[2:3], v[186:187] op_sel_hi:[1,0]
    v_pk_mul_f32 v[20:21], v[20:21], v[186:187] op_sel_hi:[1,0]
    v_pk_mul_f32 v[22:23], v[22:23], v[186:187] op_sel_hi:[1,0]
    v_cvt_pk_bf16_f32 v0, v0, v1
    v_cvt_pk_bf16_f32 v1, v2, v3
    v_cvt_pk_bf16_f32 v2, v20, v21
    v_cvt_pk_bf16_f32 v3, v22, v23
    ds_write_b128 v228, v[0:3]
    v_pk_mul_f32 v[4:5], v[4:5], v[188:189] op_sel_hi:[1,0]
    v_pk_mul_f32 v[6:7], v[6:7], v[188:189] op_sel_hi:[1,0]
    v_pk_mul_f32 v[24:25], v[24:25], v[188:189] op_sel_hi:[1,0]
    v_pk_mul_f32 v[26:27], v[26:27], v[188:189] op_sel_hi:[1,0]
    v_cvt_pk_bf16_f32 v4, v4, v5
    v_cvt_pk_bf16_f32 v5, v6, v7
    v_cvt_pk_bf16_f32 v6, v24, v25
    v_cvt_pk_bf16_f32 v7, v26, v27
    ds_write_b128 v228, v[4:7] offset:1024
    v_pk_mul_f32 v[8:9], v[8:9], v[190:191] op_sel_hi:[1,0]
    v_pk_mul_f32 v[10:11], v[10:11], v[190:191] op_sel_hi:[1,0]
    v_pk_mul_f32 v[28:29], v[28:29], v[190:191] op_sel_hi:[1,0]
    v_pk_mul_f32 v[30:31], v[30:31], v[190:191] op_sel_hi:[1,0]
    v_cvt_pk_bf16_f32 v8, v8, v9
    v_cvt_pk_bf16_f32 v9, v10, v11
    v_cvt_pk_bf16_f32 v10, v28, v29
    v_cvt_pk_bf16_f32 v11, v30, v31
    ds_write_b128 v228, v[8:11] offset:2048
    v_pk_mul_f32 v[12:13], v[12:13], v[192:193] op_sel_hi:[1,0]
    v_pk_mul_f32 v[14:15], v[14:15], v[192:193] op_sel_hi:[1,0]
    v_pk_mul_f32 v[32:33], v[32:33], v[192:193] op_sel_hi:[1,0]
    v_pk_mul_f32 v[34:35], v[34:35], v[192:193] op_sel_hi:[1,0]
    v_cvt_pk_bf16_f32 v12, v12, v13
    v_cvt_pk_bf16_f32 v13, v14, v15
    v_cvt_pk_bf16_f32 v14, v32, v33
    v_cvt_pk_bf16_f32 v15, v34, v35
    ds_write_b128 v228, v[12:15] offset:3072
    v_pk_mul_f32 v[16:17], v[16:17], v[194:195] op_sel_hi:[1,0]
    v_pk_mul_f32 v[18:19], v[18:19], v[194:195] op_sel_hi:[1,0]
    v_pk_mul_f32 v[36:37], v[36:37], v[194:195] op_sel_hi:[1,0]
    v_pk_mul_f32 v[38:39], v[38:39], v[194:195] op_sel_hi:[1,0]
    v_cvt_pk_bf16_f32 v16, v16, v17
    v_cvt_pk_bf16_f32 v17, v18, v19
    v_cvt_pk_bf16_f32 v18, v36, v37
    v_cvt_pk_bf16_f32 v19, v38, v39
    ds_write_b128 v228, v[16:19] offset:4096
    v_pk_mul_f32 v[40:41], v[40:41], v[186:187] op_sel_hi:[1,0]
    v_pk_mul_f32 v[42:43], v[42:43], v[186:187] op_sel_hi:[1,0]
    v_pk_mul_f32 v[60:61], v[60:61], v[186:187] op_sel_hi:[1,0]
    v_pk_mul_f32 v[62:63], v[62:63], v[186:187] op_sel_hi:[1,0]
    v_cvt_pk_bf16_f32 v40, v40, v41
    v_cvt_pk_bf16_f32 v41, v42, v43
    v_cvt_pk_bf16_f32 v42, v60, v61
    v_cvt_pk_bf16_f32 v43, v62, v63
    ds_write_b128 v228, v[40:43] offset:20480
    v_pk_mul_f32 v[44:45], v[44:45], v[188:189] op_sel_hi:[1,0]
    v_pk_mul_f32 v[46:47], v[46:47], v[188:189] op_sel_hi:[1,0]
    v_pk_mul_f32 v[64:65], v[64:65], v[188:189] op_sel_hi:[1,0]
    v_pk_mul_f32 v[66:67], v[66:67], v[188:189] op_sel_hi:[1,0]
    v_cvt_pk_bf16_f32 v44, v44, v45
    v_cvt_pk_bf16_f32 v45, v46, v47
    v_cvt_pk_bf16_f32 v46, v64, v65
    v_cvt_pk_bf16_f32 v47, v66, v67
    ds_write_b128 v228, v[44:47] offset:21504
    v_pk_mul_f32 v[48:49], v[48:49], v[190:191] op_sel_hi:[1,0]
    v_pk_mul_f32 v[50:51], v[50:51], v[190:191] op_sel_hi:[1,0]
    v_pk_mul_f32 v[68:69], v[68:69], v[190:191] op_sel_hi:[1,0]
    v_pk_mul_f32 v[70:71], v[70:71], v[190:191] op_sel_hi:[1,0]
    v_cvt_pk_bf16_f32 v48, v48, v49
    v_cvt_pk_bf16_f32 v49, v50, v51
    v_cvt_pk_bf16_f32 v50, v68, v69
    v_cvt_pk_bf16_f32 v51, v70, v71
    s_waitcnt lgkmcnt(14)
    ds_write_b128 v228, v[48:51] offset:22528
    v_pk_mul_f32 v[52:53], v[52:53], v[192:193] op_sel_hi:[1,0]
    v_pk_mul_f32 v[54:55], v[54:55], v[192:193] op_sel_hi:[1,0]
    v_pk_mul_f32 v[72:73], v[72:73], v[192:193] op_sel_hi:[1,0]
    v_pk_mul_f32 v[74:75], v[74:75], v[192:193] op_sel_hi:[1,0]
    v_cvt_pk_bf16_f32 v52, v52, v53
    v_cvt_pk_bf16_f32 v53, v54, v55
    v_cvt_pk_bf16_f32 v54, v72, v73
    v_cvt_pk_bf16_f32 v55, v74, v75
    s_waitcnt lgkmcnt(14)
    ds_write_b128 v228, v[52:55] offset:23552
    v_pk_mul_f32 v[56:57], v[56:57], v[194:195] op_sel_hi:[1,0]
    v_pk_mul_f32 v[58:59], v[58:59], v[194:195] op_sel_hi:[1,0]
    v_pk_mul_f32 v[76:77], v[76:77], v[194:195] op_sel_hi:[1,0]
    v_pk_mul_f32 v[78:79], v[78:79], v[194:195] op_sel_hi:[1,0]
    v_cvt_pk_bf16_f32 v56, v56, v57
    v_cvt_pk_bf16_f32 v57, v58, v59
    v_cvt_pk_bf16_f32 v58, v76, v77
    v_cvt_pk_bf16_f32 v59, v78, v79
    s_waitcnt lgkmcnt(14)
    ds_write_b128 v228, v[56:59] offset:24576
    s_waitcnt lgkmcnt(0)
    s_barrier
    ds_read_b128 v[192:195], v224
    ds_read_b128 v[196:199], v224 offset:1024
    ds_read_b128 v[200:203], v224 offset:2048
    ds_read_b128 v[204:207], v224 offset:3072
    ds_read_b128 v[208:211], v224 offset:4096
    s_setprio 1
    s_waitcnt vmcnt(2)
    s_waitcnt lgkmcnt(4)
    v_mfma_f32_16x16x32_bf16 v[0:3], v[160:163], v[192:195], 0
    ds_read_b64_tr_b16 v[176:177], v233 offset:6144
    ds_read_b64_tr_b16 v[180:181], v234 offset:6144
    v_xor_b32 v238, 64, v237
    v_mfma_f32_16x16x32_bf16 v[20:23], v[164:167], v[192:195], 0
    ds_read_b64_tr_b16 v[184:185], v235 offset:6144
    ds_read_b64_tr_b16 v[188:189], v236 offset:6144
    v_xor_b32 v239, 128, v237
    v_mfma_f32_16x16x32_bf16 v[40:43], v[168:171], v[192:195], 0
    s_mov_b32 s77, 131072
    s_add_u32 m0, s76, 0
    s_nop 0
    buffer_load_dwordx4 v220, s[64:67], s77 offen nt lds
    buffer_load_dwordx4 v221, s[64:67], s77 offen offset:1024 nt lds
    v_xor_b32 v240, 192, v237
    v_mfma_f32_16x16x32_bf16 v[60:63], v[172:175], v[192:195], 0
    ds_read_b128 v[192:195], v224 offset:5120
    s_mov_b32 s77, 139264
    s_add_u32 m0, s76, 2048
    s_nop 0
    buffer_load_dwordx4 v220, s[64:67], s77 offen nt lds
    buffer_load_dwordx4 v221, s[64:67], s77 offen offset:1024 nt lds
    v_add_u32 v241, 61440, v237
    s_waitcnt lgkmcnt(8)
    v_mfma_f32_16x16x32_bf16 v[4:7], v[160:163], v[196:199], 0
    s_mov_b32 s77, 196608
    s_add_u32 m0, s76, 4096
    s_nop 0
    buffer_load_dwordx4 v220, s[64:67], s77 offen nt lds
    buffer_load_dwordx4 v221, s[64:67], s77 offen offset:1024 nt lds
    v_add_u32 v242, 61440, v238
    v_mfma_f32_16x16x32_bf16 v[24:27], v[164:167], v[196:199], 0
    s_waitcnt lgkmcnt(1)
    s_mov_b32 s77, 204800
    s_add_u32 m0, s76, 6144
    s_nop 0
    buffer_load_dwordx4 v220, s[64:67], s77 offen nt lds
    buffer_load_dwordx4 v221, s[64:67], s77 offen offset:1024 nt lds
    v_add_u32 v244, 130048, v243
    v_mfma_f32_16x16x32_bf16 v[44:47], v[168:171], v[196:199], 0
    v_add_u32 v246, 6144, v245
    v_mfma_f32_16x16x32_bf16 v[64:67], v[172:175], v[196:199], 0
    ds_read_b128 v[196:199], v224 offset:6144
    v_add_u32 v247, 40960, v230
    v_mfma_f32_16x16x32_bf16 v[8:11], v[160:163], v[200:203], 0
    v_mul_f32 v80, v80, v248
    v_mfma_f32_16x16x32_bf16 v[28:31], v[164:167], v[200:203], 0
    v_mul_f32 v81, v81, v248
    s_waitcnt vmcnt(8)
    v_mfma_f32_16x16x32_bf16 v[48:51], v[168:171], v[200:203], 0
    ds_read_b64_tr_b16 v[178:179], v233 offset:8192
    ds_read_b64_tr_b16 v[182:183], v234 offset:8192
    v_mul_f32 v82, v82, v248
    v_mfma_f32_16x16x32_bf16 v[68:71], v[172:175], v[200:203], 0
    ds_read_b64_tr_b16 v[186:187], v235 offset:8192
    ds_read_b64_tr_b16 v[190:191], v236 offset:8192
    ds_read_b128 v[200:203], v224 offset:7168
    v_mul_f32 v83, v83, v248
    v_mfma_f32_16x16x32_bf16 v[12:15], v[160:163], v[204:207], 0
    v_mul_f32 v100, v100, v248
    v_mfma_f32_16x16x32_bf16 v[32:35], v[164:167], v[204:207], 0
    v_mul_f32 v101, v101, v248
    v_mfma_f32_16x16x32_bf16 v[52:55], v[168:171], v[204:207], 0
    v_mul_f32 v102, v102, v248
    v_mfma_f32_16x16x32_bf16 v[72:75], v[172:175], v[204:207], 0
    ds_read_b128 v[204:207], v224 offset:8192
    s_waitcnt lgkmcnt(2)
    s_mov_b32 s77, 16384
    s_add_u32 m0, s76, 8192
    s_nop 0
    buffer_load_dwordx4 v220, s[64:67], s77 offen nt lds
    buffer_load_dwordx4 v221, s[64:67], s77 offen offset:1024 nt lds
    v_mul_f32 v103, v103, v248
    v_mfma_f32_16x16x32_bf16 v[16:19], v[160:163], v[208:211], 0
    v_cvt_pk_bf16_f32 v80, v80, v81
    v_mfma_f32_16x16x32_bf16 v[36:39], v[164:167], v[208:211], 0
    v_cvt_pk_bf16_f32 v81, v82, v83
    v_mfma_f32_16x16x32_bf16 v[56:59], v[168:171], v[208:211], 0
    v_cvt_pk_bf16_f32 v82, v100, v101
    v_mfma_f32_16x16x32_bf16 v[76:79], v[172:175], v[208:211], 0
    ds_read_b128 v[208:211], v224 offset:9216
    v_cvt_pk_bf16_f32 v83, v102, v103
    s_setprio 0
    s_waitcnt vmcnt(8)
    v_mfma_f32_16x16x32_bf16 v[0:3], v[176:179], v[192:195], v[0:3]
    ds_read_b64_tr_b16 v[160:161], v233
    ds_read_b64_tr_b16 v[164:165], v234
    v_mul_f32 v84, v84, v249
    v_mfma_f32_16x16x32_bf16 v[20:23], v[180:183], v[192:195], v[20:23]
    ds_read_b64_tr_b16 v[168:169], v235
    ds_read_b64_tr_b16 v[172:173], v236
    v_mul_f32 v85, v85, v249
    v_mfma_f32_16x16x32_bf16 v[40:43], v[184:187], v[192:195], v[40:43]
    v_mul_f32 v86, v86, v249
    v_mfma_f32_16x16x32_bf16 v[60:63], v[188:191], v[192:195], v[60:63]
    ds_read_b128 v[192:195], v224 offset:10240
    v_mul_f32 v87, v87, v249
    v_mfma_f32_16x16x32_bf16 v[4:7], v[176:179], v[196:199], v[4:7]
    v_mul_f32 v104, v104, v249
    v_mfma_f32_16x16x32_bf16 v[24:27], v[180:183], v[196:199], v[24:27]
    s_waitcnt lgkmcnt(1)
    s_mov_b32 s77, 24576
    s_add_u32 m0, s76, 0
    s_nop 0
    buffer_load_dwordx4 v220, s[64:67], s77 offen nt lds
    buffer_load_dwordx4 v221, s[64:67], s77 offen offset:1024 nt lds
    v_mul_f32 v105, v105, v249
    v_mfma_f32_16x16x32_bf16 v[44:47], v[184:187], v[196:199], v[44:47]
    v_mul_f32 v106, v106, v249
    v_mfma_f32_16x16x32_bf16 v[64:67], v[188:191], v[196:199], v[64:67]
    ds_read_b128 v[196:199], v224 offset:11264
    v_mul_f32 v107, v107, v249
    v_mfma_f32_16x16x32_bf16 v[8:11], v[176:179], v[200:203], v[8:11]
    v_cvt_pk_bf16_f32 v84, v84, v85
    v_mfma_f32_16x16x32_bf16 v[28:31], v[180:183], v[200:203], v[28:31]
    v_cvt_pk_bf16_f32 v85, v86, v87
    s_waitcnt vmcnt(8)
    v_mfma_f32_16x16x32_bf16 v[48:51], v[184:187], v[200:203], v[48:51]
    ds_read_b64_tr_b16 v[162:163], v233 offset:2048
    ds_read_b64_tr_b16 v[166:167], v234 offset:2048
    v_cvt_pk_bf16_f32 v86, v104, v105
    v_mfma_f32_16x16x32_bf16 v[68:71], v[188:191], v[200:203], v[68:71]
    ds_read_b64_tr_b16 v[170:171], v235 offset:2048
    ds_read_b64_tr_b16 v[174:175], v236 offset:2048
    ds_read_b128 v[200:203], v224 offset:12288
    v_cvt_pk_bf16_f32 v87, v106, v107
    v_mfma_f32_16x16x32_bf16 v[12:15], v[176:179], v[204:207], v[12:15]
    v_mul_f32 v88, v88, v250
    v_mfma_f32_16x16x32_bf16 v[32:35], v[180:183], v[204:207], v[32:35]
    v_mul_f32 v89, v89, v250
    v_mfma_f32_16x16x32_bf16 v[52:55], v[184:187], v[204:207], v[52:55]
    v_mul_f32 v90, v90, v250
    v_mfma_f32_16x16x32_bf16 v[72:75], v[188:191], v[204:207], v[72:75]
    ds_read_b128 v[204:207], v224 offset:13312
    s_waitcnt lgkmcnt(2)
    s_mov_b32 s77, 81920
    s_add_u32 m0, s76, 2048
    s_nop 0
    buffer_load_dwordx4 v220, s[64:67], s77 offen nt lds
    buffer_load_dwordx4 v221, s[64:67], s77 offen offset:1024 nt lds
    v_mul_f32 v91, v91, v250
    v_mfma_f32_16x16x32_bf16 v[16:19], v[176:179], v[208:211], v[16:19]
    v_mul_f32 v108, v108, v250
    v_mfma_f32_16x16x32_bf16 v[36:39], v[180:183], v[208:211], v[36:39]
    v_mul_f32 v109, v109, v250
    v_mfma_f32_16x16x32_bf16 v[56:59], v[184:187], v[208:211], v[56:59]
    v_mul_f32 v110, v110, v250
    v_mfma_f32_16x16x32_bf16 v[76:79], v[188:191], v[208:211], v[76:79]
    ds_read_b128 v[208:211], v224 offset:14336
    v_mul_f32 v111, v111, v250
    s_setprio 3
    s_waitcnt vmcnt(8)
    v_mfma_f32_16x16x32_bf16 v[0:3], v[160:163], v[192:195], v[0:3]
    ds_read_b64_tr_b16 v[176:177], v233 offset:4096
    ds_read_b64_tr_b16 v[180:181], v234 offset:4096
    v_cvt_pk_bf16_f32 v88, v88, v89
    v_mfma_f32_16x16x32_bf16 v[20:23], v[164:167], v[192:195], v[20:23]
    ds_read_b64_tr_b16 v[184:185], v235 offset:4096
    ds_read_b64_tr_b16 v[188:189], v236 offset:4096
    v_cvt_pk_bf16_f32 v89, v90, v91
    v_mfma_f32_16x16x32_bf16 v[40:43], v[168:171], v[192:195], v[40:43]
    v_cvt_pk_bf16_f32 v90, v108, v109
    v_mfma_f32_16x16x32_bf16 v[60:63], v[172:175], v[192:195], v[60:63]
    ds_read_b128 v[192:195], v224 offset:15360
    v_cvt_pk_bf16_f32 v91, v110, v111
    v_mfma_f32_16x16x32_bf16 v[4:7], v[160:163], v[196:199], v[4:7]
    v_mul_f32 v92, v92, v251
    v_mfma_f32_16x16x32_bf16 v[24:27], v[164:167], v[196:199], v[24:27]
    s_waitcnt lgkmcnt(1)
    s_mov_b32 s77, 90112
    s_add_u32 m0, s76, 4096
    s_nop 0
    buffer_load_dwordx4 v220, s[64:67], s77 offen nt lds
    buffer_load_dwordx4 v221, s[64:67], s77 offen offset:1024 nt lds
    v_mul_f32 v93, v93, v251
    v_mfma_f32_16x16x32_bf16 v[44:47], v[168:171], v[196:199], v[44:47]
    v_mul_f32 v94, v94, v251
    v_mfma_f32_16x16x32_bf16 v[64:67], v[172:175], v[196:199], v[64:67]
    ds_read_b128 v[196:199], v224 offset:16384
    v_mul_f32 v95, v95, v251
    v_mfma_f32_16x16x32_bf16 v[8:11], v[160:163], v[200:203], v[8:11]
    v_mul_f32 v112, v112, v251
    v_mfma_f32_16x16x32_bf16 v[28:31], v[164:167], v[200:203], v[28:31]
    v_mul_f32 v113, v113, v251
    s_waitcnt vmcnt(8)
    v_mfma_f32_16x16x32_bf16 v[48:51], v[168:171], v[200:203], v[48:51]
    ds_read_b64_tr_b16 v[178:179], v233 offset:6144
    ds_read_b64_tr_b16 v[182:183], v234 offset:6144
    v_mul_f32 v114, v114, v251
    v_mfma_f32_16x16x32_bf16 v[68:71], v[172:175], v[200:203], v[68:71]
    ds_read_b64_tr_b16 v[186:187], v235 offset:6144
    ds_read_b64_tr_b16 v[190:191], v236 offset:6144
    ds_read_b128 v[200:203], v224 offset:17408
    v_mul_f32 v115, v115, v251
    v_mfma_f32_16x16x32_bf16 v[12:15], v[160:163], v[204:207], v[12:15]
    v_cvt_pk_bf16_f32 v92, v92, v93
    v_mfma_f32_16x16x32_bf16 v[32:35], v[164:167], v[204:207], v[32:35]
    v_cvt_pk_bf16_f32 v93, v94, v95
    v_mfma_f32_16x16x32_bf16 v[52:55], v[168:171], v[204:207], v[52:55]
    v_cvt_pk_bf16_f32 v94, v112, v113
    v_mfma_f32_16x16x32_bf16 v[72:75], v[172:175], v[204:207], v[72:75]
    ds_read_b128 v[204:207], v224 offset:18432
    s_waitcnt lgkmcnt(2)
    s_mov_b32 s77, 147456
    s_add_u32 m0, s76, 6144
    s_nop 0
    buffer_load_dwordx4 v220, s[64:67], s77 offen nt lds
    buffer_load_dwordx4 v221, s[64:67], s77 offen offset:1024 nt lds
    v_cvt_pk_bf16_f32 v95, v114, v115
    v_mfma_f32_16x16x32_bf16 v[16:19], v[160:163], v[208:211], v[16:19]
    v_mul_f32 v96, v96, v252
    v_mfma_f32_16x16x32_bf16 v[36:39], v[164:167], v[208:211], v[36:39]
    v_mul_f32 v97, v97, v252
    v_mfma_f32_16x16x32_bf16 v[56:59], v[168:171], v[208:211], v[56:59]
    v_mul_f32 v98, v98, v252
    v_mfma_f32_16x16x32_bf16 v[76:79], v[172:175], v[208:211], v[76:79]
    ds_read_b128 v[208:211], v224 offset:19456
    v_mul_f32 v99, v99, v252
    s_setprio 2
    s_waitcnt vmcnt(8)
    v_mfma_f32_16x16x32_bf16 v[0:3], v[176:179], v[192:195], v[0:3]
    ds_read_b64_tr_b16 v[160:161], v233 offset:8192
    ds_read_b64_tr_b16 v[164:165], v234 offset:8192
    v_mul_f32 v116, v116, v252
    v_mfma_f32_16x16x32_bf16 v[20:23], v[180:183], v[192:195], v[20:23]
    ds_read_b64_tr_b16 v[168:169], v235 offset:8192
    ds_read_b64_tr_b16 v[172:173], v236 offset:8192
    v_mul_f32 v117, v117, v252
    v_mfma_f32_16x16x32_bf16 v[40:43], v[184:187], v[192:195], v[40:43]
    v_mul_f32 v118, v118, v252
    v_mfma_f32_16x16x32_bf16 v[60:63], v[188:191], v[192:195], v[60:63]
    ds_read_b128 v[192:195], v224 offset:20480
    v_mul_f32 v119, v119, v252
    v_mfma_f32_16x16x32_bf16 v[4:7], v[176:179], v[196:199], v[4:7]
    v_cvt_pk_bf16_f32 v96, v96, v97
    v_mfma_f32_16x16x32_bf16 v[24:27], v[180:183], v[196:199], v[24:27]
    s_waitcnt lgkmcnt(1)
    s_mov_b32 s77, 155648
    s_add_u32 m0, s76, 8192
    s_nop 0
    buffer_load_dwordx4 v220, s[64:67], s77 offen nt lds
    buffer_load_dwordx4 v221, s[64:67], s77 offen offset:1024 nt lds
    v_cvt_pk_bf16_f32 v97, v98, v99
    v_mfma_f32_16x16x32_bf16 v[44:47], v[184:187], v[196:199], v[44:47]
    v_cvt_pk_bf16_f32 v98, v116, v117
    v_mfma_f32_16x16x32_bf16 v[64:67], v[188:191], v[196:199], v[64:67]
    ds_read_b128 v[196:199], v224 offset:21504
    v_cvt_pk_bf16_f32 v99, v118, v119
    v_mfma_f32_16x16x32_bf16 v[8:11], v[176:179], v[200:203], v[8:11]
    v_mfma_f32_16x16x32_bf16 v[28:31], v[180:183], v[200:203], v[28:31]
    s_waitcnt vmcnt(8)
    v_mfma_f32_16x16x32_bf16 v[48:51], v[184:187], v[200:203], v[48:51]
    ds_read_b64_tr_b16 v[162:163], v233
    ds_read_b64_tr_b16 v[166:167], v234
    v_mfma_f32_16x16x32_bf16 v[68:71], v[188:191], v[200:203], v[68:71]
    ds_read_b64_tr_b16 v[170:171], v235
    ds_read_b64_tr_b16 v[174:175], v236
    ds_read_b128 v[200:203], v224 offset:22528
    v_mfma_f32_16x16x32_bf16 v[12:15], v[176:179], v[204:207], v[12:15]
    v_mfma_f32_16x16x32_bf16 v[32:35], v[180:183], v[204:207], v[32:35]
    v_mfma_f32_16x16x32_bf16 v[52:55], v[184:187], v[204:207], v[52:55]
    v_mfma_f32_16x16x32_bf16 v[72:75], v[188:191], v[204:207], v[72:75]
    ds_read_b128 v[204:207], v224 offset:23552
    s_waitcnt lgkmcnt(2)
    s_mov_b32 s77, 212992
    s_add_u32 m0, s76, 0
    s_nop 0
    buffer_load_dwordx4 v220, s[64:67], s77 offen nt lds
    buffer_load_dwordx4 v221, s[64:67], s77 offen offset:1024 nt lds
    v_mfma_f32_16x16x32_bf16 v[16:19], v[176:179], v[208:211], v[16:19]
    v_mfma_f32_16x16x32_bf16 v[36:39], v[180:183], v[208:211], v[36:39]
    v_mfma_f32_16x16x32_bf16 v[56:59], v[184:187], v[208:211], v[56:59]
    v_mfma_f32_16x16x32_bf16 v[76:79], v[188:191], v[208:211], v[76:79]
    ds_read_b128 v[208:211], v224 offset:24576
    s_setprio 1
    s_waitcnt vmcnt(8)
    s_barrier
    v_mfma_f32_16x16x32_bf16 v[0:3], v[160:163], v[192:195], v[0:3]
    ds_read_b64_tr_b16 v[176:177], v233 offset:2048
    ds_read_b64_tr_b16 v[180:181], v234 offset:2048
    v_mul_f32 v120, v120, v248
    v_mfma_f32_16x16x32_bf16 v[20:23], v[164:167], v[192:195], v[20:23]
    ds_read_b64_tr_b16 v[184:185], v235 offset:2048
    ds_read_b64_tr_b16 v[188:189], v236 offset:2048
    v_mul_f32 v121, v121, v248
    v_mfma_f32_16x16x32_bf16 v[40:43], v[168:171], v[192:195], v[40:43]
    v_mul_f32 v122, v122, v248
    v_mfma_f32_16x16x32_bf16 v[60:63], v[172:175], v[192:195], v[60:63]
    ds_read_b128 v[192:195], v224 offset:25600
    v_mul_f32 v123, v123, v248
    v_mfma_f32_16x16x32_bf16 v[4:7], v[160:163], v[196:199], v[4:7]
    v_mul_f32 v140, v140, v248
    v_mfma_f32_16x16x32_bf16 v[24:27], v[164:167], v[196:199], v[24:27]
    s_waitcnt lgkmcnt(1)
    s_mov_b32 s77, 221184
    s_add_u32 m0, s76, 2048
    s_nop 0
    buffer_load_dwordx4 v220, s[64:67], s77 offen nt lds
    buffer_load_dwordx4 v221, s[64:67], s77 offen offset:1024 nt lds
    v_mul_f32 v141, v141, v248
    v_mfma_f32_16x16x32_bf16 v[44:47], v[168:171], v[196:199], v[44:47]
    v_mul_f32 v142, v142, v248
    v_mfma_f32_16x16x32_bf16 v[64:67], v[172:175], v[196:199], v[64:67]
    ds_read_b128 v[196:199], v224 offset:26624
    v_mul_f32 v143, v143, v248
    v_mfma_f32_16x16x32_bf16 v[8:11], v[160:163], v[200:203], v[8:11]
    ds_write_b128 v228, v[80:83]
    v_cvt_pk_bf16_f32 v120, v120, v121
    v_mfma_f32_16x16x32_bf16 v[28:31], v[164:167], v[200:203], v[28:31]
    v_cvt_pk_bf16_f32 v121, v122, v123
    s_waitcnt vmcnt(8)
    v_mfma_f32_16x16x32_bf16 v[48:51], v[168:171], v[200:203], v[48:51]
    ds_read_b64_tr_b16 v[178:179], v233 offset:4096
    ds_read_b64_tr_b16 v[182:183], v234 offset:4096
    v_cvt_pk_bf16_f32 v122, v140, v141
    v_mfma_f32_16x16x32_bf16 v[68:71], v[172:175], v[200:203], v[68:71]
    ds_read_b64_tr_b16 v[186:187], v235 offset:4096
    ds_read_b64_tr_b16 v[190:191], v236 offset:4096
    ds_read_b128 v[200:203], v224 offset:27648
    v_cvt_pk_bf16_f32 v123, v142, v143
    v_mfma_f32_16x16x32_bf16 v[12:15], v[160:163], v[204:207], v[12:15]
    v_mul_f32 v124, v124, v249
    v_mfma_f32_16x16x32_bf16 v[32:35], v[164:167], v[204:207], v[32:35]
    v_mul_f32 v125, v125, v249
    v_mfma_f32_16x16x32_bf16 v[52:55], v[168:171], v[204:207], v[52:55]
    v_mul_f32 v126, v126, v249
    v_mfma_f32_16x16x32_bf16 v[72:75], v[172:175], v[204:207], v[72:75]
    ds_read_b128 v[204:207], v224 offset:28672
    s_waitcnt lgkmcnt(2)
    s_mov_b32 s77, 32768
    s_add_u32 m0, s76, 4096
    s_nop 0
    buffer_load_dwordx4 v220, s[64:67], s77 offen nt lds
    buffer_load_dwordx4 v221, s[64:67], s77 offen offset:1024 nt lds
    v_mul_f32 v127, v127, v249
    v_mfma_f32_16x16x32_bf16 v[16:19], v[160:163], v[208:211], v[16:19]
    v_mul_f32 v144, v144, v249
    v_mfma_f32_16x16x32_bf16 v[36:39], v[164:167], v[208:211], v[36:39]
    v_mul_f32 v145, v145, v249
    v_mfma_f32_16x16x32_bf16 v[56:59], v[168:171], v[208:211], v[56:59]
    ds_write_b128 v228, v[84:87] offset:1024
    v_mul_f32 v146, v146, v249
    v_mfma_f32_16x16x32_bf16 v[76:79], v[172:175], v[208:211], v[76:79]
    ds_read_b128 v[208:211], v224 offset:29696
    v_mul_f32 v147, v147, v249
    s_setprio 0
    s_waitcnt vmcnt(8)
    v_mfma_f32_16x16x32_bf16 v[0:3], v[176:179], v[192:195], v[0:3]
    ds_read_b64_tr_b16 v[160:161], v233 offset:6144
    ds_read_b64_tr_b16 v[164:165], v234 offset:6144
    v_cvt_pk_bf16_f32 v124, v124, v125
    v_mfma_f32_16x16x32_bf16 v[20:23], v[180:183], v[192:195], v[20:23]
    ds_read_b64_tr_b16 v[168:169], v235 offset:6144
    ds_read_b64_tr_b16 v[172:173], v236 offset:6144
    v_cvt_pk_bf16_f32 v125, v126, v127
    v_mfma_f32_16x16x32_bf16 v[40:43], v[184:187], v[192:195], v[40:43]
    v_cvt_pk_bf16_f32 v126, v144, v145
    v_mfma_f32_16x16x32_bf16 v[60:63], v[188:191], v[192:195], v[60:63]
    ds_read_b128 v[192:195], v224 offset:30720
    v_cvt_pk_bf16_f32 v127, v146, v147
    v_mfma_f32_16x16x32_bf16 v[4:7], v[176:179], v[196:199], v[4:7]
    v_mul_f32 v128, v128, v250
    v_mfma_f32_16x16x32_bf16 v[24:27], v[180:183], v[196:199], v[24:27]
    s_waitcnt lgkmcnt(1)
    s_mov_b32 s77, 40960
    s_add_u32 m0, s76, 6144
    s_nop 0
    buffer_load_dwordx4 v220, s[64:67], s77 offen nt lds
    buffer_load_dwordx4 v221, s[64:67], s77 offen offset:1024 nt lds
    v_mul_f32 v129, v129, v250
    v_mfma_f32_16x16x32_bf16 v[44:47], v[184:187], v[196:199], v[44:47]
    v_mul_f32 v130, v130, v250
    v_mfma_f32_16x16x32_bf16 v[64:67], v[188:191], v[196:199], v[64:67]
    ds_read_b128 v[196:199], v224 offset:31744
    v_mul_f32 v131, v131, v250
    v_mfma_f32_16x16x32_bf16 v[8:11], v[176:179], v[200:203], v[8:11]
    ds_write_b128 v228, v[88:91] offset:2048
    v_mul_f32 v148, v148, v250
    v_mfma_f32_16x16x32_bf16 v[28:31], v[180:183], v[200:203], v[28:31]
    v_mul_f32 v149, v149, v250
    s_waitcnt vmcnt(8)
    v_mfma_f32_16x16x32_bf16 v[48:51], v[184:187], v[200:203], v[48:51]
    ds_read_b64_tr_b16 v[162:163], v233 offset:8192
    ds_read_b64_tr_b16 v[166:167], v234 offset:8192
    v_mul_f32 v150, v150, v250
    v_mfma_f32_16x16x32_bf16 v[68:71], v[188:191], v[200:203], v[68:71]
    ds_read_b64_tr_b16 v[170:171], v235 offset:8192
    ds_read_b64_tr_b16 v[174:175], v236 offset:8192
    ds_read_b128 v[200:203], v224 offset:32768
    v_mul_f32 v151, v151, v250
    v_mfma_f32_16x16x32_bf16 v[12:15], v[176:179], v[204:207], v[12:15]
    v_cvt_pk_bf16_f32 v128, v128, v129
    v_mfma_f32_16x16x32_bf16 v[32:35], v[180:183], v[204:207], v[32:35]
    v_cvt_pk_bf16_f32 v129, v130, v131
    v_mfma_f32_16x16x32_bf16 v[52:55], v[184:187], v[204:207], v[52:55]
    v_cvt_pk_bf16_f32 v130, v148, v149
    v_mfma_f32_16x16x32_bf16 v[72:75], v[188:191], v[204:207], v[72:75]
    ds_read_b128 v[204:207], v224 offset:33792
    s_waitcnt lgkmcnt(2)
    s_mov_b32 s77, 98304
    s_add_u32 m0, s76, 8192
    s_nop 0
    buffer_load_dwordx4 v220, s[64:67], s77 offen nt lds
    buffer_load_dwordx4 v221, s[64:67], s77 offen offset:1024 nt lds
    v_cvt_pk_bf16_f32 v131, v150, v151
    v_mfma_f32_16x16x32_bf16 v[16:19], v[176:179], v[208:211], v[16:19]
    v_mul_f32 v132, v132, v251
    v_mfma_f32_16x16x32_bf16 v[36:39], v[180:183], v[208:211], v[36:39]
    v_mul_f32 v133, v133, v251
    v_mfma_f32_16x16x32_bf16 v[56:59], v[184:187], v[208:211], v[56:59]
    ds_write_b128 v228, v[92:95] offset:3072
    v_mul_f32 v134, v134, v251
    v_mfma_f32_16x16x32_bf16 v[76:79], v[188:191], v[208:211], v[76:79]
    ds_read_b128 v[208:211], v224 offset:34816
    v_mul_f32 v135, v135, v251
    s_setprio 3
    s_waitcnt vmcnt(8)
    v_mfma_f32_16x16x32_bf16 v[0:3], v[160:163], v[192:195], v[0:3]
    ds_read_b64_tr_b16 v[176:177], v233
    ds_read_b64_tr_b16 v[180:181], v234
    v_mul_f32 v152, v152, v251
    v_mfma_f32_16x16x32_bf16 v[20:23], v[164:167], v[192:195], v[20:23]
    ds_read_b64_tr_b16 v[184:185], v235
    ds_read_b64_tr_b16 v[188:189], v236
    v_mul_f32 v153, v153, v251
    v_mfma_f32_16x16x32_bf16 v[40:43], v[168:171], v[192:195], v[40:43]
    v_mul_f32 v154, v154, v251
    v_mfma_f32_16x16x32_bf16 v[60:63], v[172:175], v[192:195], v[60:63]
    ds_read_b128 v[192:195], v224 offset:35840
    v_mul_f32 v155, v155, v251
    v_mfma_f32_16x16x32_bf16 v[4:7], v[160:163], v[196:199], v[4:7]
    v_cvt_pk_bf16_f32 v132, v132, v133
    v_mfma_f32_16x16x32_bf16 v[24:27], v[164:167], v[196:199], v[24:27]
    s_waitcnt lgkmcnt(1)
    s_mov_b32 s77, 106496
    s_add_u32 m0, s76, 0
    s_nop 0
    buffer_load_dwordx4 v220, s[64:67], s77 offen nt lds
    buffer_load_dwordx4 v221, s[64:67], s77 offen offset:1024 nt lds
    v_cvt_pk_bf16_f32 v133, v134, v135
    v_mfma_f32_16x16x32_bf16 v[44:47], v[168:171], v[196:199], v[44:47]
    v_cvt_pk_bf16_f32 v134, v152, v153
    v_mfma_f32_16x16x32_bf16 v[64:67], v[172:175], v[196:199], v[64:67]
    ds_read_b128 v[196:199], v224 offset:36864
    v_cvt_pk_bf16_f32 v135, v154, v155
    v_mfma_f32_16x16x32_bf16 v[8:11], v[160:163], v[200:203], v[8:11]
    ds_write_b128 v228, v[96:99] offset:4096
    v_mul_f32 v136, v136, v252
    v_mfma_f32_16x16x32_bf16 v[28:31], v[164:167], v[200:203], v[28:31]
    v_mul_f32 v137, v137, v252
    s_waitcnt vmcnt(8)
    v_mfma_f32_16x16x32_bf16 v[48:51], v[168:171], v[200:203], v[48:51]
    ds_read_b64_tr_b16 v[178:179], v233 offset:2048
    ds_read_b64_tr_b16 v[182:183], v234 offset:2048
    v_mul_f32 v138, v138, v252
    v_mfma_f32_16x16x32_bf16 v[68:71], v[172:175], v[200:203], v[68:71]
    ds_read_b64_tr_b16 v[186:187], v235 offset:2048
    ds_read_b64_tr_b16 v[190:191], v236 offset:2048
    ds_read_b128 v[200:203], v224 offset:37888
    v_mul_f32 v139, v139, v252
    v_mfma_f32_16x16x32_bf16 v[12:15], v[160:163], v[204:207], v[12:15]
    v_mul_f32 v156, v156, v252
    v_mfma_f32_16x16x32_bf16 v[32:35], v[164:167], v[204:207], v[32:35]
    v_mul_f32 v157, v157, v252
    v_mfma_f32_16x16x32_bf16 v[52:55], v[168:171], v[204:207], v[52:55]
    v_mul_f32 v158, v158, v252
    v_mfma_f32_16x16x32_bf16 v[72:75], v[172:175], v[204:207], v[72:75]
    ds_read_b128 v[204:207], v224 offset:38912
    s_waitcnt lgkmcnt(2)
    s_mov_b32 s77, 163840
    s_add_u32 m0, s76, 2048
    s_nop 0
    buffer_load_dwordx4 v220, s[64:67], s77 offen nt lds
    buffer_load_dwordx4 v221, s[64:67], s77 offen offset:1024 nt lds
    v_mul_f32 v159, v159, v252
    v_mfma_f32_16x16x32_bf16 v[16:19], v[160:163], v[208:211], v[16:19]
    v_cvt_pk_bf16_f32 v136, v136, v137
    v_mfma_f32_16x16x32_bf16 v[36:39], v[164:167], v[208:211], v[36:39]
    v_cvt_pk_bf16_f32 v137, v138, v139
    v_mfma_f32_16x16x32_bf16 v[56:59], v[168:171], v[208:211], v[56:59]
    v_cvt_pk_bf16_f32 v138, v156, v157
    v_mfma_f32_16x16x32_bf16 v[76:79], v[172:175], v[208:211], v[76:79]
    ds_read_b128 v[208:211], v224 offset:39936
    v_cvt_pk_bf16_f32 v139, v158, v159
    s_setprio 2
    s_waitcnt vmcnt(8)
    s_barrier
    v_mfma_f32_16x16x32_bf16 v[0:3], v[176:179], v[192:195], v[0:3]
    ds_read_b64_tr_b16 v[160:161], v233 offset:4096
    ds_read_b64_tr_b16 v[164:165], v234 offset:4096
    v_mfma_f32_16x16x32_bf16 v[20:23], v[180:183], v[192:195], v[20:23]
    ds_read_b64_tr_b16 v[168:169], v235 offset:4096
    ds_read_b64_tr_b16 v[172:173], v236 offset:4096
    v_mfma_f32_16x16x32_bf16 v[40:43], v[184:187], v[192:195], v[40:43]
    v_mfma_f32_16x16x32_bf16 v[60:63], v[188:191], v[192:195], v[60:63]
    ds_read_b128 v[192:195], v224
    v_mfma_f32_16x16x32_bf16 v[4:7], v[176:179], v[196:199], v[4:7]
    v_mfma_f32_16x16x32_bf16 v[24:27], v[180:183], v[196:199], v[24:27]
    s_waitcnt lgkmcnt(1)
    s_mov_b32 s77, 172032
    s_add_u32 m0, s76, 4096
    s_nop 0
    buffer_load_dwordx4 v220, s[64:67], s77 offen nt lds
    buffer_load_dwordx4 v221, s[64:67], s77 offen offset:1024 nt lds
    v_mfma_f32_16x16x32_bf16 v[44:47], v[184:187], v[196:199], v[44:47]
    v_mfma_f32_16x16x32_bf16 v[64:67], v[188:191], v[196:199], v[64:67]
    ds_read_b128 v[196:199], v224 offset:1024
    v_mfma_f32_16x16x32_bf16 v[8:11], v[176:179], v[200:203], v[8:11]
    v_mfma_f32_16x16x32_bf16 v[28:31], v[180:183], v[200:203], v[28:31]
    s_waitcnt vmcnt(8)
    v_mfma_f32_16x16x32_bf16 v[48:51], v[184:187], v[200:203], v[48:51]
    ds_read_b64_tr_b16 v[162:163], v233 offset:6144
    ds_read_b64_tr_b16 v[166:167], v234 offset:6144
    v_mfma_f32_16x16x32_bf16 v[68:71], v[188:191], v[200:203], v[68:71]
    ds_read_b64_tr_b16 v[170:171], v235 offset:6144
    ds_read_b64_tr_b16 v[174:175], v236 offset:6144
    ds_read_b128 v[200:203], v224 offset:2048
    v_mfma_f32_16x16x32_bf16 v[12:15], v[176:179], v[204:207], v[12:15]
    v_mfma_f32_16x16x32_bf16 v[32:35], v[180:183], v[204:207], v[32:35]
    v_mfma_f32_16x16x32_bf16 v[52:55], v[184:187], v[204:207], v[52:55]
    v_mfma_f32_16x16x32_bf16 v[72:75], v[188:191], v[204:207], v[72:75]
    ds_read_b128 v[204:207], v224 offset:3072
    s_waitcnt lgkmcnt(2)
    s_mov_b32 s77, 229376
    s_add_u32 m0, s76, 6144
    s_nop 0
    buffer_load_dwordx4 v220, s[64:67], s77 offen nt lds
    buffer_load_dwordx4 v221, s[64:67], s77 offen offset:1024 nt lds
    v_mfma_f32_16x16x32_bf16 v[16:19], v[176:179], v[208:211], v[16:19]
    v_mfma_f32_16x16x32_bf16 v[36:39], v[180:183], v[208:211], v[36:39]
    v_mfma_f32_16x16x32_bf16 v[56:59], v[184:187], v[208:211], v[56:59]
    v_mfma_f32_16x16x32_bf16 v[76:79], v[188:191], v[208:211], v[76:79]
    ds_read_b128 v[208:211], v224 offset:4096
    s_setprio 1
    s_waitcnt vmcnt(8)
    s_barrier
    v_mfma_f32_16x16x32_bf16 v[0:3], v[160:163], v[192:195], v[0:3]
    ds_read_b64_tr_b16 v[176:177], v233 offset:8192
    ds_read_b64_tr_b16 v[180:181], v234 offset:8192
    v_mfma_f32_16x16x32_bf16 v[20:23], v[164:167], v[192:195], v[20:23]
    ds_read_b64_tr_b16 v[184:185], v235 offset:8192
    ds_read_b64_tr_b16 v[188:189], v236 offset:8192
    v_mfma_f32_16x16x32_bf16 v[40:43], v[168:171], v[192:195], v[40:43]
    v_mfma_f32_16x16x32_bf16 v[60:63], v[172:175], v[192:195], v[60:63]
    ds_read_b128 v[192:195], v224 offset:5120
    v_mfma_f32_16x16x32_bf16 v[4:7], v[160:163], v[196:199], v[4:7]
    v_mfma_f32_16x16x32_bf16 v[24:27], v[164:167], v[196:199], v[24:27]
    s_waitcnt lgkmcnt(1)
    s_mov_b32 s77, 237568
    s_add_u32 m0, s76, 8192
    s_nop 0
    buffer_load_dwordx4 v220, s[64:67], s77 offen nt lds
    buffer_load_dwordx4 v221, s[64:67], s77 offen offset:1024 nt lds
    v_mfma_f32_16x16x32_bf16 v[44:47], v[168:171], v[196:199], v[44:47]
    v_mfma_f32_16x16x32_bf16 v[64:67], v[172:175], v[196:199], v[64:67]
    ds_read_b128 v[196:199], v224 offset:6144
    v_mfma_f32_16x16x32_bf16 v[8:11], v[160:163], v[200:203], v[8:11]
    ds_write_b128 v228, v[120:123] offset:20480
    v_mfma_f32_16x16x32_bf16 v[28:31], v[164:167], v[200:203], v[28:31]
    s_waitcnt vmcnt(8)
    v_mfma_f32_16x16x32_bf16 v[48:51], v[168:171], v[200:203], v[48:51]
    ds_read_b64_tr_b16 v[178:179], v233
    ds_read_b64_tr_b16 v[182:183], v234
    v_mfma_f32_16x16x32_bf16 v[68:71], v[172:175], v[200:203], v[68:71]
    ds_read_b64_tr_b16 v[186:187], v235
    ds_read_b64_tr_b16 v[190:191], v236
    ds_read_b128 v[200:203], v224 offset:7168
    v_mfma_f32_16x16x32_bf16 v[12:15], v[160:163], v[204:207], v[12:15]
    v_mfma_f32_16x16x32_bf16 v[32:35], v[164:167], v[204:207], v[32:35]
    v_mfma_f32_16x16x32_bf16 v[52:55], v[168:171], v[204:207], v[52:55]
    v_mfma_f32_16x16x32_bf16 v[72:75], v[172:175], v[204:207], v[72:75]
    ds_read_b128 v[204:207], v224 offset:8192
    s_waitcnt lgkmcnt(2)
    s_mov_b32 s77, 49152
    s_add_u32 m0, s76, 0
    s_nop 0
    buffer_load_dwordx4 v220, s[64:67], s77 offen nt lds
    buffer_load_dwordx4 v221, s[64:67], s77 offen offset:1024 nt lds
    v_mfma_f32_16x16x32_bf16 v[16:19], v[160:163], v[208:211], v[16:19]
    v_mfma_f32_16x16x32_bf16 v[36:39], v[164:167], v[208:211], v[36:39]
    v_mfma_f32_16x16x32_bf16 v[56:59], v[168:171], v[208:211], v[56:59]
    ds_write_b128 v228, v[124:127] offset:21504
    v_mfma_f32_16x16x32_bf16 v[76:79], v[172:175], v[208:211], v[76:79]
    ds_read_b128 v[208:211], v224 offset:9216
    s_setprio 0
    s_waitcnt vmcnt(8)
    v_mfma_f32_16x16x32_bf16 v[0:3], v[176:179], v[192:195], v[0:3]
    ds_read_b64_tr_b16 v[160:161], v233 offset:2048
    ds_read_b64_tr_b16 v[164:165], v234 offset:2048
    v_mfma_f32_16x16x32_bf16 v[20:23], v[180:183], v[192:195], v[20:23]
    ds_read_b64_tr_b16 v[168:169], v235 offset:2048
    ds_read_b64_tr_b16 v[172:173], v236 offset:2048
    v_mfma_f32_16x16x32_bf16 v[40:43], v[184:187], v[192:195], v[40:43]
    v_mfma_f32_16x16x32_bf16 v[60:63], v[188:191], v[192:195], v[60:63]
    ds_read_b128 v[192:195], v224 offset:10240
    v_mfma_f32_16x16x32_bf16 v[4:7], v[176:179], v[196:199], v[4:7]
    v_mfma_f32_16x16x32_bf16 v[24:27], v[180:183], v[196:199], v[24:27]
    s_waitcnt lgkmcnt(1)
    s_mov_b32 s77, 57344
    s_add_u32 m0, s76, 2048
    s_nop 0
    buffer_load_dwordx4 v220, s[64:67], s77 offen nt lds
    buffer_load_dwordx4 v221, s[64:67], s77 offen offset:1024 nt lds
    v_mfma_f32_16x16x32_bf16 v[44:47], v[184:187], v[196:199], v[44:47]
    v_mfma_f32_16x16x32_bf16 v[64:67], v[188:191], v[196:199], v[64:67]
    ds_read_b128 v[196:199], v224 offset:11264
    v_mfma_f32_16x16x32_bf16 v[8:11], v[176:179], v[200:203], v[8:11]
    ds_write_b128 v228, v[128:131] offset:22528
    v_mfma_f32_16x16x32_bf16 v[28:31], v[180:183], v[200:203], v[28:31]
    s_waitcnt vmcnt(8)
    v_mfma_f32_16x16x32_bf16 v[48:51], v[184:187], v[200:203], v[48:51]
    ds_read_b64_tr_b16 v[162:163], v233 offset:4096
    ds_read_b64_tr_b16 v[166:167], v234 offset:4096
    v_mfma_f32_16x16x32_bf16 v[68:71], v[188:191], v[200:203], v[68:71]
    ds_read_b64_tr_b16 v[170:171], v235 offset:4096
    ds_read_b64_tr_b16 v[174:175], v236 offset:4096
    ds_read_b128 v[200:203], v224 offset:12288
    v_mfma_f32_16x16x32_bf16 v[12:15], v[176:179], v[204:207], v[12:15]
    v_mfma_f32_16x16x32_bf16 v[32:35], v[180:183], v[204:207], v[32:35]
    v_mfma_f32_16x16x32_bf16 v[52:55], v[184:187], v[204:207], v[52:55]
    v_mfma_f32_16x16x32_bf16 v[72:75], v[188:191], v[204:207], v[72:75]
    ds_read_b128 v[204:207], v224 offset:13312
    s_waitcnt lgkmcnt(2)
    s_mov_b32 s77, 114688
    s_add_u32 m0, s76, 4096
    s_nop 0
    buffer_load_dwordx4 v220, s[64:67], s77 offen nt lds
    buffer_load_dwordx4 v221, s[64:67], s77 offen offset:1024 nt lds
    v_mfma_f32_16x16x32_bf16 v[16:19], v[176:179], v[208:211], v[16:19]
    v_mfma_f32_16x16x32_bf16 v[36:39], v[180:183], v[208:211], v[36:39]
    v_mfma_f32_16x16x32_bf16 v[56:59], v[184:187], v[208:211], v[56:59]
    ds_write_b128 v228, v[132:135] offset:23552
    v_mfma_f32_16x16x32_bf16 v[76:79], v[188:191], v[208:211], v[76:79]
    ds_read_b128 v[208:211], v224 offset:14336
    s_setprio 3
    s_waitcnt vmcnt(8)
    v_mfma_f32_16x16x32_bf16 v[0:3], v[160:163], v[192:195], v[0:3]
    ds_read_b64_tr_b16 v[176:177], v233 offset:6144
    ds_read_b64_tr_b16 v[180:181], v234 offset:6144
    v_mfma_f32_16x16x32_bf16 v[20:23], v[164:167], v[192:195], v[20:23]
    ds_read_b64_tr_b16 v[184:185], v235 offset:6144
    ds_read_b64_tr_b16 v[188:189], v236 offset:6144
    v_mfma_f32_16x16x32_bf16 v[40:43], v[168:171], v[192:195], v[40:43]
    v_mfma_f32_16x16x32_bf16 v[60:63], v[172:175], v[192:195], v[60:63]
    ds_read_b128 v[192:195], v224 offset:15360
    v_mfma_f32_16x16x32_bf16 v[4:7], v[160:163], v[196:199], v[4:7]
    v_mfma_f32_16x16x32_bf16 v[24:27], v[164:167], v[196:199], v[24:27]
    s_waitcnt lgkmcnt(1)
    s_mov_b32 s77, 122880
    s_add_u32 m0, s76, 6144
    s_nop 0
    buffer_load_dwordx4 v220, s[64:67], s77 offen nt lds
    buffer_load_dwordx4 v221, s[64:67], s77 offen offset:1024 nt lds
    v_mfma_f32_16x16x32_bf16 v[44:47], v[168:171], v[196:199], v[44:47]
    v_mfma_f32_16x16x32_bf16 v[64:67], v[172:175], v[196:199], v[64:67]
    ds_read_b128 v[196:199], v224 offset:16384
    v_mfma_f32_16x16x32_bf16 v[8:11], v[160:163], v[200:203], v[8:11]
    ds_write_b128 v228, v[136:139] offset:24576
    v_mfma_f32_16x16x32_bf16 v[28:31], v[164:167], v[200:203], v[28:31]
    s_waitcnt vmcnt(8)
    v_mfma_f32_16x16x32_bf16 v[48:51], v[168:171], v[200:203], v[48:51]
    ds_read_b64_tr_b16 v[178:179], v233 offset:8192
    ds_read_b64_tr_b16 v[182:183], v234 offset:8192
    v_mfma_f32_16x16x32_bf16 v[68:71], v[172:175], v[200:203], v[68:71]
    ds_read_b64_tr_b16 v[186:187], v235 offset:8192
    ds_read_b64_tr_b16 v[190:191], v236 offset:8192
    ds_read_b128 v[200:203], v224 offset:17408
    v_mfma_f32_16x16x32_bf16 v[12:15], v[160:163], v[204:207], v[12:15]
    v_mfma_f32_16x16x32_bf16 v[32:35], v[164:167], v[204:207], v[32:35]
    v_mfma_f32_16x16x32_bf16 v[52:55], v[168:171], v[204:207], v[52:55]
    v_mfma_f32_16x16x32_bf16 v[72:75], v[172:175], v[204:207], v[72:75]
    ds_read_b128 v[204:207], v224 offset:18432
    s_waitcnt lgkmcnt(2)
    s_mov_b32 s77, 180224
    s_add_u32 m0, s76, 8192
    s_nop 0
    buffer_load_dwordx4 v220, s[64:67], s77 offen nt lds
    buffer_load_dwordx4 v221, s[64:67], s77 offen offset:1024 nt lds
    v_mfma_f32_16x16x32_bf16 v[16:19], v[160:163], v[208:211], v[16:19]
    v_mfma_f32_16x16x32_bf16 v[36:39], v[164:167], v[208:211], v[36:39]
    v_mfma_f32_16x16x32_bf16 v[56:59], v[168:171], v[208:211], v[56:59]
    v_mfma_f32_16x16x32_bf16 v[76:79], v[172:175], v[208:211], v[76:79]
    ds_read_b128 v[208:211], v224 offset:19456
    s_setprio 2
    s_waitcnt vmcnt(8)
    s_barrier
    v_mfma_f32_16x16x32_bf16 v[0:3], v[176:179], v[192:195], v[0:3]
    ds_read_b64_tr_b16 v[160:161], v233
    ds_read_b64_tr_b16 v[164:165], v234
    v_mfma_f32_16x16x32_bf16 v[20:23], v[180:183], v[192:195], v[20:23]
    ds_read_b64_tr_b16 v[168:169], v235
    ds_read_b64_tr_b16 v[172:173], v236
    v_mfma_f32_16x16x32_bf16 v[40:43], v[184:187], v[192:195], v[40:43]
    v_mfma_f32_16x16x32_bf16 v[60:63], v[188:191], v[192:195], v[60:63]
    ds_read_b128 v[192:195], v224 offset:20480
    v_mfma_f32_16x16x32_bf16 v[4:7], v[176:179], v[196:199], v[4:7]
    v_mfma_f32_16x16x32_bf16 v[24:27], v[180:183], v[196:199], v[24:27]
    s_waitcnt lgkmcnt(1)
    s_mov_b32 s77, 188416
    s_add_u32 m0, s76, 0
    s_nop 0
    buffer_load_dwordx4 v220, s[64:67], s77 offen nt lds
    buffer_load_dwordx4 v221, s[64:67], s77 offen offset:1024 nt lds
    v_mfma_f32_16x16x32_bf16 v[44:47], v[184:187], v[196:199], v[44:47]
    v_mfma_f32_16x16x32_bf16 v[64:67], v[188:191], v[196:199], v[64:67]
    ds_read_b128 v[196:199], v224 offset:21504
    v_mfma_f32_16x16x32_bf16 v[8:11], v[176:179], v[200:203], v[8:11]
    v_mfma_f32_16x16x32_bf16 v[28:31], v[180:183], v[200:203], v[28:31]
    s_waitcnt vmcnt(8)
    v_mfma_f32_16x16x32_bf16 v[48:51], v[184:187], v[200:203], v[48:51]
    ds_read_b64_tr_b16 v[162:163], v233 offset:2048
    ds_read_b64_tr_b16 v[166:167], v234 offset:2048
    v_mfma_f32_16x16x32_bf16 v[68:71], v[188:191], v[200:203], v[68:71]
    ds_read_b64_tr_b16 v[170:171], v235 offset:2048
    ds_read_b64_tr_b16 v[174:175], v236 offset:2048
    ds_read_b128 v[200:203], v224 offset:22528
    v_mfma_f32_16x16x32_bf16 v[12:15], v[176:179], v[204:207], v[12:15]
    v_mfma_f32_16x16x32_bf16 v[32:35], v[180:183], v[204:207], v[32:35]
    v_mfma_f32_16x16x32_bf16 v[52:55], v[184:187], v[204:207], v[52:55]
    v_mfma_f32_16x16x32_bf16 v[72:75], v[188:191], v[204:207], v[72:75]
    ds_read_b128 v[204:207], v224 offset:23552
    s_waitcnt lgkmcnt(2)
    s_mov_b32 s77, 245760
    s_add_u32 m0, s76, 2048
    s_nop 0
    buffer_load_dwordx4 v220, s[64:67], s77 offen nt lds
    buffer_load_dwordx4 v221, s[64:67], s77 offen offset:1024 nt lds
    v_mfma_f32_16x16x32_bf16 v[16:19], v[176:179], v[208:211], v[16:19]
    v_mfma_f32_16x16x32_bf16 v[36:39], v[180:183], v[208:211], v[36:39]
    v_mfma_f32_16x16x32_bf16 v[56:59], v[184:187], v[208:211], v[56:59]
    v_mfma_f32_16x16x32_bf16 v[76:79], v[188:191], v[208:211], v[76:79]
    ds_read_b128 v[208:211], v224 offset:24576
    s_setprio 1
    s_waitcnt vmcnt(8)
    v_mfma_f32_16x16x32_bf16 v[0:3], v[160:163], v[192:195], v[0:3]
    ds_read_b64_tr_b16 v[176:177], v233 offset:4096
    ds_read_b64_tr_b16 v[180:181], v234 offset:4096
    v_mfma_f32_16x16x32_bf16 v[20:23], v[164:167], v[192:195], v[20:23]
    ds_read_b64_tr_b16 v[184:185], v235 offset:4096
    ds_read_b64_tr_b16 v[188:189], v236 offset:4096
    ds_read_b128 v[140:143], v224 offset:35840
    v_mfma_f32_16x16x32_bf16 v[40:43], v[168:171], v[192:195], v[40:43]
    v_mfma_f32_16x16x32_bf16 v[60:63], v[172:175], v[192:195], v[60:63]
    ds_read_b128 v[192:195], v224 offset:25600
    v_mfma_f32_16x16x32_bf16 v[4:7], v[160:163], v[196:199], v[4:7]
    v_mfma_f32_16x16x32_bf16 v[24:27], v[164:167], v[196:199], v[24:27]
    ds_read_b128 v[144:147], v224 offset:36864
    s_waitcnt lgkmcnt(3)
    s_mov_b32 s77, 253952
    s_add_u32 m0, s76, 4096
    s_nop 0
    buffer_load_dwordx4 v220, s[64:67], s77 offen nt lds
    buffer_load_dwordx4 v221, s[64:67], s77 offen offset:1024 nt lds
    v_mfma_f32_16x16x32_bf16 v[44:47], v[168:171], v[196:199], v[44:47]
    v_mfma_f32_16x16x32_bf16 v[64:67], v[172:175], v[196:199], v[64:67]
    ds_read_b128 v[196:199], v224 offset:26624
    v_mfma_f32_16x16x32_bf16 v[8:11], v[160:163], v[200:203], v[8:11]
    v_mfma_f32_16x16x32_bf16 v[28:31], v[164:167], v[200:203], v[28:31]
    ds_read_b128 v[148:151], v224 offset:37888
    s_waitcnt vmcnt(8)
    v_mfma_f32_16x16x32_bf16 v[48:51], v[168:171], v[200:203], v[48:51]
    ds_read_b64_tr_b16 v[178:179], v233 offset:6144
    ds_read_b64_tr_b16 v[182:183], v234 offset:6144
    v_mfma_f32_16x16x32_bf16 v[68:71], v[172:175], v[200:203], v[68:71]
    ds_read_b64_tr_b16 v[186:187], v235 offset:6144
    ds_read_b64_tr_b16 v[190:191], v236 offset:6144
    ds_read_b128 v[200:203], v224 offset:27648
    v_mfma_f32_16x16x32_bf16 v[12:15], v[160:163], v[204:207], v[12:15]
    v_mfma_f32_16x16x32_bf16 v[32:35], v[164:167], v[204:207], v[32:35]
    ds_read_b128 v[152:155], v224 offset:38912
    v_mfma_f32_16x16x32_bf16 v[52:55], v[168:171], v[204:207], v[52:55]
    v_mfma_f32_16x16x32_bf16 v[72:75], v[172:175], v[204:207], v[72:75]
    ds_read_b128 v[204:207], v224 offset:28672
    s_waitcnt lgkmcnt(3)
    s_add_u32 s99, s99, 28672
    s_sub_u32 s77, s99, 458752
    s_cselect_b32 s99, s99, s77
    s_add_u32 s77, s99, 0
    s_add_u32 m0, s76, 6144
    s_nop 0
    buffer_load_dwordx4 v245, s[68:71], s77 offen lds
    buffer_load_dwordx4 v246, s[68:71], s77 offen offset:1024 lds
    v_mfma_f32_16x16x32_bf16 v[16:19], v[160:163], v[208:211], v[16:19]
    v_mfma_f32_16x16x32_bf16 v[36:39], v[164:167], v[208:211], v[36:39]
    ds_read_b128 v[156:159], v224 offset:39936
    v_mfma_f32_16x16x32_bf16 v[56:59], v[168:171], v[208:211], v[56:59]
    v_mfma_f32_16x16x32_bf16 v[76:79], v[172:175], v[208:211], v[76:79]
    ds_read_b128 v[208:211], v224 offset:29696
    s_setprio 0
    s_waitcnt vmcnt(8)
    v_mfma_f32_16x16x32_bf16 v[0:3], v[176:179], v[192:195], v[0:3]
    ds_read_b64_tr_b16 v[160:161], v233 offset:8192
    ds_read_b64_tr_b16 v[164:165], v234 offset:8192
    v_mfma_f32_16x16x32_bf16 v[20:23], v[180:183], v[192:195], v[20:23]
    ds_read_b64_tr_b16 v[168:169], v235 offset:8192
    ds_read_b64_tr_b16 v[172:173], v236 offset:8192
    v_mfma_f32_16x16x32_bf16 v[40:43], v[184:187], v[192:195], v[40:43]
    v_mfma_f32_16x16x32_bf16 v[60:63], v[188:191], v[192:195], v[60:63]
    ds_read_b128 v[192:195], v224 offset:30720
    v_mfma_f32_16x16x32_bf16 v[4:7], v[176:179], v[196:199], v[4:7]
    v_mfma_f32_16x16x32_bf16 v[24:27], v[180:183], v[196:199], v[24:27]
    s_waitcnt lgkmcnt(1)
    s_add_u32 s77, s99, 14336
    s_add_u32 m0, s76, 8192
    s_nop 0
    buffer_load_dwordx4 v245, s[68:71], s77 offen lds
    buffer_load_dwordx4 v246, s[68:71], s77 offen offset:1024 lds
    v_mfma_f32_16x16x32_bf16 v[44:47], v[184:187], v[196:199], v[44:47]
    v_mfma_f32_16x16x32_bf16 v[64:67], v[188:191], v[196:199], v[64:67]
    ds_read_b128 v[196:199], v224 offset:31744
    v_mfma_f32_16x16x32_bf16 v[8:11], v[176:179], v[200:203], v[8:11]
    v_mfma_f32_16x16x32_bf16 v[28:31], v[180:183], v[200:203], v[28:31]
    s_waitcnt vmcnt(8)
    v_mfma_f32_16x16x32_bf16 v[48:51], v[184:187], v[200:203], v[48:51]
    ds_read_b64_tr_b16 v[162:163], v233
    ds_read_b64_tr_b16 v[166:167], v234
    v_mfma_f32_16x16x32_bf16 v[68:71], v[188:191], v[200:203], v[68:71]
    ds_read_b64_tr_b16 v[170:171], v235
    ds_read_b64_tr_b16 v[174:175], v236
    ds_read_b128 v[200:203], v224 offset:32768
    v_mfma_f32_16x16x32_bf16 v[12:15], v[176:179], v[204:207], v[12:15]
    v_mfma_f32_16x16x32_bf16 v[32:35], v[180:183], v[204:207], v[32:35]
    v_mfma_f32_16x16x32_bf16 v[52:55], v[184:187], v[204:207], v[52:55]
    v_mfma_f32_16x16x32_bf16 v[72:75], v[188:191], v[204:207], v[72:75]
    ds_read_b128 v[204:207], v224 offset:33792
    s_waitcnt lgkmcnt(2)
    s_add_u32 s99, s99, 28672
    s_sub_u32 s77, s99, 458752
    s_cselect_b32 s99, s99, s77
    s_add_u32 s77, s99, 0
    s_add_u32 m0, s76, 0
    s_nop 0
    buffer_load_dwordx4 v245, s[68:71], s77 offen lds
    buffer_load_dwordx4 v246, s[68:71], s77 offen offset:1024 lds
    v_mfma_f32_16x16x32_bf16 v[16:19], v[176:179], v[208:211], v[16:19]
    v_mfma_f32_16x16x32_bf16 v[36:39], v[180:183], v[208:211], v[36:39]
    v_mfma_f32_16x16x32_bf16 v[56:59], v[184:187], v[208:211], v[56:59]
    v_mfma_f32_16x16x32_bf16 v[76:79], v[188:191], v[208:211], v[76:79]
    ds_read_b128 v[208:211], v224 offset:34816
    s_setprio 3
    s_waitcnt vmcnt(8)
    v_mfma_f32_16x16x32_bf16 v[0:3], v[160:163], v[192:195], v[0:3]
    ds_read_b64_tr_b16 v[176:177], v233 offset:2048
    ds_read_b64_tr_b16 v[180:181], v234 offset:2048
    v_mfma_f32_16x16x32_bf16 v[20:23], v[164:167], v[192:195], v[20:23]
    ds_read_b64_tr_b16 v[184:185], v235 offset:2048
    ds_read_b64_tr_b16 v[188:189], v236 offset:2048
    s_waitcnt vmcnt(6)
    v_mfma_f32_16x16x32_bf16 v[40:43], v[168:171], v[192:195], v[40:43]
    ds_read_b64_tr_b16 v[178:179], v233 offset:4096
    ds_read_b64_tr_b16 v[182:183], v234 offset:4096
    v_mfma_f32_16x16x32_bf16 v[60:63], v[172:175], v[192:195], v[60:63]
    ds_read_b64_tr_b16 v[186:187], v235 offset:4096
    ds_read_b64_tr_b16 v[190:191], v236 offset:4096
    v_mfma_f32_16x16x32_bf16 v[4:7], v[160:163], v[196:199], v[4:7]
    v_mfma_f32_16x16x32_bf16 v[24:27], v[164:167], v[196:199], v[24:27]
    v_mfma_f32_16x16x32_bf16 v[44:47], v[168:171], v[196:199], v[44:47]
    v_mfma_f32_16x16x32_bf16 v[64:67], v[172:175], v[196:199], v[64:67]
    s_waitcnt lgkmcnt(0)
    s_barrier
    v_mfma_f32_16x16x32_bf16 v[0:3], v[176:179], v[140:143], v[0:3]
    s_add_u32 s77, s99, 14336
    s_add_u32 m0, s76, 2048
    s_nop 0
    buffer_load_dwordx4 v245, s[68:71], s77 offen lds
    buffer_load_dwordx4 v246, s[68:71], s77 offen offset:1024 lds
    v_mfma_f32_16x16x32_bf16 v[20:23], v[180:183], v[140:143], v[20:23]
    s_add_u32 s99, s99, 28672
    s_sub_u32 s77, s99, 458752
    s_cselect_b32 s99, s99, s77
    s_add_u32 s77, s99, 0
    s_add_u32 m0, s76, 4096
    s_nop 0
    buffer_load_dwordx4 v245, s[68:71], s77 offen lds
    buffer_load_dwordx4 v246, s[68:71], s77 offen offset:1024 lds
    v_mfma_f32_16x16x32_bf16 v[40:43], v[184:187], v[140:143], v[40:43]
    s_cmp_eq_u32 s92, 1
    s_cbranch_scc1 L_sk52
    s_mov_b32 s88, 0
    buffer_load_dwordx4 v[80:83], v222, s[28:31], s88 offen
L_sk52:
    s_cmp_eq_u32 s92, 1
    s_cbranch_scc1 L_sk53
    s_mov_b32 s88, 14336
    buffer_load_dwordx4 v[84:87], v222, s[28:31], s88 offen
L_sk53:
    v_mfma_f32_16x16x32_bf16 v[60:63], v[188:191], v[140:143], v[60:63]
    s_cmp_eq_u32 s92, 1
    s_cbranch_scc1 L_sk54
    s_mov_b32 s88, 28672
    buffer_load_dwordx4 v[88:91], v222, s[28:31], s88 offen
L_sk54:
    s_cmp_eq_u32 s92, 1
    s_cbranch_scc1 L_sk55
    s_mov_b32 s88, 43008
    buffer_load_dwordx4 v[92:95], v222, s[28:31], s88 offen
L_sk55:
    v_mfma_f32_16x16x32_bf16 v[8:11], v[160:163], v[200:203], v[8:11]
    v_mfma_f32_16x16x32_bf16 v[28:31], v[164:167], v[200:203], v[28:31]
    v_mfma_f32_16x16x32_bf16 v[48:51], v[168:171], v[200:203], v[48:51]
    v_cvt_pk_bf16_f32 v0, v0, v1
    v_cvt_pk_bf16_f32 v1, v2, v3
    v_cvt_pk_bf16_f32 v2, v20, v21
    v_mfma_f32_16x16x32_bf16 v[68:71], v[172:175], v[200:203], v[68:71]
    v_cvt_pk_bf16_f32 v3, v22, v23
    v_cvt_pk_bf16_f32 v40, v40, v41
    v_cvt_pk_bf16_f32 v41, v42, v43
    v_mfma_f32_16x16x32_bf16 v[4:7], v[176:179], v[144:147], v[4:7]
    v_cvt_pk_bf16_f32 v42, v60, v61
    v_cvt_pk_bf16_f32 v43, v62, v63
    ds_write_b128 v232, v[0:3]
    v_mfma_f32_16x16x32_bf16 v[24:27], v[180:183], v[144:147], v[24:27]
    ds_write_b128 v232, v[40:43] offset:5120
    v_mfma_f32_16x16x32_bf16 v[44:47], v[184:187], v[144:147], v[44:47]
    v_mfma_f32_16x16x32_bf16 v[64:67], v[188:191], v[144:147], v[64:67]
    s_setprio 2
    v_mfma_f32_16x16x32_bf16 v[12:15], v[160:163], v[204:207], v[12:15]
    v_mfma_f32_16x16x32_bf16 v[32:35], v[164:167], v[204:207], v[32:35]
    s_cmp_eq_u32 s92, 1
    s_cbranch_scc1 L_sk56
    s_mov_b32 s88, 57344
    buffer_load_dwordx4 v[96:99], v222, s[28:31], s88 offen
L_sk56:
    s_cmp_eq_u32 s92, 1
    s_cbranch_scc1 L_sk57
    s_mov_b32 s88, 0
    buffer_load_dwordx4 v[100:103], v223, s[28:31], s88 offen
L_sk57:
    v_mfma_f32_16x16x32_bf16 v[52:55], v[168:171], v[204:207], v[52:55]
    s_cmp_eq_u32 s92, 1
    s_cbranch_scc1 L_sk58
    s_mov_b32 s88, 14336
    buffer_load_dwordx4 v[104:107], v223, s[28:31], s88 offen
L_sk58:
    s_cmp_eq_u32 s92, 1
    s_cbranch_scc1 L_sk59
    s_mov_b32 s88, 28672
    buffer_load_dwordx4 v[108:111], v223, s[28:31], s88 offen
L_sk59:
    v_cvt_pk_bf16_f32 v4, v4, v5
    v_cvt_pk_bf16_f32 v5, v6, v7
    v_cvt_pk_bf16_f32 v6, v24, v25
    v_mfma_f32_16x16x32_bf16 v[72:75], v[172:175], v[204:207], v[72:75]
    v_cvt_pk_bf16_f32 v7, v26, v27
    v_cvt_pk_bf16_f32 v44, v44, v45
    v_cvt_pk_bf16_f32 v45, v46, v47
    v_mfma_f32_16x16x32_bf16 v[8:11], v[176:179], v[148:151], v[8:11]
    v_cvt_pk_bf16_f32 v46, v64, v65
    v_cvt_pk_bf16_f32 v47, v66, v67
    ds_write_b128 v232, v[4:7] offset:1024
    v_mfma_f32_16x16x32_bf16 v[28:31], v[180:183], v[148:151], v[28:31]
    ds_write_b128 v232, v[44:47] offset:6144
    v_mfma_f32_16x16x32_bf16 v[48:51], v[184:187], v[148:151], v[48:51]
    v_mfma_f32_16x16x32_bf16 v[68:71], v[188:191], v[148:151], v[68:71]
    v_mfma_f32_16x16x32_bf16 v[16:19], v[160:163], v[208:211], v[16:19]
    v_mfma_f32_16x16x32_bf16 v[36:39], v[164:167], v[208:211], v[36:39]
    v_mfma_f32_16x16x32_bf16 v[56:59], v[168:171], v[208:211], v[56:59]
    v_cvt_pk_bf16_f32 v8, v8, v9
    v_cvt_pk_bf16_f32 v9, v10, v11
    v_cvt_pk_bf16_f32 v10, v28, v29
    v_mfma_f32_16x16x32_bf16 v[76:79], v[172:175], v[208:211], v[76:79]
    v_cvt_pk_bf16_f32 v11, v30, v31
    v_cvt_pk_bf16_f32 v48, v48, v49
    v_cvt_pk_bf16_f32 v49, v50, v51
    v_mfma_f32_16x16x32_bf16 v[12:15], v[176:179], v[152:155], v[12:15]
    s_waitcnt vmcnt(8)
    s_waitcnt vmcnt(6)
    ds_read_b64_tr_b16 v[160:161], v233 offset:6144
    ds_read_b64_tr_b16 v[164:165], v234 offset:6144
    ds_read_b64_tr_b16 v[168:169], v235 offset:6144
    ds_read_b64_tr_b16 v[172:173], v236 offset:6144
    ds_read_b64_tr_b16 v[162:163], v233 offset:8192
    ds_read_b64_tr_b16 v[166:167], v234 offset:8192
    ds_read_b64_tr_b16 v[170:171], v235 offset:8192
    ds_read_b64_tr_b16 v[174:175], v236 offset:8192
    v_cvt_pk_bf16_f32 v50, v68, v69
    v_cvt_pk_bf16_f32 v51, v70, v71
    ds_write_b128 v232, v[8:11] offset:2048
    v_mfma_f32_16x16x32_bf16 v[32:35], v[180:183], v[152:155], v[32:35]
    s_cmp_eq_u32 s92, 1
    s_cbranch_scc1 L_sk60
    s_mov_b32 s88, 43008
    buffer_load_dwordx4 v[112:115], v223, s[28:31], s88 offen
L_sk60:
    s_cmp_eq_u32 s92, 1
    s_cbranch_scc1 L_sk61
    s_mov_b32 s88, 57344
    buffer_load_dwordx4 v[116:119], v223, s[28:31], s88 offen
L_sk61:
    ds_write_b128 v232, v[48:51] offset:7168
    v_mfma_f32_16x16x32_bf16 v[52:55], v[184:187], v[152:155], v[52:55]
    v_mfma_f32_16x16x32_bf16 v[72:75], v[188:191], v[152:155], v[72:75]
    v_mfma_f32_16x16x32_bf16 v[16:19], v[176:179], v[156:159], v[16:19]
    v_mfma_f32_16x16x32_bf16 v[36:39], v[180:183], v[156:159], v[36:39]
    v_mfma_f32_16x16x32_bf16 v[56:59], v[184:187], v[156:159], v[56:59]
    v_cvt_pk_bf16_f32 v12, v12, v13
    v_cvt_pk_bf16_f32 v13, v14, v15
    v_cvt_pk_bf16_f32 v14, v32, v33
    v_mfma_f32_16x16x32_bf16 v[76:79], v[188:191], v[156:159], v[76:79]
    v_cvt_pk_bf16_f32 v15, v34, v35
    v_cvt_pk_bf16_f32 v52, v52, v53
    v_cvt_pk_bf16_f32 v53, v54, v55
    v_cvt_pk_bf16_f32 v54, v72, v73
    v_cvt_pk_bf16_f32 v55, v74, v75
    ds_write_b128 v232, v[12:15] offset:3072
    s_waitcnt lgkmcnt(14)
    ds_write_b128 v232, v[52:55] offset:8192
    v_cvt_pk_bf16_f32 v16, v16, v17
    v_cvt_pk_bf16_f32 v17, v18, v19
    v_cvt_pk_bf16_f32 v18, v36, v37
    v_cvt_pk_bf16_f32 v19, v38, v39
    v_cvt_pk_bf16_f32 v56, v56, v57
    v_cvt_pk_bf16_f32 v57, v58, v59
    v_cvt_pk_bf16_f32 v58, v76, v77
    v_cvt_pk_bf16_f32 v59, v78, v79
    s_waitcnt lgkmcnt(14)
    ds_write_b128 v232, v[16:19] offset:4096
    s_waitcnt lgkmcnt(14)
    ds_write_b128 v232, v[56:59] offset:9216
    s_setprio 0
    s_waitcnt lgkmcnt(0)
    s_barrier
    s_cmp_lg_u32 s83, 7
    s_cbranch_scc1 L_o1
    s_waitcnt vmcnt(0)
    s_add_u32 s98, s98, 262144
    s_sub_u32 s77, s98, 3670016
    s_cselect_b32 s98, s98, s77
    s_add_u32 s77, s98, 0
    s_add_u32 m0, s76, 0
    s_nop 0
    buffer_load_dwordx4 v243, s[32:35], s77 offen lds
    buffer_load_dwordx4 v244, s[32:35], s77 offen offset:1024 lds
    s_add_u32 s77, s98, 32768
    s_add_u32 m0, s76, 2048
    s_nop 0
    buffer_load_dwordx4 v243, s[32:35], s77 offen lds
    buffer_load_dwordx4 v244, s[32:35], s77 offen offset:1024 lds
    s_add_u32 s98, s98, 262144
    s_sub_u32 s77, s98, 3670016
    s_cselect_b32 s98, s98, s77
    s_add_u32 s77, s98, 0
    s_add_u32 m0, s76, 4096
    s_nop 0
    buffer_load_dwordx4 v243, s[32:35], s77 offen lds
    buffer_load_dwordx4 v244, s[32:35], s77 offen offset:1024 lds
    s_add_u32 s77, s98, 32768
    s_add_u32 m0, s76, 6144
    s_nop 0
    buffer_load_dwordx4 v243, s[32:35], s77 offen lds
    buffer_load_dwordx4 v244, s[32:35], s77 offen offset:1024 lds
    s_add_u32 s98, s98, 262144
    s_sub_u32 s77, s98, 3670016
    s_cselect_b32 s98, s98, s77
    s_add_u32 s77, s98, 0
    s_add_u32 m0, s76, 8192
    s_nop 0
    buffer_load_dwordx4 v243, s[32:35], s77 offen lds
    buffer_load_dwordx4 v244, s[32:35], s77 offen offset:1024 lds
    s_barrier
    s_cmp_eq_u32 s92, 1
    s_cbranch_scc1 L_sk62
    ds_write_b128 v229, v[80:83] offset:0
L_sk62:
    s_cmp_eq_u32 s92, 1
    s_cbranch_scc1 L_sk63
    ds_write_b128 v229, v[84:87] offset:4096
L_sk63:
    s_cmp_eq_u32 s92, 1
    s_cbranch_scc1 L_sk64
    ds_write_b128 v229, v[88:91] offset:8192
L_sk64:
    s_cmp_eq_u32 s92, 1
    s_cbranch_scc1 L_sk65
    ds_write_b128 v229, v[92:95] offset:12288
L_sk65:
    s_cmp_eq_u32 s92, 1
    s_cbranch_scc1 L_sk66
    ds_write_b128 v229, v[96:99] offset:16384
L_sk66:
    s_waitcnt vmcnt(0) lgkmcnt(0)
    s_barrier
    ds_read_b64_tr_b16 v[160:161], v233
    ds_read_b64_tr_b16 v[164:165], v234
    ds_read_b64_tr_b16 v[168:169], v235
    ds_read_b64_tr_b16 v[172:173], v236
    ds_read_b64_tr_b16 v[162:163], v233 offset:2048
    ds_read_b64_tr_b16 v[166:167], v234 offset:2048
    ds_read_b64_tr_b16 v[170:171], v235 offset:2048
    ds_read_b64_tr_b16 v[174:175], v236 offset:2048
    ds_read_b128 v[192:195], v237
    ds_read_b128 v[196:199], v237 offset:4096
    ds_read_b128 v[200:203], v237 offset:8192
    ds_read_b128 v[204:207], v237 offset:12288
    ds_read_b128 v[208:211], v237 offset:16384
    s_waitcnt lgkmcnt(0)
    s_add_u32 s77, s98, 32768
    s_add_u32 m0, s76, 0
    s_nop 0
    buffer_load_dwordx4 v243, s[32:35], s77 offen lds
    buffer_load_dwordx4 v244, s[32:35], s77 offen offset:1024 lds
    s_add_u32 s98, s98, 262144
    s_sub_u32 s77, s98, 3670016
    s_cselect_b32 s98, s98, s77
    s_add_u32 s77, s98, 0
    s_add_u32 m0, s76, 2048
    s_nop 0
    buffer_load_dwordx4 v243, s[32:35], s77 offen lds
    buffer_load_dwordx4 v244, s[32:35], s77 offen offset:1024 lds
    s_branch L_oend1
L_o1:
    ds_read_b128 v[192:195], v230
    ds_read_b128 v[196:199], v230 offset:1024
    ds_read_b128 v[200:203], v230 offset:2048
    ds_read_b128 v[204:207], v230 offset:3072
    ds_read_b128 v[208:211], v230 offset:4096
    s_setprio 3
    s_waitcnt vmcnt(4)
    s_waitcnt lgkmcnt(4)
    v_mfma_f32_16x16x32_bf16 v[0:3], v[160:163], v[192:195], 0
    ds_read_b64_tr_b16 v[176:177], v233
    ds_read_b64_tr_b16 v[180:181], v234
    v_mfma_f32_16x16x32_bf16 v[20:23], v[164:167], v[192:195], 0
    ds_read_b64_tr_b16 v[184:185], v235
    ds_read_b64_tr_b16 v[188:189], v236
    v_mfma_f32_16x16x32_bf16 v[40:43], v[168:171], v[192:195], 0
    s_add_u32 s77, s99, 14336
    s_add_u32 m0, s76, 6144
    s_nop 0
    buffer_load_dwordx4 v245, s[68:71], s77 offen lds
    buffer_load_dwordx4 v246, s[68:71], s77 offen offset:1024 lds
    v_mfma_f32_16x16x32_bf16 v[60:63], v[172:175], v[192:195], 0
    ds_read_b128 v[192:195], v230 offset:5120
    s_add_u32 s99, s99, 28672
    s_sub_u32 s77, s99, 458752
    s_cselect_b32 s99, s99, s77
    s_add_u32 s77, s99, 0
    s_add_u32 m0, s76, 8192
    s_nop 0
    buffer_load_dwordx4 v245, s[68:71], s77 offen lds
    buffer_load_dwordx4 v246, s[68:71], s77 offen offset:1024 lds
    s_waitcnt lgkmcnt(8)
    v_mfma_f32_16x16x32_bf16 v[4:7], v[160:163], v[196:199], 0
    v_mfma_f32_16x16x32_bf16 v[24:27], v[164:167], v[196:199], 0
    s_waitcnt lgkmcnt(1)
    s_add_u32 s77, s99, 14336
    s_add_u32 m0, s76, 0
    s_nop 0
    buffer_load_dwordx4 v245, s[68:71], s77 offen lds
    buffer_load_dwordx4 v246, s[68:71], s77 offen offset:1024 lds
    v_mfma_f32_16x16x32_bf16 v[44:47], v[168:171], v[196:199], 0
    v_mfma_f32_16x16x32_bf16 v[64:67], v[172:175], v[196:199], 0
    ds_read_b128 v[196:199], v230 offset:6144
    v_mfma_f32_16x16x32_bf16 v[8:11], v[160:163], v[200:203], 0
    v_mfma_f32_16x16x32_bf16 v[28:31], v[164:167], v[200:203], 0
    s_waitcnt vmcnt(8)
    v_mfma_f32_16x16x32_bf16 v[48:51], v[168:171], v[200:203], 0
    ds_read_b64_tr_b16 v[178:179], v233 offset:2048
    ds_read_b64_tr_b16 v[182:183], v234 offset:2048
    v_mfma_f32_16x16x32_bf16 v[68:71], v[172:175], v[200:203], 0
    ds_read_b64_tr_b16 v[186:187], v235 offset:2048
    ds_read_b64_tr_b16 v[190:191], v236 offset:2048
    ds_read_b128 v[200:203], v230 offset:7168
    v_mfma_f32_16x16x32_bf16 v[12:15], v[160:163], v[204:207], 0
    v_mfma_f32_16x16x32_bf16 v[32:35], v[164:167], v[204:207], 0
    v_mfma_f32_16x16x32_bf16 v[52:55], v[168:171], v[204:207], 0
    v_mfma_f32_16x16x32_bf16 v[72:75], v[172:175], v[204:207], 0
    ds_read_b128 v[204:207], v230 offset:8192
    s_waitcnt lgkmcnt(2)
    s_add_u32 s99, s99, 28672
    s_sub_u32 s77, s99, 458752
    s_cselect_b32 s99, s99, s77
    s_add_u32 s77, s99, 0
    s_add_u32 m0, s76, 2048
    s_nop 0
    buffer_load_dwordx4 v245, s[68:71], s77 offen lds
    buffer_load_dwordx4 v246, s[68:71], s77 offen offset:1024 lds
    v_mfma_f32_16x16x32_bf16 v[16:19], v[160:163], v[208:211], 0
    v_mfma_f32_16x16x32_bf16 v[36:39], v[164:167], v[208:211], 0
    v_mfma_f32_16x16x32_bf16 v[56:59], v[168:171], v[208:211], 0
    v_mfma_f32_16x16x32_bf16 v[76:79], v[172:175], v[208:211], 0
    ds_read_b128 v[208:211], v230 offset:9216
    s_setprio 2
    s_waitcnt vmcnt(8)
    v_mfma_f32_16x16x32_bf16 v[0:3], v[176:179], v[192:195], v[0:3]
    ds_read_b64_tr_b16 v[160:161], v233 offset:4096
    ds_read_b64_tr_b16 v[164:165], v234 offset:4096
    v_mfma_f32_16x16x32_bf16 v[20:23], v[180:183], v[192:195], v[20:23]
    ds_read_b64_tr_b16 v[168:169], v235 offset:4096
    ds_read_b64_tr_b16 v[172:173], v236 offset:4096
    v_mfma_f32_16x16x32_bf16 v[40:43], v[184:187], v[192:195], v[40:43]
    v_mfma_f32_16x16x32_bf16 v[60:63], v[188:191], v[192:195], v[60:63]
    ds_read_b128 v[192:195], v230 offset:10240
    v_mfma_f32_16x16x32_bf16 v[4:7], v[176:179], v[196:199], v[4:7]
    v_mfma_f32_16x16x32_bf16 v[24:27], v[180:183], v[196:199], v[24:27]
    s_waitcnt lgkmcnt(1)
    s_add_u32 s77, s99, 14336
    s_add_u32 m0, s76, 4096
    s_nop 0
    buffer_load_dwordx4 v245, s[68:71], s77 offen lds
    buffer_load_dwordx4 v246, s[68:71], s77 offen offset:1024 lds
    v_mfma_f32_16x16x32_bf16 v[44:47], v[184:187], v[196:199], v[44:47]
    v_mfma_f32_16x16x32_bf16 v[64:67], v[188:191], v[196:199], v[64:67]
    ds_read_b128 v[196:199], v230 offset:11264
    v_mfma_f32_16x16x32_bf16 v[8:11], v[176:179], v[200:203], v[8:11]
    v_mfma_f32_16x16x32_bf16 v[28:31], v[180:183], v[200:203], v[28:31]
    s_waitcnt vmcnt(8)
    v_mfma_f32_16x16x32_bf16 v[48:51], v[184:187], v[200:203], v[48:51]
    ds_read_b64_tr_b16 v[162:163], v233 offset:6144
    ds_read_b64_tr_b16 v[166:167], v234 offset:6144
    v_mfma_f32_16x16x32_bf16 v[68:71], v[188:191], v[200:203], v[68:71]
    ds_read_b64_tr_b16 v[170:171], v235 offset:6144
    ds_read_b64_tr_b16 v[174:175], v236 offset:6144
    ds_read_b128 v[200:203], v230 offset:12288
    v_mfma_f32_16x16x32_bf16 v[12:15], v[176:179], v[204:207], v[12:15]
    v_mfma_f32_16x16x32_bf16 v[32:35], v[180:183], v[204:207], v[32:35]
    v_mfma_f32_16x16x32_bf16 v[52:55], v[184:187], v[204:207], v[52:55]
    v_mfma_f32_16x16x32_bf16 v[72:75], v[188:191], v[204:207], v[72:75]
    ds_read_b128 v[204:207], v230 offset:13312
    s_waitcnt lgkmcnt(2)
    s_add_u32 s99, s99, 28672
    s_sub_u32 s77, s99, 458752
    s_cselect_b32 s99, s99, s77
    s_add_u32 s77, s99, 0
    s_add_u32 m0, s76, 6144
    s_nop 0
    buffer_load_dwordx4 v245, s[68:71], s77 offen lds
    buffer_load_dwordx4 v246, s[68:71], s77 offen offset:1024 lds
    v_mfma_f32_16x16x32_bf16 v[16:19], v[176:179], v[208:211], v[16:19]
    v_mfma_f32_16x16x32_bf16 v[36:39], v[180:183], v[208:211], v[36:39]
    v_mfma_f32_16x16x32_bf16 v[56:59], v[184:187], v[208:211], v[56:59]
    v_mfma_f32_16x16x32_bf16 v[76:79], v[188:191], v[208:211], v[76:79]
    ds_read_b128 v[208:211], v230 offset:14336
    s_setprio 1
    s_waitcnt vmcnt(8)
    v_mfma_f32_16x16x32_bf16 v[0:3], v[160:163], v[192:195], v[0:3]
    ds_read_b64_tr_b16 v[176:177], v233 offset:8192
    ds_read_b64_tr_b16 v[180:181], v234 offset:8192
    v_mfma_f32_16x16x32_bf16 v[20:23], v[164:167], v[192:195], v[20:23]
    ds_read_b64_tr_b16 v[184:185], v235 offset:8192
    ds_read_b64_tr_b16 v[188:189], v236 offset:8192
    v_mfma_f32_16x16x32_bf16 v[40:43], v[168:171], v[192:195], v[40:43]
    v_mfma_f32_16x16x32_bf16 v[60:63], v[172:175], v[192:195], v[60:63]
    ds_read_b128 v[192:195], v230 offset:15360
    v_mfma_f32_16x16x32_bf16 v[4:7], v[160:163], v[196:199], v[4:7]
    v_mfma_f32_16x16x32_bf16 v[24:27], v[164:167], v[196:199], v[24:27]
    s_waitcnt lgkmcnt(1)
    s_add_u32 s77, s99, 14336
    s_add_u32 m0, s76, 8192
    s_nop 0
    buffer_load_dwordx4 v245, s[68:71], s77 offen lds
    buffer_load_dwordx4 v246, s[68:71], s77 offen offset:1024 lds
    v_mfma_f32_16x16x32_bf16 v[44:47], v[168:171], v[196:199], v[44:47]
    v_mfma_f32_16x16x32_bf16 v[64:67], v[172:175], v[196:199], v[64:67]
    ds_read_b128 v[196:199], v230 offset:16384
    v_mfma_f32_16x16x32_bf16 v[8:11], v[160:163], v[200:203], v[8:11]
    v_mfma_f32_16x16x32_bf16 v[28:31], v[164:167], v[200:203], v[28:31]
    s_waitcnt vmcnt(8)
    v_mfma_f32_16x16x32_bf16 v[48:51], v[168:171], v[200:203], v[48:51]
    ds_read_b64_tr_b16 v[178:179], v233
    ds_read_b64_tr_b16 v[182:183], v234
    v_mfma_f32_16x16x32_bf16 v[68:71], v[172:175], v[200:203], v[68:71]
    ds_read_b64_tr_b16 v[186:187], v235
    ds_read_b64_tr_b16 v[190:191], v236
    ds_read_b128 v[200:203], v230 offset:17408
    v_mfma_f32_16x16x32_bf16 v[12:15], v[160:163], v[204:207], v[12:15]
    v_mfma_f32_16x16x32_bf16 v[32:35], v[164:167], v[204:207], v[32:35]
    v_mfma_f32_16x16x32_bf16 v[52:55], v[168:171], v[204:207], v[52:55]
    v_mfma_f32_16x16x32_bf16 v[72:75], v[172:175], v[204:207], v[72:75]
    ds_read_b128 v[204:207], v230 offset:18432
    s_waitcnt lgkmcnt(2)
    s_add_u32 s99, s99, 28672
    s_sub_u32 s77, s99, 458752
    s_cselect_b32 s99, s99, s77
    s_add_u32 s77, s99, 0
    s_add_u32 m0, s76, 0
    s_nop 0
    buffer_load_dwordx4 v245, s[68:71], s77 offen lds
    buffer_load_dwordx4 v246, s[68:71], s77 offen offset:1024 lds
    v_mfma_f32_16x16x32_bf16 v[16:19], v[160:163], v[208:211], v[16:19]
    v_mfma_f32_16x16x32_bf16 v[36:39], v[164:167], v[208:211], v[36:39]
    v_mfma_f32_16x16x32_bf16 v[56:59], v[168:171], v[208:211], v[56:59]
    v_mfma_f32_16x16x32_bf16 v[76:79], v[172:175], v[208:211], v[76:79]
    ds_read_b128 v[208:211], v230 offset:19456
    s_setprio 0
    s_waitcnt vmcnt(8)
    v_mfma_f32_16x16x32_bf16 v[0:3], v[176:179], v[192:195], v[0:3]
    ds_read_b64_tr_b16 v[160:161], v233 offset:2048
    ds_read_b64_tr_b16 v[164:165], v234 offset:2048
    v_mfma_f32_16x16x32_bf16 v[20:23], v[180:183], v[192:195], v[20:23]
    ds_read_b64_tr_b16 v[168:169], v235 offset:2048
    ds_read_b64_tr_b16 v[172:173], v236 offset:2048
    v_mfma_f32_16x16x32_bf16 v[40:43], v[184:187], v[192:195], v[40:43]
    v_mfma_f32_16x16x32_bf16 v[60:63], v[188:191], v[192:195], v[60:63]
    ds_read_b128 v[192:195], v230 offset:20480
    v_mfma_f32_16x16x32_bf16 v[4:7], v[176:179], v[196:199], v[4:7]
    v_mfma_f32_16x16x32_bf16 v[24:27], v[180:183], v[196:199], v[24:27]
    s_waitcnt lgkmcnt(1)
    s_add_u32 s77, s99, 14336
    s_add_u32 m0, s76, 2048
    s_nop 0
    buffer_load_dwordx4 v245, s[68:71], s77 offen lds
    buffer_load_dwordx4 v246, s[68:71], s77 offen offset:1024 lds
    v_mfma_f32_16x16x32_bf16 v[44:47], v[184:187], v[196:199], v[44:47]
    v_mfma_f32_16x16x32_bf16 v[64:67], v[188:191], v[196:199], v[64:67]
    ds_read_b128 v[196:199], v230 offset:21504
    v_mfma_f32_16x16x32_bf16 v[8:11], v[176:179], v[200:203], v[8:11]
    v_mfma_f32_16x16x32_bf16 v[28:31], v[180:183], v[200:203], v[28:31]
    s_waitcnt vmcnt(8)
    v_mfma_f32_16x16x32_bf16 v[48:51], v[184:187], v[200:203], v[48:51]
    ds_read_b64_tr_b16 v[162:163], v233 offset:4096
    ds_read_b64_tr_b16 v[166:167], v234 offset:4096
    v_mfma_f32_16x16x32_bf16 v[68:71], v[188:191], v[200:203], v[68:71]
    ds_read_b64_tr_b16 v[170:171], v235 offset:4096
    ds_read_b64_tr_b16 v[174:175], v236 offset:4096
    ds_read_b128 v[200:203], v230 offset:22528
    v_mfma_f32_16x16x32_bf16 v[12:15], v[176:179], v[204:207], v[12:15]
    v_mfma_f32_16x16x32_bf16 v[32:35], v[180:183], v[204:207], v[32:35]
    v_mfma_f32_16x16x32_bf16 v[52:55], v[184:187], v[204:207], v[52:55]
    v_mfma_f32_16x16x32_bf16 v[72:75], v[188:191], v[204:207], v[72:75]
    ds_read_b128 v[204:207], v230 offset:23552
    s_waitcnt lgkmcnt(2)
    s_add_u32 s99, s99, 28672
    s_sub_u32 s77, s99, 458752
    s_cselect_b32 s99, s99, s77
    s_add_u32 s77, s99, 0
    s_add_u32 m0, s76, 4096
    s_nop 0
    buffer_load_dwordx4 v245, s[68:71], s77 offen lds
    buffer_load_dwordx4 v246, s[68:71], s77 offen offset:1024 lds
    v_mfma_f32_16x16x32_bf16 v[16:19], v[176:179], v[208:211], v[16:19]
    v_mfma_f32_16x16x32_bf16 v[36:39], v[180:183], v[208:211], v[36:39]
    v_mfma_f32_16x16x32_bf16 v[56:59], v[184:187], v[208:211], v[56:59]
    v_mfma_f32_16x16x32_bf16 v[76:79], v[188:191], v[208:211], v[76:79]
    ds_read_b128 v[208:211], v230 offset:24576
    s_setprio 3
    s_waitcnt vmcnt(8)
    v_mfma_f32_16x16x32_bf16 v[0:3], v[160:163], v[192:195], v[0:3]
    ds_read_b64_tr_b16 v[176:177], v233 offset:6144
    ds_read_b64_tr_b16 v[180:181], v234 offset:6144
    v_mfma_f32_16x16x32_bf16 v[20:23], v[164:167], v[192:195], v[20:23]
    ds_read_b64_tr_b16 v[184:185], v235 offset:6144
    ds_read_b64_tr_b16 v[188:189], v236 offset:6144
    v_mfma_f32_16x16x32_bf16 v[40:43], v[168:171], v[192:195], v[40:43]
    v_mfma_f32_16x16x32_bf16 v[60:63], v[172:175], v[192:195], v[60:63]
    ds_read_b128 v[192:195], v230 offset:25600
    v_mfma_f32_16x16x32_bf16 v[4:7], v[160:163], v[196:199], v[4:7]
    v_mfma_f32_16x16x32_bf16 v[24:27], v[164:167], v[196:199], v[24:27]
    s_waitcnt lgkmcnt(1)
    s_add_u32 s77, s99, 14336
    s_add_u32 m0, s76, 6144
    s_nop 0
    buffer_load_dwordx4 v245, s[68:71], s77 offen lds
    buffer_load_dwordx4 v246, s[68:71], s77 offen offset:1024 lds
    v_mfma_f32_16x16x32_bf16 v[44:47], v[168:171], v[196:199], v[44:47]
    v_mfma_f32_16x16x32_bf16 v[64:67], v[172:175], v[196:199], v[64:67]
    ds_read_b128 v[196:199], v230 offset:26624
    v_mfma_f32_16x16x32_bf16 v[8:11], v[160:163], v[200:203], v[8:11]
    v_mfma_f32_16x16x32_bf16 v[28:31], v[164:167], v[200:203], v[28:31]
    s_waitcnt vmcnt(8)
    v_mfma_f32_16x16x32_bf16 v[48:51], v[168:171], v[200:203], v[48:51]
    ds_read_b64_tr_b16 v[178:179], v233 offset:8192
    ds_read_b64_tr_b16 v[182:183], v234 offset:8192
    v_mfma_f32_16x16x32_bf16 v[68:71], v[172:175], v[200:203], v[68:71]
    ds_read_b64_tr_b16 v[186:187], v235 offset:8192
    ds_read_b64_tr_b16 v[190:191], v236 offset:8192
    ds_read_b128 v[200:203], v230 offset:27648
    v_mfma_f32_16x16x32_bf16 v[12:15], v[160:163], v[204:207], v[12:15]
    v_mfma_f32_16x16x32_bf16 v[32:35], v[164:167], v[204:207], v[32:35]
    v_mfma_f32_16x16x32_bf16 v[52:55], v[168:171], v[204:207], v[52:55]
    v_mfma_f32_16x16x32_bf16 v[72:75], v[172:175], v[204:207], v[72:75]
    ds_read_b128 v[204:207], v230 offset:28672
    s_waitcnt lgkmcnt(2)
    s_add_u32 s99, s99, 28672
    s_sub_u32 s77, s99, 458752
    s_cselect_b32 s99, s99, s77
    s_add_u32 s77, s99, 0
    s_add_u32 m0, s76, 8192
    s_nop 0
    buffer_load_dwordx4 v245, s[68:71], s77 offen lds
    buffer_load_dwordx4 v246, s[68:71], s77 offen offset:1024 lds
    v_mfma_f32_16x16x32_bf16 v[16:19], v[160:163], v[208:211], v[16:19]
    v_mfma_f32_16x16x32_bf16 v[36:39], v[164:167], v[208:211], v[36:39]
    v_mfma_f32_16x16x32_bf16 v[56:59], v[168:171], v[208:211], v[56:59]
    v_mfma_f32_16x16x32_bf16 v[76:79], v[172:175], v[208:211], v[76:79]
    ds_read_b128 v[208:211], v230 offset:29696
    s_setprio 2
    s_waitcnt vmcnt(8)
    v_mfma_f32_16x16x32_bf16 v[0:3], v[176:179], v[192:195], v[0:3]
    ds_read_b64_tr_b16 v[160:161], v233
    ds_read_b64_tr_b16 v[164:165], v234
    v_mfma_f32_16x16x32_bf16 v[20:23], v[180:183], v[192:195], v[20:23]
    ds_read_b64_tr_b16 v[168:169], v235
    ds_read_b64_tr_b16 v[172:173], v236
    v_mfma_f32_16x16x32_bf16 v[40:43], v[184:187], v[192:195], v[40:43]
    v_mfma_f32_16x16x32_bf16 v[60:63], v[188:191], v[192:195], v[60:63]
    ds_read_b128 v[192:195], v230 offset:30720
    v_mfma_f32_16x16x32_bf16 v[4:7], v[176:179], v[196:199], v[4:7]
    v_mfma_f32_16x16x32_bf16 v[24:27], v[180:183], v[196:199], v[24:27]
    s_waitcnt lgkmcnt(1)
    s_add_u32 s77, s99, 14336
    s_add_u32 m0, s76, 0
    s_nop 0
    buffer_load_dwordx4 v245, s[68:71], s77 offen lds
    buffer_load_dwordx4 v246, s[68:71], s77 offen offset:1024 lds
    v_mfma_f32_16x16x32_bf16 v[44:47], v[184:187], v[196:199], v[44:47]
    v_mfma_f32_16x16x32_bf16 v[64:67], v[188:191], v[196:199], v[64:67]
    ds_read_b128 v[196:199], v230 offset:31744
    v_mfma_f32_16x16x32_bf16 v[8:11], v[176:179], v[200:203], v[8:11]
    v_mfma_f32_16x16x32_bf16 v[28:31], v[180:183], v[200:203], v[28:31]
    s_waitcnt vmcnt(8)
    v_mfma_f32_16x16x32_bf16 v[48:51], v[184:187], v[200:203], v[48:51]
    ds_read_b64_tr_b16 v[162:163], v233 offset:2048
    ds_read_b64_tr_b16 v[166:167], v234 offset:2048
    v_mfma_f32_16x16x32_bf16 v[68:71], v[188:191], v[200:203], v[68:71]
    ds_read_b64_tr_b16 v[170:171], v235 offset:2048
    ds_read_b64_tr_b16 v[174:175], v236 offset:2048
    ds_read_b128 v[200:203], v230 offset:32768
    v_mfma_f32_16x16x32_bf16 v[12:15], v[176:179], v[204:207], v[12:15]
    v_mfma_f32_16x16x32_bf16 v[32:35], v[180:183], v[204:207], v[32:35]
    v_mfma_f32_16x16x32_bf16 v[52:55], v[184:187], v[204:207], v[52:55]
    v_mfma_f32_16x16x32_bf16 v[72:75], v[188:191], v[204:207], v[72:75]
    ds_read_b128 v[204:207], v230 offset:33792
    s_waitcnt lgkmcnt(2)
    s_add_u32 s99, s99, 28672
    s_sub_u32 s77, s99, 458752
    s_cselect_b32 s99, s99, s77
    s_add_u32 s77, s99, 0
    s_add_u32 m0, s76, 2048
    s_nop 0
    buffer_load_dwordx4 v245, s[68:71], s77 offen lds
    buffer_load_dwordx4 v246, s[68:71], s77 offen offset:1024 lds
    v_mfma_f32_16x16x32_bf16 v[16:19], v[176:179], v[208:211], v[16:19]
    v_mfma_f32_16x16x32_bf16 v[36:39], v[180:183], v[208:211], v[36:39]
    v_mfma_f32_16x16x32_bf16 v[56:59], v[184:187], v[208:211], v[56:59]
    v_mfma_f32_16x16x32_bf16 v[76:79], v[188:191], v[208:211], v[76:79]
    ds_read_b128 v[208:211], v230 offset:34816
    s_setprio 1
    s_waitcnt vmcnt(8)
    v_mfma_f32_16x16x32_bf16 v[0:3], v[160:163], v[192:195], v[0:3]
    ds_read_b64_tr_b16 v[176:177], v233 offset:4096
    ds_read_b64_tr_b16 v[180:181], v234 offset:4096
    v_mfma_f32_16x16x32_bf16 v[20:23], v[164:167], v[192:195], v[20:23]
    ds_read_b64_tr_b16 v[184:185], v235 offset:4096
    ds_read_b64_tr_b16 v[188:189], v236 offset:4096
    v_mfma_f32_16x16x32_bf16 v[40:43], v[168:171], v[192:195], v[40:43]
    v_mfma_f32_16x16x32_bf16 v[60:63], v[172:175], v[192:195], v[60:63]
    ds_read_b128 v[192:195], v230 offset:35840
    v_mfma_f32_16x16x32_bf16 v[4:7], v[160:163], v[196:199], v[4:7]
    v_mfma_f32_16x16x32_bf16 v[24:27], v[164:167], v[196:199], v[24:27]
    s_waitcnt lgkmcnt(1)
    s_add_u32 s77, s99, 14336
    s_add_u32 m0, s76, 4096
    s_nop 0
    buffer_load_dwordx4 v245, s[68:71], s77 offen lds
    buffer_load_dwordx4 v246, s[68:71], s77 offen offset:1024 lds
    v_mfma_f32_16x16x32_bf16 v[44:47], v[168:171], v[196:199], v[44:47]
    v_mfma_f32_16x16x32_bf16 v[64:67], v[172:175], v[196:199], v[64:67]
    ds_read_b128 v[196:199], v230 offset:36864
    v_mfma_f32_16x16x32_bf16 v[8:11], v[160:163], v[200:203], v[8:11]
    v_mfma_f32_16x16x32_bf16 v[28:31], v[164:167], v[200:203], v[28:31]
    s_waitcnt vmcnt(8)
    v_mfma_f32_16x16x32_bf16 v[48:51], v[168:171], v[200:203], v[48:51]
    ds_read_b64_tr_b16 v[178:179], v233 offset:6144
    ds_read_b64_tr_b16 v[182:183], v234 offset:6144
    v_mfma_f32_16x16x32_bf16 v[68:71], v[172:175], v[200:203], v[68:71]
    ds_read_b64_tr_b16 v[186:187], v235 offset:6144
    ds_read_b64_tr_b16 v[190:191], v236 offset:6144
    ds_read_b128 v[200:203], v230 offset:37888
    v_mfma_f32_16x16x32_bf16 v[12:15], v[160:163], v[204:207], v[12:15]
    v_mfma_f32_16x16x32_bf16 v[32:35], v[164:167], v[204:207], v[32:35]
    v_mfma_f32_16x16x32_bf16 v[52:55], v[168:171], v[204:207], v[52:55]
    v_mfma_f32_16x16x32_bf16 v[72:75], v[172:175], v[204:207], v[72:75]
    ds_read_b128 v[204:207], v230 offset:38912
    s_waitcnt lgkmcnt(2)
    s_add_u32 s99, s99, 28672
    s_sub_u32 s77, s99, 458752
    s_cselect_b32 s99, s99, s77
    s_add_u32 s77, s99, 0
    s_add_u32 m0, s76, 6144
    s_nop 0
    buffer_load_dwordx4 v245, s[68:71], s77 offen lds
    buffer_load_dwordx4 v246, s[68:71], s77 offen offset:1024 lds
    v_mfma_f32_16x16x32_bf16 v[16:19], v[160:163], v[208:211], v[16:19]
    v_mfma_f32_16x16x32_bf16 v[36:39], v[164:167], v[208:211], v[36:39]
    v_mfma_f32_16x16x32_bf16 v[56:59], v[168:171], v[208:211], v[56:59]
    v_mfma_f32_16x16x32_bf16 v[76:79], v[172:175], v[208:211], v[76:79]
    ds_read_b128 v[208:211], v230 offset:39936
    s_setprio 0
    s_waitcnt vmcnt(8)
    v_mfma_f32_16x16x32_bf16 v[0:3], v[176:179], v[192:195], v[0:3]
    ds_read_b64_tr_b16 v[160:161], v233 offset:8192
    ds_read_b64_tr_b16 v[164:165], v234 offset:8192
    v_mfma_f32_16x16x32_bf16 v[20:23], v[180:183], v[192:195], v[20:23]
    ds_read_b64_tr_b16 v[168:169], v235 offset:8192
    ds_read_b64_tr_b16 v[172:173], v236 offset:8192
    v_mfma_f32_16x16x32_bf16 v[40:43], v[184:187], v[192:195], v[40:43]
    v_mfma_f32_16x16x32_bf16 v[60:63], v[188:191], v[192:195], v[60:63]
    ds_read_b128 v[192:195], v247
    v_mfma_f32_16x16x32_bf16 v[4:7], v[176:179], v[196:199], v[4:7]
    v_mfma_f32_16x16x32_bf16 v[24:27], v[180:183], v[196:199], v[24:27]
    s_waitcnt lgkmcnt(1)
    s_add_u32 s77, s99, 14336
    s_add_u32 m0, s76, 8192
    s_nop 0
    buffer_load_dwordx4 v245, s[68:71], s77 offen lds
    buffer_load_dwordx4 v246, s[68:71], s77 offen offset:1024 lds
    v_mfma_f32_16x16x32_bf16 v[44:47], v[184:187], v[196:199], v[44:47]
    v_mfma_f32_16x16x32_bf16 v[64:67], v[188:191], v[196:199], v[64:67]
    ds_read_b128 v[196:199], v247 offset:1024
    v_mfma_f32_16x16x32_bf16 v[8:11], v[176:179], v[200:203], v[8:11]
    v_mfma_f32_16x16x32_bf16 v[28:31], v[180:183], v[200:203], v[28:31]
    s_waitcnt vmcnt(8)
    v_mfma_f32_16x16x32_bf16 v[48:51], v[184:187], v[200:203], v[48:51]
    ds_read_b64_tr_b16 v[162:163], v233
    ds_read_b64_tr_b16 v[166:167], v234
    v_mfma_f32_16x16x32_bf16 v[68:71], v[188:191], v[200:203], v[68:71]
    ds_read_b64_tr_b16 v[170:171], v235
    ds_read_b64_tr_b16 v[174:175], v236
    ds_read_b128 v[200:203], v247 offset:2048
    v_mfma_f32_16x16x32_bf16 v[12:15], v[176:179], v[204:207], v[12:15]
    v_mfma_f32_16x16x32_bf16 v[32:35], v[180:183], v[204:207], v[32:35]
    v_mfma_f32_16x16x32_bf16 v[52:55], v[184:187], v[204:207], v[52:55]
    v_mfma_f32_16x16x32_bf16 v[72:75], v[188:191], v[204:207], v[72:75]
    ds_read_b128 v[204:207], v247 offset:3072
    s_waitcnt lgkmcnt(2)
    s_add_u32 s99, s99, 28672
    s_sub_u32 s77, s99, 458752
    s_cselect_b32 s99, s99, s77
    s_add_u32 s77, s99, 0
    s_add_u32 m0, s76, 0
    s_nop 0
    buffer_load_dwordx4 v245, s[68:71], s77 offen lds
    buffer_load_dwordx4 v246, s[68:71], s77 offen offset:1024 lds
    v_mfma_f32_16x16x32_bf16 v[16:19], v[176:179], v[208:211], v[16:19]
    v_mfma_f32_16x16x32_bf16 v[36:39], v[180:183], v[208:211], v[36:39]
    v_mfma_f32_16x16x32_bf16 v[56:59], v[184:187], v[208:211], v[56:59]
    v_mfma_f32_16x16x32_bf16 v[76:79], v[188:191], v[208:211], v[76:79]
    ds_read_b128 v[208:211], v247 offset:4096
    s_setprio 3
    s_waitcnt vmcnt(8)
    s_barrier
    v_mfma_f32_16x16x32_bf16 v[0:3], v[160:163], v[192:195], v[0:3]
    ds_read_b64_tr_b16 v[176:177], v233 offset:2048
    ds_read_b64_tr_b16 v[180:181], v234 offset:2048
    v_mfma_f32_16x16x32_bf16 v[20:23], v[164:167], v[192:195], v[20:23]
    ds_read_b64_tr_b16 v[184:185], v235 offset:2048
    ds_read_b64_tr_b16 v[188:189], v236 offset:2048
    v_mfma_f32_16x16x32_bf16 v[40:43], v[168:171], v[192:195], v[40:43]
    v_mfma_f32_16x16x32_bf16 v[60:63], v[172:175], v[192:195], v[60:63]
    ds_read_b128 v[192:195], v247 offset:5120
    v_mfma_f32_16x16x32_bf16 v[4:7], v[160:163], v[196:199], v[4:7]
    v_mfma_f32_16x16x32_bf16 v[24:27], v[164:167], v[196:199], v[24:27]
    s_waitcnt lgkmcnt(1)
    s_add_u32 s77, s99, 14336
    s_add_u32 m0, s76, 2048
    s_nop 0
    buffer_load_dwordx4 v245, s[68:71], s77 offen lds
    buffer_load_dwordx4 v246, s[68:71], s77 offen offset:1024 lds
    v_mfma_f32_16x16x32_bf16 v[44:47], v[168:171], v[196:199], v[44:47]
    v_mfma_f32_16x16x32_bf16 v[64:67], v[172:175], v[196:199], v[64:67]
    ds_read_b128 v[196:199], v247 offset:6144
    v_mfma_f32_16x16x32_bf16 v[8:11], v[160:163], v[200:203], v[8:11]
    s_cmp_eq_u32 s92, 1
    s_cbranch_scc1 L_sk67
    ds_write_b128 v229, v[80:83] offset:0
L_sk67:
    v_mfma_f32_16x16x32_bf16 v[28:31], v[164:167], v[200:203], v[28:31]
    s_waitcnt vmcnt(8)
    v_mfma_f32_16x16x32_bf16 v[48:51], v[168:171], v[200:203], v[48:51]
    ds_read_b64_tr_b16 v[178:179], v233 offset:4096
    ds_read_b64_tr_b16 v[182:183], v234 offset:4096
    v_mfma_f32_16x16x32_bf16 v[68:71], v[172:175], v[200:203], v[68:71]
    ds_read_b64_tr_b16 v[186:187], v235 offset:4096
    ds_read_b64_tr_b16 v[190:191], v236 offset:4096
    ds_read_b128 v[200:203], v247 offset:7168
    v_mfma_f32_16x16x32_bf16 v[12:15], v[160:163], v[204:207], v[12:15]
    v_mfma_f32_16x16x32_bf16 v[32:35], v[164:167], v[204:207], v[32:35]
    v_mfma_f32_16x16x32_bf16 v[52:55], v[168:171], v[204:207], v[52:55]
    v_mfma_f32_16x16x32_bf16 v[72:75], v[172:175], v[204:207], v[72:75]
    ds_read_b128 v[204:207], v247 offset:8192
    s_waitcnt lgkmcnt(2)
    s_add_u32 s99, s99, 28672
    s_sub_u32 s77, s99, 458752
    s_cselect_b32 s99, s99, s77
    s_add_u32 s77, s99, 0
    s_add_u32 m0, s76, 4096
    s_nop 0
    buffer_load_dwordx4 v245, s[68:71], s77 offen lds
    buffer_load_dwordx4 v246, s[68:71], s77 offen offset:1024 lds
    v_mfma_f32_16x16x32_bf16 v[16:19], v[160:163], v[208:211], v[16:19]
    v_mfma_f32_16x16x32_bf16 v[36:39], v[164:167], v[208:211], v[36:39]
    v_mfma_f32_16x16x32_bf16 v[56:59], v[168:171], v[208:211], v[56:59]
    s_cmp_eq_u32 s92, 1
    s_cbranch_scc1 L_sk68
    ds_write_b128 v229, v[84:87] offset:4096
L_sk68:
    v_mfma_f32_16x16x32_bf16 v[76:79], v[172:175], v[208:211], v[76:79]
    ds_read_b128 v[208:211], v247 offset:9216
    s_setprio 2
    s_waitcnt vmcnt(8)
    v_mfma_f32_16x16x32_bf16 v[0:3], v[176:179], v[192:195], v[0:3]
    ds_read_b64_tr_b16 v[160:161], v233 offset:6144
    ds_read_b64_tr_b16 v[164:165], v234 offset:6144
    v_mfma_f32_16x16x32_bf16 v[20:23], v[180:183], v[192:195], v[20:23]
    ds_read_b64_tr_b16 v[168:169], v235 offset:6144
    ds_read_b64_tr_b16 v[172:173], v236 offset:6144
    v_mfma_f32_16x16x32_bf16 v[40:43], v[184:187], v[192:195], v[40:43]
    v_mfma_f32_16x16x32_bf16 v[60:63], v[188:191], v[192:195], v[60:63]
    ds_read_b128 v[192:195], v247 offset:10240
    v_mfma_f32_16x16x32_bf16 v[4:7], v[176:179], v[196:199], v[4:7]
    v_mfma_f32_16x16x32_bf16 v[24:27], v[180:183], v[196:199], v[24:27]
    s_waitcnt lgkmcnt(1)
    s_add_u32 s77, s99, 14336
    s_add_u32 m0, s76, 6144
    s_nop 0
    buffer_load_dwordx4 v245, s[68:71], s77 offen lds
    buffer_load_dwordx4 v246, s[68:71], s77 offen offset:1024 lds
    v_mfma_f32_16x16x32_bf16 v[44:47], v[184:187], v[196:199], v[44:47]
    v_mfma_f32_16x16x32_bf16 v[64:67], v[188:191], v[196:199], v[64:67]
    ds_read_b128 v[196:199], v247 offset:11264
    v_mfma_f32_16x16x32_bf16 v[8:11], v[176:179], v[200:203], v[8:11]
    s_cmp_eq_u32 s92, 1
    s_cbranch_scc1 L_sk69
    ds_write_b128 v229, v[88:91] offset:8192
L_sk69:
    v_mfma_f32_16x16x32_bf16 v[28:31], v[180:183], v[200:203], v[28:31]
    s_waitcnt vmcnt(8)
    v_mfma_f32_16x16x32_bf16 v[48:51], v[184:187], v[200:203], v[48:51]
    ds_read_b64_tr_b16 v[162:163], v233 offset:8192
    ds_read_b64_tr_b16 v[166:167], v234 offset:8192
    v_mfma_f32_16x16x32_bf16 v[68:71], v[188:191], v[200:203], v[68:71]
    ds_read_b64_tr_b16 v[170:171], v235 offset:8192
    ds_read_b64_tr_b16 v[174:175], v236 offset:8192
    ds_read_b128 v[200:203], v247 offset:12288
    v_mfma_f32_16x16x32_bf16 v[12:15], v[176:179], v[204:207], v[12:15]
    v_mfma_f32_16x16x32_bf16 v[32:35], v[180:183], v[204:207], v[32:35]
    v_mfma_f32_16x16x32_bf16 v[52:55], v[184:187], v[204:207], v[52:55]
    v_mfma_f32_16x16x32_bf16 v[72:75], v[188:191], v[204:207], v[72:75]
    ds_read_b128 v[204:207], v247 offset:13312
    s_waitcnt lgkmcnt(2)
    s_add_u32 s99, s99, 28672
    s_sub_u32 s77, s99, 458752
    s_cselect_b32 s99, s99, s77
    s_add_u32 s77, s99, 0
    s_add_u32 m0, s76, 8192
    s_nop 0
    buffer_load_dwordx4 v245, s[68:71], s77 offen lds
    buffer_load_dwordx4 v246, s[68:71], s77 offen offset:1024 lds
    v_mfma_f32_16x16x32_bf16 v[16:19], v[176:179], v[208:211], v[16:19]
    v_mfma_f32_16x16x32_bf16 v[36:39], v[180:183], v[208:211], v[36:39]
    v_mfma_f32_16x16x32_bf16 v[56:59], v[184:187], v[208:211], v[56:59]
    s_cmp_eq_u32 s92, 1
    s_cbranch_scc1 L_sk70
    ds_write_b128 v229, v[92:95] offset:12288
L_sk70:
    v_mfma_f32_16x16x32_bf16 v[76:79], v[188:191], v[208:211], v[76:79]
    ds_read_b128 v[208:211], v247 offset:14336
    s_setprio 1
    s_waitcnt vmcnt(8)
    v_mfma_f32_16x16x32_bf16 v[0:3], v[160:163], v[192:195], v[0:3]
    ds_read_b64_tr_b16 v[176:177], v233
    ds_read_b64_tr_b16 v[180:181], v234
    v_mfma_f32_16x16x32_bf16 v[20:23], v[164:167], v[192:195], v[20:23]
    ds_read_b64_tr_b16 v[184:185], v235
    ds_read_b64_tr_b16 v[188:189], v236
    v_mfma_f32_16x16x32_bf16 v[40:43], v[168:171], v[192:195], v[40:43]
    v_mfma_f32_16x16x32_bf16 v[60:63], v[172:175], v[192:195], v[60:63]
    ds_read_b128 v[192:195], v247 offset:15360
    v_mfma_f32_16x16x32_bf16 v[4:7], v[160:163], v[196:199], v[4:7]
    v_mfma_f32_16x16x32_bf16 v[24:27], v[164:167], v[196:199], v[24:27]
    s_waitcnt lgkmcnt(1)
    s_add_u32 s77, s99, 14336
    s_add_u32 m0, s76, 0
    s_nop 0
    buffer_load_dwordx4 v245, s[68:71], s77 offen lds
    buffer_load_dwordx4 v246, s[68:71], s77 offen offset:1024 lds
    v_mfma_f32_16x16x32_bf16 v[44:47], v[168:171], v[196:199], v[44:47]
    v_mfma_f32_16x16x32_bf16 v[64:67], v[172:175], v[196:199], v[64:67]
    ds_read_b128 v[196:199], v247 offset:16384
    v_mfma_f32_16x16x32_bf16 v[8:11], v[160:163], v[200:203], v[8:11]
    s_cmp_eq_u32 s92, 1
    s_cbranch_scc1 L_sk71
    ds_write_b128 v229, v[96:99] offset:16384
L_sk71:
    v_mfma_f32_16x16x32_bf16 v[28:31], v[164:167], v[200:203], v[28:31]
    s_waitcnt vmcnt(8)
    v_mfma_f32_16x16x32_bf16 v[48:51], v[168:171], v[200:203], v[48:51]
    ds_read_b64_tr_b16 v[178:179], v233 offset:2048
    ds_read_b64_tr_b16 v[182:183], v234 offset:2048
    v_mfma_f32_16x16x32_bf16 v[68:71], v[172:175], v[200:203], v[68:71]
    ds_read_b64_tr_b16 v[186:187], v235 offset:2048
    ds_read_b64_tr_b16 v[190:191], v236 offset:2048
    ds_read_b128 v[200:203], v247 offset:17408
    v_mfma_f32_16x16x32_bf16 v[12:15], v[160:163], v[204:207], v[12:15]
    v_mfma_f32_16x16x32_bf16 v[32:35], v[164:167], v[204:207], v[32:35]
    v_mfma_f32_16x16x32_bf16 v[52:55], v[168:171], v[204:207], v[52:55]
    v_mfma_f32_16x16x32_bf16 v[72:75], v[172:175], v[204:207], v[72:75]
    ds_read_b128 v[204:207], v247 offset:18432
    s_waitcnt lgkmcnt(2)
    s_add_u32 s99, s99, 28672
    s_sub_u32 s77, s99, 458752
    s_cselect_b32 s99, s99, s77
    s_add_u32 s77, s99, 0
    s_add_u32 m0, s76, 2048
    s_nop 0
    buffer_load_dwordx4 v245, s[68:71], s77 offen lds
    buffer_load_dwordx4 v246, s[68:71], s77 offen offset:1024 lds
    v_mfma_f32_16x16x32_bf16 v[16:19], v[160:163], v[208:211], v[16:19]
    v_mfma_f32_16x16x32_bf16 v[36:39], v[164:167], v[208:211], v[36:39]
    v_mfma_f32_16x16x32_bf16 v[56:59], v[168:171], v[208:211], v[56:59]
    v_mfma_f32_16x16x32_bf16 v[76:79], v[172:175], v[208:211], v[76:79]
    ds_read_b128 v[208:211], v247 offset:19456
    s_setprio 0
    s_waitcnt vmcnt(8)
    v_mfma_f32_16x16x32_bf16 v[0:3], v[176:179], v[192:195], v[0:3]
    ds_read_b64_tr_b16 v[160:161], v233 offset:4096
    ds_read_b64_tr_b16 v[164:165], v234 offset:4096
    v_mfma_f32_16x16x32_bf16 v[20:23], v[180:183], v[192:195], v[20:23]
    ds_read_b64_tr_b16 v[168:169], v235 offset:4096
    ds_read_b64_tr_b16 v[172:173], v236 offset:4096
    v_mfma_f32_16x16x32_bf16 v[40:43], v[184:187], v[192:195], v[40:43]
    v_mfma_f32_16x16x32_bf16 v[60:63], v[188:191], v[192:195], v[60:63]
    ds_read_b128 v[192:195], v247 offset:20480
    v_mfma_f32_16x16x32_bf16 v[4:7], v[176:179], v[196:199], v[4:7]
    v_mfma_f32_16x16x32_bf16 v[24:27], v[180:183], v[196:199], v[24:27]
    s_waitcnt lgkmcnt(1)
    s_add_u32 s77, s99, 14336
    s_add_u32 m0, s76, 4096
    s_nop 0
    buffer_load_dwordx4 v245, s[68:71], s77 offen lds
    buffer_load_dwordx4 v246, s[68:71], s77 offen offset:1024 lds
    v_mfma_f32_16x16x32_bf16 v[44:47], v[184:187], v[196:199], v[44:47]
    v_mfma_f32_16x16x32_bf16 v[64:67], v[188:191], v[196:199], v[64:67]
    ds_read_b128 v[196:199], v247 offset:21504
    v_mfma_f32_16x16x32_bf16 v[8:11], v[176:179], v[200:203], v[8:11]
    v_mfma_f32_16x16x32_bf16 v[28:31], v[180:183], v[200:203], v[28:31]
    s_waitcnt vmcnt(8)
    v_mfma_f32_16x16x32_bf16 v[48:51], v[184:187], v[200:203], v[48:51]
    ds_read_b64_tr_b16 v[162:163], v233 offset:6144
    ds_read_b64_tr_b16 v[166:167], v234 offset:6144
    v_mfma_f32_16x16x32_bf16 v[68:71], v[188:191], v[200:203], v[68:71]
    ds_read_b64_tr_b16 v[170:171], v235 offset:6144
    ds_read_b64_tr_b16 v[174:175], v236 offset:6144
    ds_read_b128 v[200:203], v247 offset:22528
    v_mfma_f32_16x16x32_bf16 v[12:15], v[176:179], v[204:207], v[12:15]
    v_mfma_f32_16x16x32_bf16 v[32:35], v[180:183], v[204:207], v[32:35]
    v_mfma_f32_16x16x32_bf16 v[52:55], v[184:187], v[204:207], v[52:55]
    v_mfma_f32_16x16x32_bf16 v[72:75], v[188:191], v[204:207], v[72:75]
    ds_read_b128 v[204:207], v247 offset:23552
    s_waitcnt lgkmcnt(2)
    s_add_u32 s99, s99, 28672
    s_sub_u32 s77, s99, 458752
    s_cselect_b32 s99, s99, s77
    s_add_u32 s77, s99, 0
    s_add_u32 m0, s76, 6144
    s_nop 0
    buffer_load_dwordx4 v245, s[68:71], s77 offen lds
    buffer_load_dwordx4 v246, s[68:71], s77 offen offset:1024 lds
    v_mfma_f32_16x16x32_bf16 v[16:19], v[176:179], v[208:211], v[16:19]
    v_mfma_f32_16x16x32_bf16 v[36:39], v[180:183], v[208:211], v[36:39]
    v_mfma_f32_16x16x32_bf16 v[56:59], v[184:187], v[208:211], v[56:59]
    v_mfma_f32_16x16x32_bf16 v[76:79], v[188:191], v[208:211], v[76:79]
    ds_read_b128 v[208:211], v247 offset:24576
    s_setprio 3
    s_waitcnt vmcnt(8)
    v_mfma_f32_16x16x32_bf16 v[0:3], v[160:163], v[192:195], v[0:3]
    ds_read_b64_tr_b16 v[176:177], v233 offset:8192
    ds_read_b64_tr_b16 v[180:181], v234 offset:8192
    v_mfma_f32_16x16x32_bf16 v[20:23], v[164:167], v[192:195], v[20:23]
    ds_read_b64_tr_b16 v[184:185], v235 offset:8192
    ds_read_b64_tr_b16 v[188:189], v236 offset:8192
    v_mfma_f32_16x16x32_bf16 v[40:43], v[168:171], v[192:195], v[40:43]
    v_mfma_f32_16x16x32_bf16 v[60:63], v[172:175], v[192:195], v[60:63]
    ds_read_b128 v[192:195], v247 offset:25600
    v_mfma_f32_16x16x32_bf16 v[4:7], v[160:163], v[196:199], v[4:7]
    v_mfma_f32_16x16x32_bf16 v[24:27], v[164:167], v[196:199], v[24:27]
    s_waitcnt lgkmcnt(1)
    s_add_u32 s77, s99, 14336
    s_add_u32 m0, s76, 8192
    s_nop 0
    buffer_load_dwordx4 v245, s[68:71], s77 offen lds
    buffer_load_dwordx4 v246, s[68:71], s77 offen offset:1024 lds
    v_mfma_f32_16x16x32_bf16 v[44:47], v[168:171], v[196:199], v[44:47]
    v_mfma_f32_16x16x32_bf16 v[64:67], v[172:175], v[196:199], v[64:67]
    ds_read_b128 v[196:199], v247 offset:26624
    v_mfma_f32_16x16x32_bf16 v[8:11], v[160:163], v[200:203], v[8:11]
    v_mfma_f32_16x16x32_bf16 v[28:31], v[164:167], v[200:203], v[28:31]
    s_waitcnt vmcnt(8)
    v_mfma_f32_16x16x32_bf16 v[48:51], v[168:171], v[200:203], v[48:51]
    ds_read_b64_tr_b16 v[178:179], v233
    ds_read_b64_tr_b16 v[182:183], v234
    v_mfma_f32_16x16x32_bf16 v[68:71], v[172:175], v[200:203], v[68:71]
    ds_read_b64_tr_b16 v[186:187], v235
    ds_read_b64_tr_b16 v[190:191], v236
    ds_read_b128 v[200:203], v247 offset:27648
    v_mfma_f32_16x16x32_bf16 v[12:15], v[160:163], v[204:207], v[12:15]
    v_mfma_f32_16x16x32_bf16 v[32:35], v[164:167], v[204:207], v[32:35]
    v_mfma_f32_16x16x32_bf16 v[52:55], v[168:171], v[204:207], v[52:55]
    v_mfma_f32_16x16x32_bf16 v[72:75], v[172:175], v[204:207], v[72:75]
    ds_read_b128 v[204:207], v247 offset:28672
    s_waitcnt lgkmcnt(2)
    s_add_u32 s98, s98, 262144
    s_sub_u32 s77, s98, 3670016
    s_cselect_b32 s98, s98, s77
    s_add_u32 s77, s98, 0
    s_add_u32 m0, s76, 0
    s_nop 0
    buffer_load_dwordx4 v243, s[32:35], s77 offen lds
    buffer_load_dwordx4 v244, s[32:35], s77 offen offset:1024 lds
    v_mfma_f32_16x16x32_bf16 v[16:19], v[160:163], v[208:211], v[16:19]
    v_mfma_f32_16x16x32_bf16 v[36:39], v[164:167], v[208:211], v[36:39]
    v_mfma_f32_16x16x32_bf16 v[56:59], v[168:171], v[208:211], v[56:59]
    v_mfma_f32_16x16x32_bf16 v[76:79], v[172:175], v[208:211], v[76:79]
    ds_read_b128 v[208:211], v247 offset:29696
    s_setprio 2
    s_waitcnt vmcnt(8)
    s_barrier
    v_mfma_f32_16x16x32_bf16 v[0:3], v[176:179], v[192:195], v[0:3]
    ds_read_b64_tr_b16 v[160:161], v233 offset:2048
    ds_read_b64_tr_b16 v[164:165], v234 offset:2048
    v_mfma_f32_16x16x32_bf16 v[20:23], v[180:183], v[192:195], v[20:23]
    ds_read_b64_tr_b16 v[168:169], v235 offset:2048
    ds_read_b64_tr_b16 v[172:173], v236 offset:2048
    v_mfma_f32_16x16x32_bf16 v[40:43], v[184:187], v[192:195], v[40:43]
    v_mfma_f32_16x16x32_bf16 v[60:63], v[188:191], v[192:195], v[60:63]
    ds_read_b128 v[192:195], v247 offset:30720
    v_mfma_f32_16x16x32_bf16 v[4:7], v[176:179], v[196:199], v[4:7]
    v_mfma_f32_16x16x32_bf16 v[24:27], v[180:183], v[196:199], v[24:27]
    s_waitcnt lgkmcnt(1)
    s_add_u32 s77, s98, 32768
    s_add_u32 m0, s76, 2048
    s_nop 0
    buffer_load_dwordx4 v243, s[32:35], s77 offen lds
    buffer_load_dwordx4 v244, s[32:35], s77 offen offset:1024 lds
    v_mfma_f32_16x16x32_bf16 v[44:47], v[184:187], v[196:199], v[44:47]
    v_mfma_f32_16x16x32_bf16 v[64:67], v[188:191], v[196:199], v[64:67]
    ds_read_b128 v[196:199], v247 offset:31744
    v_mfma_f32_16x16x32_bf16 v[8:11], v[176:179], v[200:203], v[8:11]
    v_mfma_f32_16x16x32_bf16 v[28:31], v[180:183], v[200:203], v[28:31]
    s_waitcnt vmcnt(8)
    v_mfma_f32_16x16x32_bf16 v[48:51], v[184:187], v[200:203], v[48:51]
    ds_read_b64_tr_b16 v[162:163], v233 offset:4096
    ds_read_b64_tr_b16 v[166:167], v234 offset:4096
    v_mfma_f32_16x16x32_bf16 v[68:71], v[188:191], v[200:203], v[68:71]
    ds_read_b64_tr_b16 v[170:171], v235 offset:4096
    ds_read_b64_tr_b16 v[174:175], v236 offset:4096
    ds_read_b128 v[200:203], v247 offset:32768
    v_mfma_f32_16x16x32_bf16 v[12:15], v[176:179], v[204:207], v[12:15]
    v_mfma_f32_16x16x32_bf16 v[32:35], v[180:183], v[204:207], v[32:35]
    v_mfma_f32_16x16x32_bf16 v[52:55], v[184:187], v[204:207], v[52:55]
    v_mfma_f32_16x16x32_bf16 v[72:75], v[188:191], v[204:207], v[72:75]
    ds_read_b128 v[204:207], v247 offset:33792
    s_waitcnt lgkmcnt(2)
    s_add_u32 s98, s98, 262144
    s_sub_u32 s77, s98, 3670016
    s_cselect_b32 s98, s98, s77
    s_add_u32 s77, s98, 0
    s_add_u32 m0, s76, 4096
    s_nop 0
    buffer_load_dwordx4 v243, s[32:35], s77 offen lds
    buffer_load_dwordx4 v244, s[32:35], s77 offen offset:1024 lds
    v_mfma_f32_16x16x32_bf16 v[16:19], v[176:179], v[208:211], v[16:19]
    v_mfma_f32_16x16x32_bf16 v[36:39], v[180:183], v[208:211], v[36:39]
    v_mfma_f32_16x16x32_bf16 v[56:59], v[184:187], v[208:211], v[56:59]
    v_mfma_f32_16x16x32_bf16 v[76:79], v[188:191], v[208:211], v[76:79]
    ds_read_b128 v[208:211], v247 offset:34816
    s_setprio 1
    s_waitcnt vmcnt(8)
    v_mfma_f32_16x16x32_bf16 v[0:3], v[160:163], v[192:195], v[0:3]
    ds_read_b64_tr_b16 v[176:177], v233 offset:6144
    ds_read_b64_tr_b16 v[180:181], v234 offset:6144
    v_mfma_f32_16x16x32_bf16 v[20:23], v[164:167], v[192:195], v[20:23]
    ds_read_b64_tr_b16 v[184:185], v235 offset:6144
    ds_read_b64_tr_b16 v[188:189], v236 offset:6144
    v_mfma_f32_16x16x32_bf16 v[40:43], v[168:171], v[192:195], v[40:43]
    v_mfma_f32_16x16x32_bf16 v[60:63], v[172:175], v[192:195], v[60:63]
    ds_read_b128 v[192:195], v247 offset:35840
    v_mfma_f32_16x16x32_bf16 v[4:7], v[160:163], v[196:199], v[4:7]
    v_mfma_f32_16x16x32_bf16 v[24:27], v[164:167], v[196:199], v[24:27]
    s_waitcnt lgkmcnt(1)
    s_add_u32 s77, s98, 32768
    s_add_u32 m0, s76, 6144
    s_nop 0
    buffer_load_dwordx4 v243, s[32:35], s77 offen lds
    buffer_load_dwordx4 v244, s[32:35], s77 offen offset:1024 lds
    v_mfma_f32_16x16x32_bf16 v[44:47], v[168:171], v[196:199], v[44:47]
    v_mfma_f32_16x16x32_bf16 v[64:67], v[172:175], v[196:199], v[64:67]
    ds_read_b128 v[196:199], v247 offset:36864
    v_mfma_f32_16x16x32_bf16 v[8:11], v[160:163], v[200:203], v[8:11]
    v_mfma_f32_16x16x32_bf16 v[28:31], v[164:167], v[200:203], v[28:31]
    s_waitcnt vmcnt(8)
    v_mfma_f32_16x16x32_bf16 v[48:51], v[168:171], v[200:203], v[48:51]
    ds_read_b64_tr_b16 v[178:179], v233 offset:8192
    ds_read_b64_tr_b16 v[182:183], v234 offset:8192
    v_mfma_f32_16x16x32_bf16 v[68:71], v[172:175], v[200:203], v[68:71]
    ds_read_b64_tr_b16 v[186:187], v235 offset:8192
    ds_read_b64_tr_b16 v[190:191], v236 offset:8192
    ds_read_b128 v[200:203], v247 offset:37888
    v_mfma_f32_16x16x32_bf16 v[12:15], v[160:163], v[204:207], v[12:15]
    v_mfma_f32_16x16x32_bf16 v[32:35], v[164:167], v[204:207], v[32:35]
    v_mfma_f32_16x16x32_bf16 v[52:55], v[168:171], v[204:207], v[52:55]
    v_mfma_f32_16x16x32_bf16 v[72:75], v[172:175], v[204:207], v[72:75]
    ds_read_b128 v[204:207], v247 offset:38912
    s_waitcnt lgkmcnt(2)
    s_add_u32 s98, s98, 262144
    s_sub_u32 s77, s98, 3670016
    s_cselect_b32 s98, s98, s77
    s_add_u32 s77, s98, 0
    s_add_u32 m0, s76, 8192
    s_nop 0
    buffer_load_dwordx4 v243, s[32:35], s77 offen lds
    buffer_load_dwordx4 v244, s[32:35], s77 offen offset:1024 lds
    v_mfma_f32_16x16x32_bf16 v[16:19], v[160:163], v[208:211], v[16:19]
    v_mfma_f32_16x16x32_bf16 v[36:39], v[164:167], v[208:211], v[36:39]
    v_mfma_f32_16x16x32_bf16 v[56:59], v[168:171], v[208:211], v[56:59]
    v_mfma_f32_16x16x32_bf16 v[76:79], v[172:175], v[208:211], v[76:79]
    ds_read_b128 v[208:211], v247 offset:39936
    s_setprio 0
    s_waitcnt vmcnt(8)
    v_mfma_f32_16x16x32_bf16 v[0:3], v[176:179], v[192:195], v[0:3]
    ds_read_b64_tr_b16 v[160:161], v233
    ds_read_b64_tr_b16 v[164:165], v234
    v_mfma_f32_16x16x32_bf16 v[20:23], v[180:183], v[192:195], v[20:23]
    ds_read_b64_tr_b16 v[168:169], v235
    ds_read_b64_tr_b16 v[172:173], v236
    v_mfma_f32_16x16x32_bf16 v[40:43], v[184:187], v[192:195], v[40:43]
    v_mfma_f32_16x16x32_bf16 v[60:63], v[188:191], v[192:195], v[60:63]
    ds_read_b128 v[192:195], v237
    v_mfma_f32_16x16x32_bf16 v[4:7], v[176:179], v[196:199], v[4:7]
    v_mfma_f32_16x16x32_bf16 v[24:27], v[180:183], v[196:199], v[24:27]
    s_waitcnt lgkmcnt(1)
    s_add_u32 s77, s98, 32768
    s_add_u32 m0, s76, 0
    s_nop 0
    buffer_load_dwordx4 v243, s[32:35], s77 offen lds
    buffer_load_dwordx4 v244, s[32:35], s77 offen offset:1024 lds
    v_mfma_f32_16x16x32_bf16 v[44:47], v[184:187], v[196:199], v[44:47]
    v_mfma_f32_16x16x32_bf16 v[64:67], v[188:191], v[196:199], v[64:67]
    ds_read_b128 v[196:199], v237 offset:4096
    v_cvt_pk_bf16_f32 v120, v0, v1
    v_cvt_pk_bf16_f32 v121, v2, v3
    v_cvt_pk_bf16_f32 v122, v20, v21
    v_mfma_f32_16x16x32_bf16 v[8:11], v[176:179], v[200:203], v[8:11]
    v_cvt_pk_bf16_f32 v123, v22, v23
    v_cvt_pk_bf16_f32 v140, v40, v41
    v_cvt_pk_bf16_f32 v141, v42, v43
    v_mfma_f32_16x16x32_bf16 v[28:31], v[180:183], v[200:203], v[28:31]
    v_cvt_pk_bf16_f32 v142, v60, v61
    v_cvt_pk_bf16_f32 v143, v62, v63
    s_waitcnt vmcnt(8)
    v_mfma_f32_16x16x32_bf16 v[48:51], v[184:187], v[200:203], v[48:51]
    ds_read_b64_tr_b16 v[162:163], v233 offset:2048
    ds_read_b64_tr_b16 v[166:167], v234 offset:2048
    v_mfma_f32_16x16x32_bf16 v[68:71], v[188:191], v[200:203], v[68:71]
    ds_read_b64_tr_b16 v[170:171], v235 offset:2048
    ds_read_b64_tr_b16 v[174:175], v236 offset:2048
    ds_read_b128 v[200:203], v237 offset:8192
    v_cvt_pk_bf16_f32 v124, v4, v5
    v_cvt_pk_bf16_f32 v125, v6, v7
    v_cvt_pk_bf16_f32 v126, v24, v25
    v_mfma_f32_16x16x32_bf16 v[12:15], v[176:179], v[204:207], v[12:15]
    v_cvt_pk_bf16_f32 v127, v26, v27
    v_cvt_pk_bf16_f32 v144, v44, v45
    v_cvt_pk_bf16_f32 v145, v46, v47
    v_mfma_f32_16x16x32_bf16 v[32:35], v[180:183], v[204:207], v[32:35]
    v_cvt_pk_bf16_f32 v146, v64, v65
    v_cvt_pk_bf16_f32 v147, v66, v67
    v_mfma_f32_16x16x32_bf16 v[52:55], v[184:187], v[204:207], v[52:55]
    v_mfma_f32_16x16x32_bf16 v[72:75], v[188:191], v[204:207], v[72:75]
    ds_read_b128 v[204:207], v237 offset:12288
    s_waitcnt lgkmcnt(2)
    s_add_u32 s98, s98, 262144
    s_sub_u32 s77, s98, 3670016
    s_cselect_b32 s98, s98, s77
    s_add_u32 s77, s98, 0
    s_add_u32 m0, s76, 2048
    s_nop 0
    buffer_load_dwordx4 v243, s[32:35], s77 offen lds
    buffer_load_dwordx4 v244, s[32:35], s77 offen offset:1024 lds
    v_cvt_pk_bf16_f32 v128, v8, v9
    v_cvt_pk_bf16_f32 v129, v10, v11
    v_cvt_pk_bf16_f32 v130, v28, v29
    v_mfma_f32_16x16x32_bf16 v[16:19], v[176:179], v[208:211], v[16:19]
    v_cvt_pk_bf16_f32 v131, v30, v31
    v_cvt_pk_bf16_f32 v148, v48, v49
    v_cvt_pk_bf16_f32 v149, v50, v51
    v_mfma_f32_16x16x32_bf16 v[36:39], v[180:183], v[208:211], v[36:39]
    v_cvt_pk_bf16_f32 v150, v68, v69
    v_cvt_pk_bf16_f32 v151, v70, v71
    v_mfma_f32_16x16x32_bf16 v[56:59], v[184:187], v[208:211], v[56:59]
    v_mfma_f32_16x16x32_bf16 v[76:79], v[188:191], v[208:211], v[76:79]
    ds_read_b128 v[208:211], v237 offset:16384
    v_cvt_pk_bf16_f32 v132, v12, v13
    v_cvt_pk_bf16_f32 v133, v14, v15
    v_cvt_pk_bf16_f32 v134, v32, v33
    v_cvt_pk_bf16_f32 v135, v34, v35
    v_cvt_pk_bf16_f32 v152, v52, v53
    v_cvt_pk_bf16_f32 v153, v54, v55
    v_cvt_pk_bf16_f32 v154, v72, v73
    v_cvt_pk_bf16_f32 v155, v74, v75
    v_cvt_pk_bf16_f32 v136, v16, v17
    v_cvt_pk_bf16_f32 v137, v18, v19
    v_cvt_pk_bf16_f32 v138, v36, v37
    v_cvt_pk_bf16_f32 v139, v38, v39
    v_cvt_pk_bf16_f32 v156, v56, v57
    v_cvt_pk_bf16_f32 v157, v58, v59
    v_cvt_pk_bf16_f32 v158, v76, v77
    v_cvt_pk_bf16_f32 v159, v78, v79
L_oend1:
    s_mov_b64 s[44:45], s[74:75]
    s_mov_b32 s46, 71680
    s_add_u32 s92, s92, 1
    s_cmp_eq_u32 s92, 2
    s_cbranch_scc1 L_final
    s_branch L_body0
L_final:
    s_add_u32 s88, s82, 0
    buffer_store_dwordx4 v[120:123], v230, s[44:47], s88 offen sc1
    s_add_u32 s88, s82, 1024
    buffer_store_dwordx4 v[124:127], v230, s[44:47], s88 offen sc1
    s_add_u32 s88, s82, 2048
    buffer_store_dwordx4 v[128:131], v230, s[44:47], s88 offen sc1
    s_add_u32 s88, s82, 3072
    buffer_store_dwordx4 v[132:135], v230, s[44:47], s88 offen sc1
    s_add_u32 s88, s82, 4096
    buffer_store_dwordx4 v[136:139], v230, s[44:47], s88 offen sc1
    s_add_u32 s88, s82, 5120
    buffer_store_dwordx4 v[140:143], v230, s[44:47], s88 offen sc1
    s_add_u32 s88, s82, 6144
    buffer_store_dwordx4 v[144:147], v230, s[44:47], s88 offen sc1
    s_add_u32 s88, s82, 7168
    buffer_store_dwordx4 v[148:151], v230, s[44:47], s88 offen sc1
    s_add_u32 s88, s82, 8192
    buffer_store_dwordx4 v[152:155], v230, s[44:47], s88 offen sc1
    s_add_u32 s88, s82, 9216
    buffer_store_dwordx4 v[156:159], v230, s[44:47], s88 offen sc1
L_attn_done:
    s_endpgm
.globl reduce_kernel
.p2align 8
.type reduce_kernel,@function
reduce_kernel:
    s_cmp_ge_u32 s2, 2240
    s_cbranch_scc1 L_red_done
    s_load_dwordx2 s[4:5], s[0:1], 80
    s_load_dwordx2 s[6:7], s[0:1], 96
    v_lshrrev_b32 v1, 6, v0
    v_and_b32 v2, 63, v0
    v_readfirstlane_b32 s8, v1
    v_lshlrev_b32 v3, 4, v2
    s_nop 1
    s_mul_i32 s9, s2, 2
    s_add_u32 s9, s9, s8
    s_mul_hi_u32 s10, s9, 61356676
    s_mul_i32 s11, s10, 70
    s_sub_u32 s11, s9, s11
    s_and_b32 s12, s10, 31
    s_lshr_b32 s13, s10, 5
    s_xor_b32 s14, s12, s13
    s_not_b32 s14, s14
    s_and_b32 s14, s14, 1
    s_lshl_b32 s15, s12, 6
    s_add_u32 s15, s15, s11
    s_lshl_b32 s15, s15, 2
    s_add_u32 s15, s15, 0x4000000
    s_waitcnt lgkmcnt(0)
    s_lshl_b32 s24, s14, 5
    s_add_u32 s24, s24, s12
    s_mul_i32 s24, s24, 573440
    s_add_u32 s16, s6, s24
    s_addc_u32 s17, s7, 0
    s_and_b32 s17, s17, 0xffff
    s_mov_b32 s18, 573440
    s_mov_b32 s19, 0x20000
    s_lshl_b32 s15, s11, 10
    buffer_load_dwordx4 v[16:19], v3, s[16:19], s15 offen
    s_add_u32 s15, s15, 71680
    buffer_load_dwordx4 v[20:23], v3, s[16:19], s15 offen
    s_add_u32 s15, s15, 71680
    buffer_load_dwordx4 v[24:27], v3, s[16:19], s15 offen
    s_add_u32 s15, s15, 71680
    buffer_load_dwordx4 v[28:31], v3, s[16:19], s15 offen
    s_add_u32 s15, s15, 71680
    buffer_load_dwordx4 v[32:35], v3, s[16:19], s15 offen
    s_add_u32 s15, s15, 71680
    buffer_load_dwordx4 v[36:39], v3, s[16:19], s15 offen
    s_add_u32 s15, s15, 71680
    buffer_load_dwordx4 v[40:43], v3, s[16:19], s15 offen
    s_add_u32 s15, s15, 71680
    buffer_load_dwordx4 v[44:47], v3, s[16:19], s15 offen
    s_mov_b32 s20, s4
    s_and_b32 s21, s5, 0xffff
    s_mov_b32 s22, 4587520
    s_mov_b32 s23, 0x20000
    s_mul_i32 s25, s11, 205
    s_lshr_b32 s25, s25, 10
    s_mul_i32 s26, s25, 5
    s_sub_u32 s26, s11, s26
    s_mul_i32 s24, s12, 80
    s_lshl_b32 s26, s26, 4
    s_add_u32 s24, s24, s26
    s_mul_i32 s24, s24, 1792
    s_mul_i32 s26, s14, 896
    s_add_u32 s24, s24, s26
    s_lshl_b32 s25, s25, 6
    s_add_u32 s24, s24, s25
    v_and_b32 v4, 15, v2
    v_mul_u32_u24 v4, 1792, v4
    v_bfe_u32 v5, v2, 4, 1
    v_lshl_add_u32 v4, v5, 5, v4
    v_lshrrev_b32 v5, 5, v2
    v_lshl_add_u32 v4, v5, 4, v4
    s_waitcnt vmcnt(7)
    v_lshlrev_b32 v48, 16, v16
    v_and_b32 v49, 0xffff0000, v16
    v_lshlrev_b32 v50, 16, v17
    v_and_b32 v51, 0xffff0000, v17
    v_lshlrev_b32 v52, 16, v18
    v_and_b32 v53, 0xffff0000, v18
    v_lshlrev_b32 v54, 16, v19
    v_and_b32 v55, 0xffff0000, v19
    s_waitcnt vmcnt(6)
    v_lshlrev_b32 v6, 16, v20
    v_and_b32 v7, 0xffff0000, v20
    v_pk_add_f32 v[48:49], v[48:49], v[6:7]
    v_lshlrev_b32 v6, 16, v21
    v_and_b32 v7, 0xffff0000, v21
    v_pk_add_f32 v[50:51], v[50:51], v[6:7]
    v_lshlrev_b32 v6, 16, v22
    v_and_b32 v7, 0xffff0000, v22
    v_pk_add_f32 v[52:53], v[52:53], v[6:7]
    v_lshlrev_b32 v6, 16, v23
    v_and_b32 v7, 0xffff0000, v23
    v_pk_add_f32 v[54:55], v[54:55], v[6:7]
    s_waitcnt vmcnt(5)
    v_lshlrev_b32 v6, 16, v24
    v_and_b32 v7, 0xffff0000, v24
    v_pk_add_f32 v[48:49], v[48:49], v[6:7]
    v_lshlrev_b32 v6, 16, v25
    v_and_b32 v7, 0xffff0000, v25
    v_pk_add_f32 v[50:51], v[50:51], v[6:7]
    v_lshlrev_b32 v6, 16, v26
    v_and_b32 v7, 0xffff0000, v26
    v_pk_add_f32 v[52:53], v[52:53], v[6:7]
    v_lshlrev_b32 v6, 16, v27
    v_and_b32 v7, 0xffff0000, v27
    v_pk_add_f32 v[54:55], v[54:55], v[6:7]
    s_waitcnt vmcnt(4)
    v_lshlrev_b32 v6, 16, v28
    v_and_b32 v7, 0xffff0000, v28
    v_pk_add_f32 v[48:49], v[48:49], v[6:7]
    v_lshlrev_b32 v6, 16, v29
    v_and_b32 v7, 0xffff0000, v29
    v_pk_add_f32 v[50:51], v[50:51], v[6:7]
    v_lshlrev_b32 v6, 16, v30
    v_and_b32 v7, 0xffff0000, v30
    v_pk_add_f32 v[52:53], v[52:53], v[6:7]
    v_lshlrev_b32 v6, 16, v31
    v_and_b32 v7, 0xffff0000, v31
    v_pk_add_f32 v[54:55], v[54:55], v[6:7]
    s_waitcnt vmcnt(3)
    v_lshlrev_b32 v6, 16, v32
    v_and_b32 v7, 0xffff0000, v32
    v_pk_add_f32 v[48:49], v[48:49], v[6:7]
    v_lshlrev_b32 v6, 16, v33
    v_and_b32 v7, 0xffff0000, v33
    v_pk_add_f32 v[50:51], v[50:51], v[6:7]
    v_lshlrev_b32 v6, 16, v34
    v_and_b32 v7, 0xffff0000, v34
    v_pk_add_f32 v[52:53], v[52:53], v[6:7]
    v_lshlrev_b32 v6, 16, v35
    v_and_b32 v7, 0xffff0000, v35
    v_pk_add_f32 v[54:55], v[54:55], v[6:7]
    s_waitcnt vmcnt(2)
    v_lshlrev_b32 v6, 16, v36
    v_and_b32 v7, 0xffff0000, v36
    v_pk_add_f32 v[48:49], v[48:49], v[6:7]
    v_lshlrev_b32 v6, 16, v37
    v_and_b32 v7, 0xffff0000, v37
    v_pk_add_f32 v[50:51], v[50:51], v[6:7]
    v_lshlrev_b32 v6, 16, v38
    v_and_b32 v7, 0xffff0000, v38
    v_pk_add_f32 v[52:53], v[52:53], v[6:7]
    v_lshlrev_b32 v6, 16, v39
    v_and_b32 v7, 0xffff0000, v39
    v_pk_add_f32 v[54:55], v[54:55], v[6:7]
    s_waitcnt vmcnt(1)
    v_lshlrev_b32 v6, 16, v40
    v_and_b32 v7, 0xffff0000, v40
    v_pk_add_f32 v[48:49], v[48:49], v[6:7]
    v_lshlrev_b32 v6, 16, v41
    v_and_b32 v7, 0xffff0000, v41
    v_pk_add_f32 v[50:51], v[50:51], v[6:7]
    v_lshlrev_b32 v6, 16, v42
    v_and_b32 v7, 0xffff0000, v42
    v_pk_add_f32 v[52:53], v[52:53], v[6:7]
    v_lshlrev_b32 v6, 16, v43
    v_and_b32 v7, 0xffff0000, v43
    v_pk_add_f32 v[54:55], v[54:55], v[6:7]
    s_waitcnt vmcnt(0)
    v_lshlrev_b32 v6, 16, v44
    v_and_b32 v7, 0xffff0000, v44
    v_pk_add_f32 v[48:49], v[48:49], v[6:7]
    v_lshlrev_b32 v6, 16, v45
    v_and_b32 v7, 0xffff0000, v45
    v_pk_add_f32 v[50:51], v[50:51], v[6:7]
    v_lshlrev_b32 v6, 16, v46
    v_and_b32 v7, 0xffff0000, v46
    v_pk_add_f32 v[52:53], v[52:53], v[6:7]
    v_lshlrev_b32 v6, 16, v47
    v_and_b32 v7, 0xffff0000, v47
    v_pk_add_f32 v[54:55], v[54:55], v[6:7]
    v_cvt_pk_bf16_f32 v8, v48, v49
    v_cvt_pk_bf16_f32 v9, v50, v51
    v_cvt_pk_bf16_f32 v10, v52, v53
    v_cvt_pk_bf16_f32 v11, v54, v55
    s_nop 0
    v_permlane16_swap_b32 v8, v10
    v_permlane16_swap_b32 v9, v11
    buffer_store_dwordx4 v[8:11], v4, s[20:23], s24 offen
L_red_end:
L_red_done:
    s_endpgm
.section .rodata,"a"
.p2align 6
.amdhsa_kernel concat_heads__gqa_block_cached__mha_block_cached__near_ridge_kernel
  .amdhsa_next_free_vgpr 256
  .amdhsa_next_free_sgpr 102
  .amdhsa_accum_offset 256
  .amdhsa_group_segment_fixed_size 0
  .amdhsa_kernarg_size 104
  .amdhsa_user_sgpr_count 2
  .amdhsa_user_sgpr_kernarg_segment_ptr 1
  .amdhsa_system_sgpr_workgroup_id_x 1
.end_amdhsa_kernel
.p2align 6
.amdhsa_kernel reduce_kernel
  .amdhsa_next_free_vgpr 56
  .amdhsa_next_free_sgpr 32
  .amdhsa_accum_offset 56
  .amdhsa_group_segment_fixed_size 0
  .amdhsa_kernarg_size 104
  .amdhsa_user_sgpr_count 2
  .amdhsa_user_sgpr_kernarg_segment_ptr 1
  .amdhsa_system_sgpr_workgroup_id_x 1
.end_amdhsa_kernel
```
